```python
import torch

def _softmax(x, axis=-1):
    return torch.softmax(x, dim=axis)

def _gelu(x):
    return torch.nn.functional.gelu(x, approximate='tanh')

def _silu(x):
    return torch.nn.functional.silu(x)

def _sigmoid(x):
    return torch.sigmoid(x)

def _layernorm(x, axis=-1, eps=1e-05):
    m = x.mean(dim=axis, keepdim=True)
    v = x.var(dim=axis, keepdim=True, unbiased=False)
    return (x - m) / torch.sqrt(v + eps)

def _scatter_add(tgt, idx, src, axis=0):
    return tgt.clone().index_add_(axis, idx, src)

def _segment_sum(src, seg, n):
    out = torch.zeros((n,) + src.shape[1:], dtype=src.dtype)
    return out.index_add_(0, seg, src)

def _pad(x, pw):
    flat = tuple((v for pair in reversed(pw) for v in pair))
    return torch.nn.functional.pad(x, flat)
kernel_name = 'adaLN_cond__mha_block__glu_gated_glu__prompt'

def setup_inputs():

    _w = lambda a: (lambda t: t.to(torch.bfloat16) if t.is_floating_point() else t)(torch.as_tensor(a))

    def _A_setup():
        B, S, D, H = (1, 2048, 512, 32)
        return {'x': _w((lambda *s: torch.randn(*s, dtype=torch.bfloat16) * 0.05)(B, S, D)), 'wqkv': _w((lambda *s: torch.randn(*s, dtype=torch.bfloat16) * 0.05)(D, 3 * D)), 'wo': _w((lambda *s: torch.randn(*s, dtype=torch.bfloat16) * 0.05)(D, D))}
    _A_in = _A_setup()

    def _B_setup():
        B, S, D, F = (1, 2048, 512, 1376)
        return {'x': _w((lambda *s: torch.randn(*s, dtype=torch.bfloat16) * 0.05)(B, S, D)), 'w_gate': _w((lambda *s: torch.randn(*s, dtype=torch.bfloat16) * 0.05)(D, F)), 'w_up': _w((lambda *s: torch.randn(*s, dtype=torch.bfloat16) * 0.05)(D, F)), 'w_down': _w((lambda *s: torch.randn(*s, dtype=torch.bfloat16) * 0.05)(F, D))}
    _B_in = _B_setup()
    return {'A_x': _A_in['x'], 'A_wqkv': _A_in['wqkv'], 'A_wo': _A_in['wo'], 'B_x': _B_in['x'], 'B_w_gate': _B_in['w_gate'], 'B_w_up': _B_in['w_up'], 'B_w_down': _B_in['w_down'], 'c': _w((lambda *s: torch.randn(*s, dtype=torch.bfloat16) * 0.1)(1, 512) * 8.0), 'w_mod': _w((lambda *s: torch.randn(*s, dtype=torch.bfloat16) * 0.1)(512, 6 * 512) * 512 ** (-0.5) * 8.0)}

def reference(A_x, A_wqkv, A_wo, B_x, B_w_gate, B_w_up, B_w_down, c, w_mod):

    def _A_ref(x, wqkv, wo):
        B, S, D = x.shape
        H = 32
        Dh = D // H
        qkv = (lambda x, *d: x.permute(*d))((x @ wqkv).reshape(B, S, 3, H, Dh), 2, 0, 3, 1, 4)
        q, k, v = (qkv[0], qkv[1], qkv[2])
        scores = torch.einsum('bhqd,bhkd->bhqk', q, k) * Dh ** (-0.5)
        p = _softmax(scores, axis=-1)
        o = torch.einsum('bhqk,bhkd->bhqd', p, v)
        return (lambda x, *d: x.permute(*d))(o, 0, 2, 1, 3).reshape(B, S, D) @ wo

    def _B_ref(x, w_gate, w_up, w_down):
        g = torch.einsum('bsd,df->bsf', x, w_gate)
        u = torch.einsum('bsd,df->bsf', x, w_up)
        h = _sigmoid(g) * u
        return torch.einsum('bsf,fd->bsd', h, w_down)
    x = A_x
    mod = (_silu(c) @ w_mod).reshape(c.shape[0], 6, 1, -1)
    sa, ca, ga, sb, cb, gb = (mod[:, 0].clone(), mod[:, 1].clone(), mod[:, 2].clone(), mod[:, 3].clone(), mod[:, 4].clone(), mod[:, 5].clone())
    h = _layernorm(x, axis=-1) * (1 + ca) + sa
    x = x + ga * _A_ref(h, A_wqkv, A_wo)
    h = _layernorm(x, axis=-1) * (1 + cb) + sb
    x = x + gb * _B_ref(h, B_w_gate, B_w_up, B_w_down)
    return x
```

```asm
; @launch kernel=front_kernel grid=(256,1,1) block=(512,1,1) lds=137280
; @launch kernel=fused_kernel grid=(256,1,1) block=(512,1,1) lds=163840
.amdgcn_target "amdgcn-amd-amdhsa--gfx950"
.text
.globl front_kernel
.p2align 8
.type front_kernel,@function
front_kernel:
  s_cmp_ge_u32 s2, 256
  s_cbranch_scc1 fr_end
  s_load_dwordx2 s[48:49], s[0:1], 32
  s_load_dwordx2 s[50:51], s[0:1], 40
  s_load_dwordx2 s[52:53], s[0:1], 48
  s_load_dwordx2 s[54:55], s[0:1], 16
  v_lshrrev_b32 v2, 6, v0
  v_and_b32 v1, 63, v0
  v_readfirstlane_b32 s28, v2
  s_getreg_b32 s24, hwreg(HW_REG_XCC_ID, 0, 4)
  s_and_b32 s24, s24, 7
  s_bfe_u32 s25, s2, 0x50003
  s_mov_b32 s29, 0
  s_lshl_b32 s62, s24, 4
  v_mov_b32 v5, 0
  v_mov_b32 v6, 137216
  v_lshlrev_b32 v3, 4, v1
  s_mov_b32 s46, 0x200000
  s_mov_b32 s47, 0x00020000
  s_load_dwordx2 s[56:57], s[0:1], 80
  s_load_dwordx2 s[4:5], s[0:1], 56
  s_load_dwordx2 s[8:9], s[0:1], 64
  s_load_dwordx2 s[12:13], s[0:1], 0
  s_load_dwordx2 s[16:17], s[0:1], 88
  s_load_dwordx2 s[20:21], s[0:1], 8
  s_mov_b32 s58, 256
  s_mov_b32 s59, 0x00020000
  s_mov_b32 s6, 1024
  s_mov_b32 s7, 0x00020000
  s_mov_b32 s10, 3145728
  s_mov_b32 s11, 0x00020000
  s_mov_b32 s14, 2097152
  s_mov_b32 s15, 0x00020000
  s_mov_b32 s18, 33554432
  s_mov_b32 s19, 0x00020000
  s_mov_b32 s22, 1572864
  s_mov_b32 s23, 0x00020000
  s_waitcnt lgkmcnt(0)
  s_cmp_eq_u32 s28, 4
  s_cbranch_scc0 fr_nc
  s_lshl_b32 s30, 1, s25
  v_mov_b32 v4, s30
  s_mov_b64 exec, 1
  buffer_atomic_or v4, v5, s[56:59], s62 offen sc0
  ds_write_b32 v6, v5 offset:4
  ds_write_b32 v6, v5 offset:8
  ds_write_b32 v6, v5 offset:12
  v_mov_b32 v2, -2
  ds_write_b32 v6, v2
  s_mov_b64 exec, -1
  s_waitcnt lgkmcnt(0)
fr_nc:
  v_lshrrev_b32 v8, 3, v1
  v_and_b32 v9, 7, v1
  v_xor_b32 v9, v9, v8
  v_lshlrev_b32 v9, 4, v9
  v_lshl_add_u32 v164, v8, 10, v9
  v_add_u32 v165, 7168, v164
  v_add_u32 v166, 14336, v164
  v_add_u32 v167, 21504, v164
  v_and_b32 v16, 3, v1
  v_lshrrev_b32 v17, 2, v1
  v_mul_u32_u24 v18, 0xc000, v17
  v_lshl_add_u32 v18, v16, 4, v18
  v_mul_u32_u24 v19, 0x6000, v17
  v_lshl_add_u32 v19, v16, 4, v19
  v_lshlrev_b32 v7, 4, v17
  s_and_b32 s31, s28, 3
fr_start:
  s_lshr_b32 s26, s24, 1
  s_lshl_b32 s26, s26, 2
  s_and_b32 s27, s25, 3
  s_add_u32 s26, s26, s27
  s_and_b32 s27, s24, 1
  s_lshl_b32 s27, s27, 3
  s_lshr_b32 s30, s25, 2
  s_add_u32 s27, s27, s30
  s_lshl_b32 s32, s26, 2
  s_add_u32 s32, s32, s31
  s_cmp_ge_u32 s28, 4
  s_cbranch_scc0 fr_main
fr_h0:
  s_and_b32 s39, s25, 3
  s_lshl_b32 s39, s39, 3
  s_lshr_b32 s38, s25, 2
  s_add_u32 s39, s39, s38
  s_sub_u32 s38, s39, 4
  s_lshr_b32 s35, s38, 1
  s_add_u32 s35, s35, 2
  s_lshl_b32 s36, s35, 9
  s_lshl_b32 s37, s24, 6
  s_and_b32 s38, s38, 1
  s_lshl_b32 s38, s38, 5
  s_add_u32 s37, s37, s38
  s_add_u32 s36, s36, s37
  s_lshl_b32 s38, s24, 7
  s_lshl_b32 s34, s39, 5
  s_add_u32 s38, s38, s34
  s_cmp_lt_u32 s39, 4
  s_cselect_b32 s36, s38, s36
  s_cmp_lt_u32 s39, 12
  s_cselect_b64 exec, -1, 0
  s_lshl_b32 s33, s31, 8
  buffer_load_dwordx4 v[20:23], v7, s[4:7], s33 offen
  s_mul_i32 s33, s31, 786432
  s_lshl_b32 s34, s36, 1
  s_add_u32 s34, s34, s33
  buffer_load_dwordx4 v[44:47], v18, s[8:11], s34 offen
  s_add_u32 s34, s34, 6144
  buffer_load_dwordx4 v[48:51], v18, s[8:11], s34 offen
  s_add_u32 s34, s34, 6144
  buffer_load_dwordx4 v[52:55], v18, s[8:11], s34 offen
  s_add_u32 s34, s34, 6144
  buffer_load_dwordx4 v[56:59], v18, s[8:11], s34 offen
  s_add_u32 s34, s34, 6144
  buffer_load_dwordx4 v[60:63], v18, s[8:11], s34 offen
  s_add_u32 s34, s34, 6144
  buffer_load_dwordx4 v[64:67], v18, s[8:11], s34 offen
  s_add_u32 s34, s34, 6144
  buffer_load_dwordx4 v[68:71], v18, s[8:11], s34 offen
  s_add_u32 s34, s34, 6144
  buffer_load_dwordx4 v[72:75], v18, s[8:11], s34 offen
  s_add_u32 s34, s34, 6144
  s_not_b64 exec, exec
  s_mov_b64 exec, -1
  s_barrier
  s_cmp_eq_u32 s28, 4
  s_cbranch_scc0 fr_cl2
  s_cmp_eq_u32 s29, 0
  s_cbranch_scc0 fr_cl2
  s_mov_b32 s34, s25
  s_waitcnt vmcnt(9)
  s_getreg_b32 s42, hwreg(HW_REG_HW_ID, 8, 8)
  s_mul_i32 s43, s42, 11
  s_add_u32 s43, s43, s2
  s_and_b32 s43, s43, 31
fr_cl0:
  v_readfirstlane_b32 s40, v4
  s_bitcmp1_b32 s40, s34
  s_cbranch_scc0 fr_cl1
  s_mov_b32 s41, s40
  s_lshr_b64 s[40:41], s[40:41], s43
  s_ff0_i32_b32 s34, s40
  s_cmp_lt_i32 s34, 0
  s_cbranch_scc1 fr_cl1
  s_add_u32 s34, s34, s43
  s_and_b32 s34, s34, 31
  s_lshl_b32 s40, 1, s34
  v_mov_b32 v4, s40
  s_mov_b64 exec, 1
  buffer_atomic_or v4, v5, s[56:59], s62 offen sc0
  s_mov_b64 exec, -1
  s_waitcnt vmcnt(0)
  s_branch fr_cl0
fr_cl1:
  v_mov_b32 v2, s34
  ds_write_b32 v6, v2
fr_cl2:
  s_mov_b32 s60, 0
fr_ck1:
  ds_read_b32 v2, v6
  s_waitcnt lgkmcnt(0)
  v_readfirstlane_b32 s34, v2
  s_cmp_eq_u32 s34, s25
  s_cbranch_scc1 fr_h1
  s_cmp_eq_u32 s34, -2
  s_cbranch_scc0 fr_rr
  s_sleep 1
  s_add_u32 s60, s60, 1
  s_cmp_lt_u32 s60, 160000
  s_cbranch_scc1 fr_ck1
fr_rr:
  s_cmp_lt_i32 s34, 0
  s_cbranch_scc1 fr_end
  s_mov_b32 s25, s34
  s_mov_b32 s29, 1
  s_waitcnt vmcnt(0)
  s_barrier
  s_branch fr_start
fr_main:
  s_lshl_b32 s33, s32, 15
  s_lshl_b32 s35, s28, 15
  s_barrier
  s_add_u32 m0, s35, 0
  s_add_u32 s36, s33, 0
  buffer_load_dwordx4 v164, s[12:15], s36 offen offset:0 lds
  buffer_load_dwordx4 v165, s[12:15], s36 offen offset:1024 lds
  buffer_load_dwordx4 v166, s[12:15], s36 offen offset:2048 lds
  buffer_load_dwordx4 v167, s[12:15], s36 offen offset:3072 lds
  s_add_u32 m0, s35, 4096
  s_add_u32 s36, s33, 128
  buffer_load_dwordx4 v164, s[12:15], s36 offen offset:0 lds
  buffer_load_dwordx4 v165, s[12:15], s36 offen offset:1024 lds
  buffer_load_dwordx4 v166, s[12:15], s36 offen offset:2048 lds
  buffer_load_dwordx4 v167, s[12:15], s36 offen offset:3072 lds
  s_add_u32 m0, s35, 8192
  s_add_u32 s36, s33, 256
  buffer_load_dwordx4 v164, s[12:15], s36 offen offset:0 lds
  buffer_load_dwordx4 v165, s[12:15], s36 offen offset:1024 lds
  buffer_load_dwordx4 v166, s[12:15], s36 offen offset:2048 lds
  buffer_load_dwordx4 v167, s[12:15], s36 offen offset:3072 lds
  v_lshrrev_b32 v8, 5, v1
  v_bfe_u32 v9, v1, 4, 1
  v_and_b32 v10, 31, v1
  v_and_b32 v11, 7, v1
  v_lshlrev_b32 v12, 7, v10
  v_add_u32 v12, s35, v12
  v_add_u32 v13, 0, v8
  v_xor_b32 v13, v13, v11
  v_lshl_add_u32 v252, v13, 4, v12
  v_add_u32 v13, 2, v8
  v_xor_b32 v13, v13, v11
  v_lshl_add_u32 v253, v13, 4, v12
  v_add_u32 v13, 4, v8
  v_xor_b32 v13, v13, v11
  v_lshl_add_u32 v254, v13, 4, v12
  v_add_u32 v13, 6, v8
  v_xor_b32 v13, v13, v11
  v_lshl_add_u32 v255, v13, 4, v12
  v_mul_u32_u24 v12, 576, v8
  v_lshrrev_b32 v13, 3, v10
  v_mul_u32_u24 v13, 144, v13
  v_add_u32 v12, v12, v13
  v_lshl_add_u32 v12, v11, 4, v12
  v_add_u32 v13, 36864, v12
  v_add_u32 v15, 73728, v12
  v_lshlrev_b32 v14, 4, v8
  v_add_u32 v14, 131072, v14
  v_mov_b32 v144, 0
  v_mov_b32 v145, 0
  v_mov_b32 v146, 0
  v_mov_b32 v147, 0
  v_mov_b32 v148, 0
  v_mov_b32 v149, 0
  v_mov_b32 v150, 0
  v_mov_b32 v151, 0
  v_mov_b32 v152, 0x3f803f80
  s_waitcnt vmcnt(8)
  ds_read_b128 v[16:19], v252 offset:0
  ds_read_b128 v[20:23], v253 offset:0
  ds_read_b128 v[24:27], v254 offset:0
  ds_read_b128 v[28:31], v255 offset:0
  s_add_u32 m0, s35, 12288
  s_add_u32 s36, s33, 384
  buffer_load_dwordx4 v164, s[12:15], s36 offen offset:0 lds
  buffer_load_dwordx4 v165, s[12:15], s36 offen offset:1024 lds
  buffer_load_dwordx4 v166, s[12:15], s36 offen offset:2048 lds
  buffer_load_dwordx4 v167, s[12:15], s36 offen offset:3072 lds
  ds_read_b32 v2, v6
  s_waitcnt lgkmcnt(0)
  v_readfirstlane_b32 s34, v2
  s_cmp_eq_u32 s34, -2
  s_cselect_b32 s34, s25, s34
  s_cmp_eq_u32 s34, s25
  s_cbranch_scc0 fr_rr
  s_waitcnt vmcnt(8)
  ds_read_b128 v[32:35], v252 offset:4096
  ds_read_b128 v[36:39], v253 offset:4096
  ds_read_b128 v[40:43], v254 offset:4096
  ds_read_b128 v[44:47], v255 offset:4096
  s_add_u32 m0, s35, 16384
  s_add_u32 s36, s33, 512
  buffer_load_dwordx4 v164, s[12:15], s36 offen offset:0 lds
  buffer_load_dwordx4 v165, s[12:15], s36 offen offset:1024 lds
  buffer_load_dwordx4 v166, s[12:15], s36 offen offset:2048 lds
  buffer_load_dwordx4 v167, s[12:15], s36 offen offset:3072 lds
  ds_read_b32 v2, v6
  v_dot2_f32_bf16 v144, v16, v152, v144
  v_dot2_f32_bf16 v148, v16, v16, v148
  v_dot2_f32_bf16 v145, v17, v152, v145
  v_dot2_f32_bf16 v149, v17, v17, v149
  v_dot2_f32_bf16 v146, v18, v152, v146
  v_dot2_f32_bf16 v150, v18, v18, v150
  v_dot2_f32_bf16 v147, v19, v152, v147
  v_dot2_f32_bf16 v151, v19, v19, v151
  v_dot2_f32_bf16 v144, v20, v152, v144
  v_dot2_f32_bf16 v148, v20, v20, v148
  v_dot2_f32_bf16 v145, v21, v152, v145
  v_dot2_f32_bf16 v149, v21, v21, v149
  v_dot2_f32_bf16 v146, v22, v152, v146
  v_dot2_f32_bf16 v150, v22, v22, v150
  v_dot2_f32_bf16 v147, v23, v152, v147
  v_dot2_f32_bf16 v151, v23, v23, v151
  v_dot2_f32_bf16 v144, v24, v152, v144
  v_dot2_f32_bf16 v148, v24, v24, v148
  v_dot2_f32_bf16 v145, v25, v152, v145
  v_dot2_f32_bf16 v149, v25, v25, v149
  v_dot2_f32_bf16 v146, v26, v152, v146
  v_dot2_f32_bf16 v150, v26, v26, v150
  v_dot2_f32_bf16 v147, v27, v152, v147
  v_dot2_f32_bf16 v151, v27, v27, v151
  v_dot2_f32_bf16 v144, v28, v152, v144
  v_dot2_f32_bf16 v148, v28, v28, v148
  v_dot2_f32_bf16 v145, v29, v152, v145
  v_dot2_f32_bf16 v149, v29, v29, v149
  v_dot2_f32_bf16 v146, v30, v152, v146
  v_dot2_f32_bf16 v150, v30, v30, v150
  v_dot2_f32_bf16 v147, v31, v152, v147
  v_dot2_f32_bf16 v151, v31, v31, v151
  s_waitcnt lgkmcnt(0)
  v_readfirstlane_b32 s34, v2
  s_cmp_eq_u32 s34, -2
  s_cselect_b32 s34, s25, s34
  s_cmp_eq_u32 s34, s25
  s_cbranch_scc0 fr_rr
  s_waitcnt vmcnt(8)
  ds_read_b128 v[48:51], v252 offset:8192
  ds_read_b128 v[52:55], v253 offset:8192
  ds_read_b128 v[56:59], v254 offset:8192
  ds_read_b128 v[60:63], v255 offset:8192
  s_add_u32 m0, s35, 20480
  s_add_u32 s36, s33, 640
  buffer_load_dwordx4 v164, s[12:15], s36 offen offset:0 lds
  buffer_load_dwordx4 v165, s[12:15], s36 offen offset:1024 lds
  buffer_load_dwordx4 v166, s[12:15], s36 offen offset:2048 lds
  buffer_load_dwordx4 v167, s[12:15], s36 offen offset:3072 lds
  ds_read_b32 v2, v6
  v_dot2_f32_bf16 v144, v32, v152, v144
  v_dot2_f32_bf16 v148, v32, v32, v148
  v_dot2_f32_bf16 v145, v33, v152, v145
  v_dot2_f32_bf16 v149, v33, v33, v149
  v_dot2_f32_bf16 v146, v34, v152, v146
  v_dot2_f32_bf16 v150, v34, v34, v150
  v_dot2_f32_bf16 v147, v35, v152, v147
  v_dot2_f32_bf16 v151, v35, v35, v151
  v_dot2_f32_bf16 v144, v36, v152, v144
  v_dot2_f32_bf16 v148, v36, v36, v148
  v_dot2_f32_bf16 v145, v37, v152, v145
  v_dot2_f32_bf16 v149, v37, v37, v149
  v_dot2_f32_bf16 v146, v38, v152, v146
  v_dot2_f32_bf16 v150, v38, v38, v150
  v_dot2_f32_bf16 v147, v39, v152, v147
  v_dot2_f32_bf16 v151, v39, v39, v151
  v_dot2_f32_bf16 v144, v40, v152, v144
  v_dot2_f32_bf16 v148, v40, v40, v148
  v_dot2_f32_bf16 v145, v41, v152, v145
  v_dot2_f32_bf16 v149, v41, v41, v149
  v_dot2_f32_bf16 v146, v42, v152, v146
  v_dot2_f32_bf16 v150, v42, v42, v150
  v_dot2_f32_bf16 v147, v43, v152, v147
  v_dot2_f32_bf16 v151, v43, v43, v151
  v_dot2_f32_bf16 v144, v44, v152, v144
  v_dot2_f32_bf16 v148, v44, v44, v148
  v_dot2_f32_bf16 v145, v45, v152, v145
  v_dot2_f32_bf16 v149, v45, v45, v149
  v_dot2_f32_bf16 v146, v46, v152, v146
  v_dot2_f32_bf16 v150, v46, v46, v150
  v_dot2_f32_bf16 v147, v47, v152, v147
  v_dot2_f32_bf16 v151, v47, v47, v151
  s_waitcnt lgkmcnt(0)
  v_readfirstlane_b32 s34, v2
  s_cmp_eq_u32 s34, -2
  s_cselect_b32 s34, s25, s34
  s_cmp_eq_u32 s34, s25
  s_cbranch_scc0 fr_rr
  s_waitcnt vmcnt(8)
  ds_read_b128 v[64:67], v252 offset:12288
  ds_read_b128 v[68:71], v253 offset:12288
  ds_read_b128 v[72:75], v254 offset:12288
  ds_read_b128 v[76:79], v255 offset:12288
  s_add_u32 m0, s35, 24576
  s_add_u32 s36, s33, 768
  buffer_load_dwordx4 v164, s[12:15], s36 offen offset:0 lds
  buffer_load_dwordx4 v165, s[12:15], s36 offen offset:1024 lds
  buffer_load_dwordx4 v166, s[12:15], s36 offen offset:2048 lds
  buffer_load_dwordx4 v167, s[12:15], s36 offen offset:3072 lds
  v_dot2_f32_bf16 v144, v48, v152, v144
  v_dot2_f32_bf16 v148, v48, v48, v148
  v_dot2_f32_bf16 v145, v49, v152, v145
  v_dot2_f32_bf16 v149, v49, v49, v149
  v_dot2_f32_bf16 v146, v50, v152, v146
  v_dot2_f32_bf16 v150, v50, v50, v150
  v_dot2_f32_bf16 v147, v51, v152, v147
  v_dot2_f32_bf16 v151, v51, v51, v151
  v_dot2_f32_bf16 v144, v52, v152, v144
  v_dot2_f32_bf16 v148, v52, v52, v148
  v_dot2_f32_bf16 v145, v53, v152, v145
  v_dot2_f32_bf16 v149, v53, v53, v149
  v_dot2_f32_bf16 v146, v54, v152, v146
  v_dot2_f32_bf16 v150, v54, v54, v150
  v_dot2_f32_bf16 v147, v55, v152, v147
  v_dot2_f32_bf16 v151, v55, v55, v151
  v_dot2_f32_bf16 v144, v56, v152, v144
  v_dot2_f32_bf16 v148, v56, v56, v148
  v_dot2_f32_bf16 v145, v57, v152, v145
  v_dot2_f32_bf16 v149, v57, v57, v149
  v_dot2_f32_bf16 v146, v58, v152, v146
  v_dot2_f32_bf16 v150, v58, v58, v150
  v_dot2_f32_bf16 v147, v59, v152, v147
  v_dot2_f32_bf16 v151, v59, v59, v151
  v_dot2_f32_bf16 v144, v60, v152, v144
  v_dot2_f32_bf16 v148, v60, v60, v148
  v_dot2_f32_bf16 v145, v61, v152, v145
  v_dot2_f32_bf16 v149, v61, v61, v149
  v_dot2_f32_bf16 v146, v62, v152, v146
  v_dot2_f32_bf16 v150, v62, v62, v150
  v_dot2_f32_bf16 v147, v63, v152, v147
  v_dot2_f32_bf16 v151, v63, v63, v151
  s_waitcnt lgkmcnt(0)
  s_waitcnt vmcnt(8)
  ds_read_b128 v[80:83], v252 offset:16384
  ds_read_b128 v[84:87], v253 offset:16384
  ds_read_b128 v[88:91], v254 offset:16384
  ds_read_b128 v[92:95], v255 offset:16384
  s_add_u32 m0, s35, 28672
  s_add_u32 s36, s33, 896
  buffer_load_dwordx4 v164, s[12:15], s36 offen offset:0 lds
  buffer_load_dwordx4 v165, s[12:15], s36 offen offset:1024 lds
  buffer_load_dwordx4 v166, s[12:15], s36 offen offset:2048 lds
  buffer_load_dwordx4 v167, s[12:15], s36 offen offset:3072 lds
  v_mov_b32 v7, 1
  s_mov_b64 exec, 1
  ds_add_u32 v6, v7 offset:12
  s_mov_b64 exec, -1
  ds_read_b32 v2, v6
  v_dot2_f32_bf16 v144, v64, v152, v144
  v_dot2_f32_bf16 v148, v64, v64, v148
  v_dot2_f32_bf16 v145, v65, v152, v145
  v_dot2_f32_bf16 v149, v65, v65, v149
  v_dot2_f32_bf16 v146, v66, v152, v146
  v_dot2_f32_bf16 v150, v66, v66, v150
  v_dot2_f32_bf16 v147, v67, v152, v147
  v_dot2_f32_bf16 v151, v67, v67, v151
  v_dot2_f32_bf16 v144, v68, v152, v144
  v_dot2_f32_bf16 v148, v68, v68, v148
  v_dot2_f32_bf16 v145, v69, v152, v145
  v_dot2_f32_bf16 v149, v69, v69, v149
  v_dot2_f32_bf16 v146, v70, v152, v146
  v_dot2_f32_bf16 v150, v70, v70, v150
  v_dot2_f32_bf16 v147, v71, v152, v147
  v_dot2_f32_bf16 v151, v71, v71, v151
  v_dot2_f32_bf16 v144, v72, v152, v144
  v_dot2_f32_bf16 v148, v72, v72, v148
  v_dot2_f32_bf16 v145, v73, v152, v145
  v_dot2_f32_bf16 v149, v73, v73, v149
  v_dot2_f32_bf16 v146, v74, v152, v146
  v_dot2_f32_bf16 v150, v74, v74, v150
  v_dot2_f32_bf16 v147, v75, v152, v147
  v_dot2_f32_bf16 v151, v75, v75, v151
  v_dot2_f32_bf16 v144, v76, v152, v144
  v_dot2_f32_bf16 v148, v76, v76, v148
  v_dot2_f32_bf16 v145, v77, v152, v145
  v_dot2_f32_bf16 v149, v77, v77, v149
  v_dot2_f32_bf16 v146, v78, v152, v146
  v_dot2_f32_bf16 v150, v78, v78, v150
  v_dot2_f32_bf16 v147, v79, v152, v147
  v_dot2_f32_bf16 v151, v79, v79, v151
  s_waitcnt lgkmcnt(0)
  v_readfirstlane_b32 s34, v2
  s_cmp_eq_u32 s34, -2
  s_cselect_b32 s34, s25, s34
  s_cmp_eq_u32 s34, s25
  s_cbranch_scc0 fr_rr
  s_waitcnt vmcnt(8)
  ds_read_b128 v[96:99], v252 offset:20480
  ds_read_b128 v[100:103], v253 offset:20480
  ds_read_b128 v[104:107], v254 offset:20480
  ds_read_b128 v[108:111], v255 offset:20480
  v_dot2_f32_bf16 v144, v80, v152, v144
  v_dot2_f32_bf16 v148, v80, v80, v148
  v_dot2_f32_bf16 v145, v81, v152, v145
  v_dot2_f32_bf16 v149, v81, v81, v149
  v_dot2_f32_bf16 v146, v82, v152, v146
  v_dot2_f32_bf16 v150, v82, v82, v150
  v_dot2_f32_bf16 v147, v83, v152, v147
  v_dot2_f32_bf16 v151, v83, v83, v151
  v_dot2_f32_bf16 v144, v84, v152, v144
  v_dot2_f32_bf16 v148, v84, v84, v148
  v_dot2_f32_bf16 v145, v85, v152, v145
  v_dot2_f32_bf16 v149, v85, v85, v149
  v_dot2_f32_bf16 v146, v86, v152, v146
  v_dot2_f32_bf16 v150, v86, v86, v150
  v_dot2_f32_bf16 v147, v87, v152, v147
  v_dot2_f32_bf16 v151, v87, v87, v151
  v_dot2_f32_bf16 v144, v88, v152, v144
  v_dot2_f32_bf16 v148, v88, v88, v148
  v_dot2_f32_bf16 v145, v89, v152, v145
  v_dot2_f32_bf16 v149, v89, v89, v149
  v_dot2_f32_bf16 v146, v90, v152, v146
  v_dot2_f32_bf16 v150, v90, v90, v150
  v_dot2_f32_bf16 v147, v91, v152, v147
  v_dot2_f32_bf16 v151, v91, v91, v151
  v_dot2_f32_bf16 v144, v92, v152, v144
  v_dot2_f32_bf16 v148, v92, v92, v148
  v_dot2_f32_bf16 v145, v93, v152, v145
  v_dot2_f32_bf16 v149, v93, v93, v149
  v_dot2_f32_bf16 v146, v94, v152, v146
  v_dot2_f32_bf16 v150, v94, v94, v150
  v_dot2_f32_bf16 v147, v95, v152, v147
  v_dot2_f32_bf16 v151, v95, v95, v151
  s_waitcnt lgkmcnt(0)
  s_waitcnt vmcnt(4)
  ds_read_b128 v[112:115], v252 offset:24576
  ds_read_b128 v[116:119], v253 offset:24576
  ds_read_b128 v[120:123], v254 offset:24576
  ds_read_b128 v[124:127], v255 offset:24576
  v_dot2_f32_bf16 v144, v96, v152, v144
  v_dot2_f32_bf16 v148, v96, v96, v148
  v_dot2_f32_bf16 v145, v97, v152, v145
  v_dot2_f32_bf16 v149, v97, v97, v149
  v_dot2_f32_bf16 v146, v98, v152, v146
  v_dot2_f32_bf16 v150, v98, v98, v150
  v_dot2_f32_bf16 v147, v99, v152, v147
  v_dot2_f32_bf16 v151, v99, v99, v151
  v_dot2_f32_bf16 v144, v100, v152, v144
  v_dot2_f32_bf16 v148, v100, v100, v148
  v_dot2_f32_bf16 v145, v101, v152, v145
  v_dot2_f32_bf16 v149, v101, v101, v149
  v_dot2_f32_bf16 v146, v102, v152, v146
  v_dot2_f32_bf16 v150, v102, v102, v150
  v_dot2_f32_bf16 v147, v103, v152, v147
  v_dot2_f32_bf16 v151, v103, v103, v151
  v_dot2_f32_bf16 v144, v104, v152, v144
  v_dot2_f32_bf16 v148, v104, v104, v148
  v_dot2_f32_bf16 v145, v105, v152, v145
  v_dot2_f32_bf16 v149, v105, v105, v149
  v_dot2_f32_bf16 v146, v106, v152, v146
  v_dot2_f32_bf16 v150, v106, v106, v150
  v_dot2_f32_bf16 v147, v107, v152, v147
  v_dot2_f32_bf16 v151, v107, v107, v151
  v_dot2_f32_bf16 v144, v108, v152, v144
  v_dot2_f32_bf16 v148, v108, v108, v148
  v_dot2_f32_bf16 v145, v109, v152, v145
  v_dot2_f32_bf16 v149, v109, v109, v149
  v_dot2_f32_bf16 v146, v110, v152, v146
  v_dot2_f32_bf16 v150, v110, v110, v150
  v_dot2_f32_bf16 v147, v111, v152, v147
  v_dot2_f32_bf16 v151, v111, v111, v151
  s_waitcnt lgkmcnt(0)
  s_waitcnt vmcnt(0)
  ds_read_b128 v[128:131], v252 offset:28672
  ds_read_b128 v[132:135], v253 offset:28672
  ds_read_b128 v[136:139], v254 offset:28672
  ds_read_b128 v[140:143], v255 offset:28672
  v_dot2_f32_bf16 v144, v112, v152, v144
  v_dot2_f32_bf16 v148, v112, v112, v148
  v_dot2_f32_bf16 v145, v113, v152, v145
  v_dot2_f32_bf16 v149, v113, v113, v149
  v_dot2_f32_bf16 v146, v114, v152, v146
  v_dot2_f32_bf16 v150, v114, v114, v150
  v_dot2_f32_bf16 v147, v115, v152, v147
  v_dot2_f32_bf16 v151, v115, v115, v151
  v_dot2_f32_bf16 v144, v116, v152, v144
  v_dot2_f32_bf16 v148, v116, v116, v148
  v_dot2_f32_bf16 v145, v117, v152, v145
  v_dot2_f32_bf16 v149, v117, v117, v149
  v_dot2_f32_bf16 v146, v118, v152, v146
  v_dot2_f32_bf16 v150, v118, v118, v150
  v_dot2_f32_bf16 v147, v119, v152, v147
  v_dot2_f32_bf16 v151, v119, v119, v151
  v_dot2_f32_bf16 v144, v120, v152, v144
  v_dot2_f32_bf16 v148, v120, v120, v148
  v_dot2_f32_bf16 v145, v121, v152, v145
  v_dot2_f32_bf16 v149, v121, v121, v149
  v_dot2_f32_bf16 v146, v122, v152, v146
  v_dot2_f32_bf16 v150, v122, v122, v150
  v_dot2_f32_bf16 v147, v123, v152, v147
  v_dot2_f32_bf16 v151, v123, v123, v151
  v_dot2_f32_bf16 v144, v124, v152, v144
  v_dot2_f32_bf16 v148, v124, v124, v148
  v_dot2_f32_bf16 v145, v125, v152, v145
  v_dot2_f32_bf16 v149, v125, v125, v149
  v_dot2_f32_bf16 v146, v126, v152, v146
  v_dot2_f32_bf16 v150, v126, v126, v150
  v_dot2_f32_bf16 v147, v127, v152, v147
  v_dot2_f32_bf16 v151, v127, v127, v151
  s_waitcnt lgkmcnt(0)
  s_mov_b32 s60, 0
fr_ck2:
  ds_read_b32 v2, v6
  s_waitcnt lgkmcnt(0)
  v_readfirstlane_b32 s34, v2
  s_cmp_eq_u32 s34, s25
  s_cbranch_scc1 fr_mok
  s_cmp_eq_u32 s34, -2
  s_cbranch_scc0 fr_rr
  s_sleep 1
  s_add_u32 s60, s60, 1
  s_cmp_lt_u32 s60, 160000
  s_cbranch_scc1 fr_ck2
  s_branch fr_rr
fr_mok:
  s_mov_b64 exec, 1
  ds_add_u32 v6, v7 offset:8
  s_mov_b64 exec, -1
  v_dot2_f32_bf16 v144, v128, v152, v144
  v_dot2_f32_bf16 v148, v128, v128, v148
  v_dot2_f32_bf16 v145, v129, v152, v145
  v_dot2_f32_bf16 v149, v129, v129, v149
  v_dot2_f32_bf16 v146, v130, v152, v146
  v_dot2_f32_bf16 v150, v130, v130, v150
  v_dot2_f32_bf16 v147, v131, v152, v147
  v_dot2_f32_bf16 v151, v131, v131, v151
  v_dot2_f32_bf16 v144, v132, v152, v144
  v_dot2_f32_bf16 v148, v132, v132, v148
  v_dot2_f32_bf16 v145, v133, v152, v145
  v_dot2_f32_bf16 v149, v133, v133, v149
  v_dot2_f32_bf16 v146, v134, v152, v146
  v_dot2_f32_bf16 v150, v134, v134, v150
  v_dot2_f32_bf16 v147, v135, v152, v147
  v_dot2_f32_bf16 v151, v135, v135, v151
  v_dot2_f32_bf16 v144, v136, v152, v144
  v_dot2_f32_bf16 v148, v136, v136, v148
  v_dot2_f32_bf16 v145, v137, v152, v145
  v_dot2_f32_bf16 v149, v137, v137, v149
  v_dot2_f32_bf16 v146, v138, v152, v146
  v_dot2_f32_bf16 v150, v138, v138, v150
  v_dot2_f32_bf16 v147, v139, v152, v147
  v_dot2_f32_bf16 v151, v139, v139, v151
  v_dot2_f32_bf16 v144, v140, v152, v144
  v_dot2_f32_bf16 v148, v140, v140, v148
  v_dot2_f32_bf16 v145, v141, v152, v145
  v_dot2_f32_bf16 v149, v141, v141, v149
  v_dot2_f32_bf16 v146, v142, v152, v146
  v_dot2_f32_bf16 v150, v142, v142, v150
  v_dot2_f32_bf16 v147, v143, v152, v147
  v_dot2_f32_bf16 v151, v143, v143, v151
  s_nop 2
  v_add_f32 v144, v144, v145
  v_add_f32 v146, v146, v147
  v_add_f32 v148, v148, v149
  v_add_f32 v150, v150, v151
  v_add_f32 v144, v144, v146
  v_add_f32 v148, v148, v150
  v_mov_b32 v145, v144
  v_mov_b32 v149, v148
  s_nop 1
  v_permlane32_swap_b32 v144, v145
  v_permlane32_swap_b32 v148, v149
  s_nop 1
  v_add_f32 v144, v144, v145
  v_add_f32 v148, v148, v149
  v_mul_f32 v144, 0.001953125, v144
  v_mul_f32 v148, 0.001953125, v148
  v_fma_f32 v148, -v144, v144, v148
  v_max_f32 v148, 0, v148
  v_add_f32 v148, 0x3727c5ac, v148
  v_rsq_f32 v148, v148
  s_nop 0
  v_mul_f32_e64 v144, -v144, v148
  v_mov_b32 v149, v148
  v_mov_b32 v145, v144
  s_mov_b32 s36, 16384
  v_lshlrev_b32 v7, 2, v10
  v_lshlrev_b32 v156, 16, v16
  v_and_b32 v157, 0xffff0000, v16
  v_pk_fma_f32 v[156:157], v[156:157], v[148:149], v[144:145]
  v_lshlrev_b32 v158, 16, v17
  v_and_b32 v159, 0xffff0000, v17
  v_pk_fma_f32 v[158:159], v[158:159], v[148:149], v[144:145]
  v_cvt_pk_f16_f32 v16, v156, v157
  v_lshlrev_b32 v160, 16, v18
  v_and_b32 v161, 0xffff0000, v18
  v_pk_fma_f32 v[160:161], v[160:161], v[148:149], v[144:145]
  v_cvt_pk_f16_f32 v17, v158, v159
  v_lshlrev_b32 v162, 16, v19
  v_and_b32 v163, 0xffff0000, v19
  v_pk_fma_f32 v[162:163], v[162:163], v[148:149], v[144:145]
  v_cvt_pk_f16_f32 v18, v160, v161
  v_lshlrev_b32 v156, 16, v20
  v_and_b32 v157, 0xffff0000, v20
  v_pk_fma_f32 v[156:157], v[156:157], v[148:149], v[144:145]
  v_cvt_pk_f16_f32 v19, v162, v163
  v_lshlrev_b32 v158, 16, v21
  v_and_b32 v159, 0xffff0000, v21
  v_pk_fma_f32 v[158:159], v[158:159], v[148:149], v[144:145]
  v_cvt_pk_f16_f32 v20, v156, v157
  v_lshlrev_b32 v160, 16, v22
  v_and_b32 v161, 0xffff0000, v22
  v_pk_fma_f32 v[160:161], v[160:161], v[148:149], v[144:145]
  v_cvt_pk_f16_f32 v21, v158, v159
  v_lshlrev_b32 v162, 16, v23
  v_and_b32 v163, 0xffff0000, v23
  v_pk_fma_f32 v[162:163], v[162:163], v[148:149], v[144:145]
  v_cvt_pk_f16_f32 v22, v160, v161
  v_lshlrev_b32 v156, 16, v24
  v_and_b32 v157, 0xffff0000, v24
  v_pk_fma_f32 v[156:157], v[156:157], v[148:149], v[144:145]
  v_cvt_pk_f16_f32 v23, v162, v163
  v_lshlrev_b32 v158, 16, v25
  v_and_b32 v159, 0xffff0000, v25
  v_pk_fma_f32 v[158:159], v[158:159], v[148:149], v[144:145]
  v_cvt_pk_f16_f32 v24, v156, v157
  v_lshlrev_b32 v160, 16, v26
  v_and_b32 v161, 0xffff0000, v26
  v_pk_fma_f32 v[160:161], v[160:161], v[148:149], v[144:145]
  v_cvt_pk_f16_f32 v25, v158, v159
  v_lshlrev_b32 v162, 16, v27
  v_and_b32 v163, 0xffff0000, v27
  v_pk_fma_f32 v[162:163], v[162:163], v[148:149], v[144:145]
  v_cvt_pk_f16_f32 v26, v160, v161
  v_lshlrev_b32 v156, 16, v28
  v_and_b32 v157, 0xffff0000, v28
  v_pk_fma_f32 v[156:157], v[156:157], v[148:149], v[144:145]
  v_cvt_pk_f16_f32 v27, v162, v163
  v_lshlrev_b32 v158, 16, v29
  v_and_b32 v159, 0xffff0000, v29
  v_pk_fma_f32 v[158:159], v[158:159], v[148:149], v[144:145]
  v_cvt_pk_f16_f32 v28, v156, v157
  v_lshlrev_b32 v160, 16, v30
  v_and_b32 v161, 0xffff0000, v30
  v_pk_fma_f32 v[160:161], v[160:161], v[148:149], v[144:145]
  v_cvt_pk_f16_f32 v29, v158, v159
  v_lshlrev_b32 v162, 16, v31
  v_and_b32 v163, 0xffff0000, v31
  v_pk_fma_f32 v[162:163], v[162:163], v[148:149], v[144:145]
  v_cvt_pk_f16_f32 v30, v160, v161
  v_lshlrev_b32 v156, 16, v32
  v_and_b32 v157, 0xffff0000, v32
  v_pk_fma_f32 v[156:157], v[156:157], v[148:149], v[144:145]
  v_cvt_pk_f16_f32 v31, v162, v163
  v_lshlrev_b32 v158, 16, v33
  v_and_b32 v159, 0xffff0000, v33
  v_pk_fma_f32 v[158:159], v[158:159], v[148:149], v[144:145]
  v_cvt_pk_f16_f32 v32, v156, v157
  v_lshlrev_b32 v160, 16, v34
  v_and_b32 v161, 0xffff0000, v34
  v_pk_fma_f32 v[160:161], v[160:161], v[148:149], v[144:145]
  v_cvt_pk_f16_f32 v33, v158, v159
  v_lshlrev_b32 v162, 16, v35
  v_and_b32 v163, 0xffff0000, v35
  v_pk_fma_f32 v[162:163], v[162:163], v[148:149], v[144:145]
  v_cvt_pk_f16_f32 v34, v160, v161
  v_lshlrev_b32 v156, 16, v36
  v_and_b32 v157, 0xffff0000, v36
  v_pk_fma_f32 v[156:157], v[156:157], v[148:149], v[144:145]
  v_cvt_pk_f16_f32 v35, v162, v163
  v_lshlrev_b32 v158, 16, v37
  v_and_b32 v159, 0xffff0000, v37
  v_pk_fma_f32 v[158:159], v[158:159], v[148:149], v[144:145]
  v_cvt_pk_f16_f32 v36, v156, v157
  v_lshlrev_b32 v160, 16, v38
  v_and_b32 v161, 0xffff0000, v38
  v_pk_fma_f32 v[160:161], v[160:161], v[148:149], v[144:145]
  v_cvt_pk_f16_f32 v37, v158, v159
  v_lshlrev_b32 v162, 16, v39
  v_and_b32 v163, 0xffff0000, v39
  v_pk_fma_f32 v[162:163], v[162:163], v[148:149], v[144:145]
  v_cvt_pk_f16_f32 v38, v160, v161
  v_lshlrev_b32 v156, 16, v40
  v_and_b32 v157, 0xffff0000, v40
  v_pk_fma_f32 v[156:157], v[156:157], v[148:149], v[144:145]
  v_cvt_pk_f16_f32 v39, v162, v163
  v_lshlrev_b32 v158, 16, v41
  v_and_b32 v159, 0xffff0000, v41
  v_pk_fma_f32 v[158:159], v[158:159], v[148:149], v[144:145]
  v_cvt_pk_f16_f32 v40, v156, v157
  v_lshlrev_b32 v160, 16, v42
  v_and_b32 v161, 0xffff0000, v42
  v_pk_fma_f32 v[160:161], v[160:161], v[148:149], v[144:145]
  v_cvt_pk_f16_f32 v41, v158, v159
  v_lshlrev_b32 v162, 16, v43
  v_and_b32 v163, 0xffff0000, v43
  v_pk_fma_f32 v[162:163], v[162:163], v[148:149], v[144:145]
  v_cvt_pk_f16_f32 v42, v160, v161
  v_lshlrev_b32 v156, 16, v44
  v_and_b32 v157, 0xffff0000, v44
  v_pk_fma_f32 v[156:157], v[156:157], v[148:149], v[144:145]
  v_cvt_pk_f16_f32 v43, v162, v163
  v_lshlrev_b32 v158, 16, v45
  v_and_b32 v159, 0xffff0000, v45
  v_pk_fma_f32 v[158:159], v[158:159], v[148:149], v[144:145]
  v_cvt_pk_f16_f32 v44, v156, v157
  v_lshlrev_b32 v160, 16, v46
  v_and_b32 v161, 0xffff0000, v46
  v_pk_fma_f32 v[160:161], v[160:161], v[148:149], v[144:145]
  v_cvt_pk_f16_f32 v45, v158, v159
  v_lshlrev_b32 v162, 16, v47
  v_and_b32 v163, 0xffff0000, v47
  v_pk_fma_f32 v[162:163], v[162:163], v[148:149], v[144:145]
  v_cvt_pk_f16_f32 v46, v160, v161
  v_lshlrev_b32 v156, 16, v48
  v_and_b32 v157, 0xffff0000, v48
  v_pk_fma_f32 v[156:157], v[156:157], v[148:149], v[144:145]
  v_cvt_pk_f16_f32 v47, v162, v163
  v_lshlrev_b32 v158, 16, v49
  v_and_b32 v159, 0xffff0000, v49
  v_pk_fma_f32 v[158:159], v[158:159], v[148:149], v[144:145]
  v_cvt_pk_f16_f32 v48, v156, v157
  v_lshlrev_b32 v160, 16, v50
  v_and_b32 v161, 0xffff0000, v50
  v_pk_fma_f32 v[160:161], v[160:161], v[148:149], v[144:145]
  v_cvt_pk_f16_f32 v49, v158, v159
  v_lshlrev_b32 v162, 16, v51
  v_and_b32 v163, 0xffff0000, v51
  v_pk_fma_f32 v[162:163], v[162:163], v[148:149], v[144:145]
  v_cvt_pk_f16_f32 v50, v160, v161
  v_lshlrev_b32 v156, 16, v52
  v_and_b32 v157, 0xffff0000, v52
  v_pk_fma_f32 v[156:157], v[156:157], v[148:149], v[144:145]
  v_cvt_pk_f16_f32 v51, v162, v163
  v_lshlrev_b32 v158, 16, v53
  v_and_b32 v159, 0xffff0000, v53
  v_pk_fma_f32 v[158:159], v[158:159], v[148:149], v[144:145]
  v_cvt_pk_f16_f32 v52, v156, v157
  v_lshlrev_b32 v160, 16, v54
  v_and_b32 v161, 0xffff0000, v54
  v_pk_fma_f32 v[160:161], v[160:161], v[148:149], v[144:145]
  v_cvt_pk_f16_f32 v53, v158, v159
  v_lshlrev_b32 v162, 16, v55
  v_and_b32 v163, 0xffff0000, v55
  v_pk_fma_f32 v[162:163], v[162:163], v[148:149], v[144:145]
  v_cvt_pk_f16_f32 v54, v160, v161
  v_lshlrev_b32 v156, 16, v56
  v_and_b32 v157, 0xffff0000, v56
  v_pk_fma_f32 v[156:157], v[156:157], v[148:149], v[144:145]
  v_cvt_pk_f16_f32 v55, v162, v163
  v_lshlrev_b32 v158, 16, v57
  v_and_b32 v159, 0xffff0000, v57
  v_pk_fma_f32 v[158:159], v[158:159], v[148:149], v[144:145]
  v_cvt_pk_f16_f32 v56, v156, v157
  v_lshlrev_b32 v160, 16, v58
  v_and_b32 v161, 0xffff0000, v58
  v_pk_fma_f32 v[160:161], v[160:161], v[148:149], v[144:145]
  v_cvt_pk_f16_f32 v57, v158, v159
  v_lshlrev_b32 v162, 16, v59
  v_and_b32 v163, 0xffff0000, v59
  v_pk_fma_f32 v[162:163], v[162:163], v[148:149], v[144:145]
  v_cvt_pk_f16_f32 v58, v160, v161
  v_lshlrev_b32 v156, 16, v60
  v_and_b32 v157, 0xffff0000, v60
  v_pk_fma_f32 v[156:157], v[156:157], v[148:149], v[144:145]
  v_cvt_pk_f16_f32 v59, v162, v163
  v_lshlrev_b32 v158, 16, v61
  v_and_b32 v159, 0xffff0000, v61
  v_pk_fma_f32 v[158:159], v[158:159], v[148:149], v[144:145]
  v_cvt_pk_f16_f32 v60, v156, v157
  v_lshlrev_b32 v160, 16, v62
  v_and_b32 v161, 0xffff0000, v62
  v_pk_fma_f32 v[160:161], v[160:161], v[148:149], v[144:145]
  v_cvt_pk_f16_f32 v61, v158, v159
  v_lshlrev_b32 v162, 16, v63
  v_and_b32 v163, 0xffff0000, v63
  v_pk_fma_f32 v[162:163], v[162:163], v[148:149], v[144:145]
  v_cvt_pk_f16_f32 v62, v160, v161
  v_lshlrev_b32 v156, 16, v64
  v_and_b32 v157, 0xffff0000, v64
  v_pk_fma_f32 v[156:157], v[156:157], v[148:149], v[144:145]
  v_cvt_pk_f16_f32 v63, v162, v163
  v_lshlrev_b32 v158, 16, v65
  v_and_b32 v159, 0xffff0000, v65
  v_pk_fma_f32 v[158:159], v[158:159], v[148:149], v[144:145]
  v_cvt_pk_f16_f32 v64, v156, v157
  v_lshlrev_b32 v160, 16, v66
  v_and_b32 v161, 0xffff0000, v66
  v_pk_fma_f32 v[160:161], v[160:161], v[148:149], v[144:145]
  v_cvt_pk_f16_f32 v65, v158, v159
  v_lshlrev_b32 v162, 16, v67
  v_and_b32 v163, 0xffff0000, v67
  v_pk_fma_f32 v[162:163], v[162:163], v[148:149], v[144:145]
  v_cvt_pk_f16_f32 v66, v160, v161
  v_lshlrev_b32 v156, 16, v68
  v_and_b32 v157, 0xffff0000, v68
  v_pk_fma_f32 v[156:157], v[156:157], v[148:149], v[144:145]
  v_cvt_pk_f16_f32 v67, v162, v163
  v_lshlrev_b32 v158, 16, v69
  v_and_b32 v159, 0xffff0000, v69
  v_pk_fma_f32 v[158:159], v[158:159], v[148:149], v[144:145]
  v_cvt_pk_f16_f32 v68, v156, v157
  v_lshlrev_b32 v160, 16, v70
  v_and_b32 v161, 0xffff0000, v70
  v_pk_fma_f32 v[160:161], v[160:161], v[148:149], v[144:145]
  v_cvt_pk_f16_f32 v69, v158, v159
  v_lshlrev_b32 v162, 16, v71
  v_and_b32 v163, 0xffff0000, v71
  v_pk_fma_f32 v[162:163], v[162:163], v[148:149], v[144:145]
  v_cvt_pk_f16_f32 v70, v160, v161
  v_lshlrev_b32 v156, 16, v72
  v_and_b32 v157, 0xffff0000, v72
  v_pk_fma_f32 v[156:157], v[156:157], v[148:149], v[144:145]
  v_cvt_pk_f16_f32 v71, v162, v163
  v_lshlrev_b32 v158, 16, v73
  v_and_b32 v159, 0xffff0000, v73
  v_pk_fma_f32 v[158:159], v[158:159], v[148:149], v[144:145]
  v_cvt_pk_f16_f32 v72, v156, v157
  v_lshlrev_b32 v160, 16, v74
  v_and_b32 v161, 0xffff0000, v74
  v_pk_fma_f32 v[160:161], v[160:161], v[148:149], v[144:145]
  v_cvt_pk_f16_f32 v73, v158, v159
  v_lshlrev_b32 v162, 16, v75
  v_and_b32 v163, 0xffff0000, v75
  v_pk_fma_f32 v[162:163], v[162:163], v[148:149], v[144:145]
  v_cvt_pk_f16_f32 v74, v160, v161
  v_lshlrev_b32 v156, 16, v76
  v_and_b32 v157, 0xffff0000, v76
  v_pk_fma_f32 v[156:157], v[156:157], v[148:149], v[144:145]
  v_cvt_pk_f16_f32 v75, v162, v163
  v_lshlrev_b32 v158, 16, v77
  v_and_b32 v159, 0xffff0000, v77
  v_pk_fma_f32 v[158:159], v[158:159], v[148:149], v[144:145]
  v_cvt_pk_f16_f32 v76, v156, v157
  v_lshlrev_b32 v160, 16, v78
  v_and_b32 v161, 0xffff0000, v78
  v_pk_fma_f32 v[160:161], v[160:161], v[148:149], v[144:145]
  v_cvt_pk_f16_f32 v77, v158, v159
  v_lshlrev_b32 v162, 16, v79
  v_and_b32 v163, 0xffff0000, v79
  v_pk_fma_f32 v[162:163], v[162:163], v[148:149], v[144:145]
  v_cvt_pk_f16_f32 v78, v160, v161
  v_lshlrev_b32 v156, 16, v80
  v_and_b32 v157, 0xffff0000, v80
  v_pk_fma_f32 v[156:157], v[156:157], v[148:149], v[144:145]
  v_cvt_pk_f16_f32 v79, v162, v163
  v_lshlrev_b32 v158, 16, v81
  v_and_b32 v159, 0xffff0000, v81
  v_pk_fma_f32 v[158:159], v[158:159], v[148:149], v[144:145]
  v_cvt_pk_f16_f32 v80, v156, v157
  v_lshlrev_b32 v160, 16, v82
  v_and_b32 v161, 0xffff0000, v82
  v_pk_fma_f32 v[160:161], v[160:161], v[148:149], v[144:145]
  v_cvt_pk_f16_f32 v81, v158, v159
  v_lshlrev_b32 v162, 16, v83
  v_and_b32 v163, 0xffff0000, v83
  v_pk_fma_f32 v[162:163], v[162:163], v[148:149], v[144:145]
  v_cvt_pk_f16_f32 v82, v160, v161
  v_lshlrev_b32 v156, 16, v84
  v_and_b32 v157, 0xffff0000, v84
  v_pk_fma_f32 v[156:157], v[156:157], v[148:149], v[144:145]
  v_cvt_pk_f16_f32 v83, v162, v163
  v_lshlrev_b32 v158, 16, v85
  v_and_b32 v159, 0xffff0000, v85
  v_pk_fma_f32 v[158:159], v[158:159], v[148:149], v[144:145]
  v_cvt_pk_f16_f32 v84, v156, v157
  v_lshlrev_b32 v160, 16, v86
  v_and_b32 v161, 0xffff0000, v86
  v_pk_fma_f32 v[160:161], v[160:161], v[148:149], v[144:145]
  v_cvt_pk_f16_f32 v85, v158, v159
  v_lshlrev_b32 v162, 16, v87
  v_and_b32 v163, 0xffff0000, v87
  v_pk_fma_f32 v[162:163], v[162:163], v[148:149], v[144:145]
  v_cvt_pk_f16_f32 v86, v160, v161
  v_lshlrev_b32 v156, 16, v88
  v_and_b32 v157, 0xffff0000, v88
  v_pk_fma_f32 v[156:157], v[156:157], v[148:149], v[144:145]
  v_cvt_pk_f16_f32 v87, v162, v163
  v_lshlrev_b32 v158, 16, v89
  v_and_b32 v159, 0xffff0000, v89
  v_pk_fma_f32 v[158:159], v[158:159], v[148:149], v[144:145]
  v_cvt_pk_f16_f32 v88, v156, v157
  v_lshlrev_b32 v160, 16, v90
  v_and_b32 v161, 0xffff0000, v90
  v_pk_fma_f32 v[160:161], v[160:161], v[148:149], v[144:145]
  v_cvt_pk_f16_f32 v89, v158, v159
  v_lshlrev_b32 v162, 16, v91
  v_and_b32 v163, 0xffff0000, v91
  v_pk_fma_f32 v[162:163], v[162:163], v[148:149], v[144:145]
  v_cvt_pk_f16_f32 v90, v160, v161
  v_lshlrev_b32 v156, 16, v92
  v_and_b32 v157, 0xffff0000, v92
  v_pk_fma_f32 v[156:157], v[156:157], v[148:149], v[144:145]
  v_cvt_pk_f16_f32 v91, v162, v163
  v_lshlrev_b32 v158, 16, v93
  v_and_b32 v159, 0xffff0000, v93
  v_pk_fma_f32 v[158:159], v[158:159], v[148:149], v[144:145]
  v_cvt_pk_f16_f32 v92, v156, v157
  v_lshlrev_b32 v160, 16, v94
  v_and_b32 v161, 0xffff0000, v94
  v_pk_fma_f32 v[160:161], v[160:161], v[148:149], v[144:145]
  v_cvt_pk_f16_f32 v93, v158, v159
  v_lshlrev_b32 v162, 16, v95
  v_and_b32 v163, 0xffff0000, v95
  v_pk_fma_f32 v[162:163], v[162:163], v[148:149], v[144:145]
  v_cvt_pk_f16_f32 v94, v160, v161
  v_lshlrev_b32 v156, 16, v96
  v_and_b32 v157, 0xffff0000, v96
  v_pk_fma_f32 v[156:157], v[156:157], v[148:149], v[144:145]
  v_cvt_pk_f16_f32 v95, v162, v163
  v_lshlrev_b32 v158, 16, v97
  v_and_b32 v159, 0xffff0000, v97
  v_pk_fma_f32 v[158:159], v[158:159], v[148:149], v[144:145]
  v_cvt_pk_f16_f32 v96, v156, v157
  v_lshlrev_b32 v160, 16, v98
  v_and_b32 v161, 0xffff0000, v98
  v_pk_fma_f32 v[160:161], v[160:161], v[148:149], v[144:145]
  v_cvt_pk_f16_f32 v97, v158, v159
  v_lshlrev_b32 v162, 16, v99
  v_and_b32 v163, 0xffff0000, v99
  v_pk_fma_f32 v[162:163], v[162:163], v[148:149], v[144:145]
  v_cvt_pk_f16_f32 v98, v160, v161
  v_lshlrev_b32 v156, 16, v100
  v_and_b32 v157, 0xffff0000, v100
  v_pk_fma_f32 v[156:157], v[156:157], v[148:149], v[144:145]
  v_cvt_pk_f16_f32 v99, v162, v163
  v_lshlrev_b32 v158, 16, v101
  v_and_b32 v159, 0xffff0000, v101
  v_pk_fma_f32 v[158:159], v[158:159], v[148:149], v[144:145]
  v_cvt_pk_f16_f32 v100, v156, v157
  v_lshlrev_b32 v160, 16, v102
  v_and_b32 v161, 0xffff0000, v102
  v_pk_fma_f32 v[160:161], v[160:161], v[148:149], v[144:145]
  v_cvt_pk_f16_f32 v101, v158, v159
  v_lshlrev_b32 v162, 16, v103
  v_and_b32 v163, 0xffff0000, v103
  v_pk_fma_f32 v[162:163], v[162:163], v[148:149], v[144:145]
  v_cvt_pk_f16_f32 v102, v160, v161
  v_lshlrev_b32 v156, 16, v104
  v_and_b32 v157, 0xffff0000, v104
  v_pk_fma_f32 v[156:157], v[156:157], v[148:149], v[144:145]
  v_cvt_pk_f16_f32 v103, v162, v163
  v_lshlrev_b32 v158, 16, v105
  v_and_b32 v159, 0xffff0000, v105
  v_pk_fma_f32 v[158:159], v[158:159], v[148:149], v[144:145]
  v_cvt_pk_f16_f32 v104, v156, v157
  v_lshlrev_b32 v160, 16, v106
  v_and_b32 v161, 0xffff0000, v106
  v_pk_fma_f32 v[160:161], v[160:161], v[148:149], v[144:145]
  v_cvt_pk_f16_f32 v105, v158, v159
  v_lshlrev_b32 v162, 16, v107
  v_and_b32 v163, 0xffff0000, v107
  v_pk_fma_f32 v[162:163], v[162:163], v[148:149], v[144:145]
  v_cvt_pk_f16_f32 v106, v160, v161
  v_lshlrev_b32 v156, 16, v108
  v_and_b32 v157, 0xffff0000, v108
  v_pk_fma_f32 v[156:157], v[156:157], v[148:149], v[144:145]
  v_cvt_pk_f16_f32 v107, v162, v163
  v_lshlrev_b32 v158, 16, v109
  v_and_b32 v159, 0xffff0000, v109
  v_pk_fma_f32 v[158:159], v[158:159], v[148:149], v[144:145]
  v_cvt_pk_f16_f32 v108, v156, v157
  v_lshlrev_b32 v160, 16, v110
  v_and_b32 v161, 0xffff0000, v110
  v_pk_fma_f32 v[160:161], v[160:161], v[148:149], v[144:145]
  v_cvt_pk_f16_f32 v109, v158, v159
  v_lshlrev_b32 v162, 16, v111
  v_and_b32 v163, 0xffff0000, v111
  v_pk_fma_f32 v[162:163], v[162:163], v[148:149], v[144:145]
  v_cvt_pk_f16_f32 v110, v160, v161
  s_cmp_eq_u32 s28, 0
  s_cbranch_scc0 fr_np
  buffer_load_dword v4, v7, s[56:59], 0 offen offset:128 sc1
fr_np:
  v_lshlrev_b32 v156, 16, v112
  v_and_b32 v157, 0xffff0000, v112
  v_pk_fma_f32 v[156:157], v[156:157], v[148:149], v[144:145]
  v_cvt_pk_f16_f32 v111, v162, v163
  v_lshlrev_b32 v158, 16, v113
  v_and_b32 v159, 0xffff0000, v113
  v_pk_fma_f32 v[158:159], v[158:159], v[148:149], v[144:145]
  v_cvt_pk_f16_f32 v112, v156, v157
  v_lshlrev_b32 v160, 16, v114
  v_and_b32 v161, 0xffff0000, v114
  v_pk_fma_f32 v[160:161], v[160:161], v[148:149], v[144:145]
  v_cvt_pk_f16_f32 v113, v158, v159
  v_lshlrev_b32 v162, 16, v115
  v_and_b32 v163, 0xffff0000, v115
  v_pk_fma_f32 v[162:163], v[162:163], v[148:149], v[144:145]
  v_cvt_pk_f16_f32 v114, v160, v161
  v_lshlrev_b32 v156, 16, v116
  v_and_b32 v157, 0xffff0000, v116
  v_pk_fma_f32 v[156:157], v[156:157], v[148:149], v[144:145]
  v_cvt_pk_f16_f32 v115, v162, v163
  v_lshlrev_b32 v158, 16, v117
  v_and_b32 v159, 0xffff0000, v117
  v_pk_fma_f32 v[158:159], v[158:159], v[148:149], v[144:145]
  v_cvt_pk_f16_f32 v116, v156, v157
  v_lshlrev_b32 v160, 16, v118
  v_and_b32 v161, 0xffff0000, v118
  v_pk_fma_f32 v[160:161], v[160:161], v[148:149], v[144:145]
  v_cvt_pk_f16_f32 v117, v158, v159
  v_lshlrev_b32 v162, 16, v119
  v_and_b32 v163, 0xffff0000, v119
  v_pk_fma_f32 v[162:163], v[162:163], v[148:149], v[144:145]
  v_cvt_pk_f16_f32 v118, v160, v161
  v_lshlrev_b32 v156, 16, v120
  v_and_b32 v157, 0xffff0000, v120
  v_pk_fma_f32 v[156:157], v[156:157], v[148:149], v[144:145]
  v_cvt_pk_f16_f32 v119, v162, v163
  v_lshlrev_b32 v158, 16, v121
  v_and_b32 v159, 0xffff0000, v121
  v_pk_fma_f32 v[158:159], v[158:159], v[148:149], v[144:145]
  v_cvt_pk_f16_f32 v120, v156, v157
  v_lshlrev_b32 v160, 16, v122
  v_and_b32 v161, 0xffff0000, v122
  v_pk_fma_f32 v[160:161], v[160:161], v[148:149], v[144:145]
  v_cvt_pk_f16_f32 v121, v158, v159
  v_lshlrev_b32 v162, 16, v123
  v_and_b32 v163, 0xffff0000, v123
  v_pk_fma_f32 v[162:163], v[162:163], v[148:149], v[144:145]
  v_cvt_pk_f16_f32 v122, v160, v161
  v_lshlrev_b32 v156, 16, v124
  v_and_b32 v157, 0xffff0000, v124
  v_pk_fma_f32 v[156:157], v[156:157], v[148:149], v[144:145]
  v_cvt_pk_f16_f32 v123, v162, v163
  v_lshlrev_b32 v158, 16, v125
  v_and_b32 v159, 0xffff0000, v125
  v_pk_fma_f32 v[158:159], v[158:159], v[148:149], v[144:145]
  v_cvt_pk_f16_f32 v124, v156, v157
  v_lshlrev_b32 v160, 16, v126
  v_and_b32 v161, 0xffff0000, v126
  v_pk_fma_f32 v[160:161], v[160:161], v[148:149], v[144:145]
  v_cvt_pk_f16_f32 v125, v158, v159
  v_lshlrev_b32 v162, 16, v127
  v_and_b32 v163, 0xffff0000, v127
  v_pk_fma_f32 v[162:163], v[162:163], v[148:149], v[144:145]
  v_cvt_pk_f16_f32 v126, v160, v161
  v_lshlrev_b32 v156, 16, v128
  v_and_b32 v157, 0xffff0000, v128
  v_pk_fma_f32 v[156:157], v[156:157], v[148:149], v[144:145]
  v_cvt_pk_f16_f32 v127, v162, v163
  v_lshlrev_b32 v158, 16, v129
  v_and_b32 v159, 0xffff0000, v129
  v_pk_fma_f32 v[158:159], v[158:159], v[148:149], v[144:145]
  v_cvt_pk_f16_f32 v128, v156, v157
  v_lshlrev_b32 v160, 16, v130
  v_and_b32 v161, 0xffff0000, v130
  v_pk_fma_f32 v[160:161], v[160:161], v[148:149], v[144:145]
  v_cvt_pk_f16_f32 v129, v158, v159
  v_lshlrev_b32 v162, 16, v131
  v_and_b32 v163, 0xffff0000, v131
  v_pk_fma_f32 v[162:163], v[162:163], v[148:149], v[144:145]
  v_cvt_pk_f16_f32 v130, v160, v161
  v_lshlrev_b32 v156, 16, v132
  v_and_b32 v157, 0xffff0000, v132
  v_pk_fma_f32 v[156:157], v[156:157], v[148:149], v[144:145]
  v_cvt_pk_f16_f32 v131, v162, v163
  v_lshlrev_b32 v158, 16, v133
  v_and_b32 v159, 0xffff0000, v133
  v_pk_fma_f32 v[158:159], v[158:159], v[148:149], v[144:145]
  v_cvt_pk_f16_f32 v132, v156, v157
  v_lshlrev_b32 v160, 16, v134
  v_and_b32 v161, 0xffff0000, v134
  v_pk_fma_f32 v[160:161], v[160:161], v[148:149], v[144:145]
  v_cvt_pk_f16_f32 v133, v158, v159
  v_lshlrev_b32 v162, 16, v135
  v_and_b32 v163, 0xffff0000, v135
  v_pk_fma_f32 v[162:163], v[162:163], v[148:149], v[144:145]
  v_cvt_pk_f16_f32 v134, v160, v161
  v_lshlrev_b32 v156, 16, v136
  v_and_b32 v157, 0xffff0000, v136
  v_pk_fma_f32 v[156:157], v[156:157], v[148:149], v[144:145]
  v_cvt_pk_f16_f32 v135, v162, v163
  v_lshlrev_b32 v158, 16, v137
  v_and_b32 v159, 0xffff0000, v137
  v_pk_fma_f32 v[158:159], v[158:159], v[148:149], v[144:145]
  v_cvt_pk_f16_f32 v136, v156, v157
  v_lshlrev_b32 v160, 16, v138
  v_and_b32 v161, 0xffff0000, v138
  v_pk_fma_f32 v[160:161], v[160:161], v[148:149], v[144:145]
  v_cvt_pk_f16_f32 v137, v158, v159
  v_lshlrev_b32 v162, 16, v139
  v_and_b32 v163, 0xffff0000, v139
  v_pk_fma_f32 v[162:163], v[162:163], v[148:149], v[144:145]
  v_cvt_pk_f16_f32 v138, v160, v161
  v_lshlrev_b32 v156, 16, v140
  v_and_b32 v157, 0xffff0000, v140
  v_pk_fma_f32 v[156:157], v[156:157], v[148:149], v[144:145]
  v_cvt_pk_f16_f32 v139, v162, v163
  v_lshlrev_b32 v158, 16, v141
  v_and_b32 v159, 0xffff0000, v141
  v_pk_fma_f32 v[158:159], v[158:159], v[148:149], v[144:145]
  v_cvt_pk_f16_f32 v140, v156, v157
  v_lshlrev_b32 v160, 16, v142
  v_and_b32 v161, 0xffff0000, v142
  v_pk_fma_f32 v[160:161], v[160:161], v[148:149], v[144:145]
  v_cvt_pk_f16_f32 v141, v158, v159
  v_lshlrev_b32 v162, 16, v143
  v_and_b32 v163, 0xffff0000, v143
  v_pk_fma_f32 v[162:163], v[162:163], v[148:149], v[144:145]
  v_cvt_pk_f16_f32 v142, v160, v161
  v_cvt_pk_f16_f32 v143, v162, v163
  s_cmp_lt_u32 s28, 1
  s_cbranch_scc0 fr_m2
  s_mov_b32 s60, 0
  s_branch fr_pchk
fr_poll:
  s_sleep 4
  buffer_load_dword v4, v7, s[56:59], 0 offen offset:128 sc1
fr_pchk:
  s_waitcnt vmcnt(0)
  v_cmp_ne_u32 vcc, 1, v4
  s_cmp_eq_u64 vcc, 0
  s_cbranch_scc1 fr_pok
  s_add_u32 s60, s60, 1
  s_cmp_lt_u32 s60, 40000
  s_cbranch_scc1 fr_poll
fr_pok:
  s_lshl_b32 s37, s28, 10
  s_add_u32 m0, s37, 131072
  s_add_u32 s36, s36, s37
  buffer_load_dwordx4 v3, s[16:19], s36 offen sc1 lds
  buffer_load_dwordx4 v3, s[16:19], s36 offen offset:1024 sc1 lds
fr_m2:
  s_waitcnt vmcnt(0)
  s_barrier
  ds_read_b128 v[180:183], v14 offset:1024
  ds_read_b128 v[184:187], v14 offset:0
  ds_read_b128 v[144:147], v12 offset:0
  ds_read_b128 v[148:151], v13 offset:0
  ds_read_b128 v[152:155], v15 offset:0
  ds_read_b128 v[188:191], v14 offset:1056
  ds_read_b128 v[192:195], v14 offset:32
  ds_read_b128 v[156:159], v12 offset:1152
  ds_read_b128 v[160:163], v13 offset:1152
  ds_read_b128 v[164:167], v15 offset:1152
  s_waitcnt lgkmcnt(8)
  v_pk_fma_f16 v16, v16, v180, v184
  v_pk_fma_f16 v17, v17, v181, v185
  v_pk_fma_f16 v18, v18, v182, v186
  v_pk_fma_f16 v19, v19, v183, v187
  s_waitcnt lgkmcnt(5)
  s_nop 0
  v_mfma_f32_32x32x16_f16 v[204:219], v[144:147], v[16:19], 0
  ds_read_b128 v[196:199], v14 offset:1088
  ds_read_b128 v[200:203], v14 offset:64
  ds_read_b128 v[168:171], v12 offset:2304
  v_mfma_f32_32x32x16_f16 v[220:235], v[148:151], v[16:19], 0
  ds_read_b128 v[172:175], v13 offset:2304
  ds_read_b128 v[176:179], v15 offset:2304
  v_mfma_f32_32x32x16_f16 v[236:251], v[16:19], v[152:155], 0
  s_waitcnt lgkmcnt(8)
  v_pk_fma_f16 v20, v20, v188, v192
  v_pk_fma_f16 v21, v21, v189, v193
  v_pk_fma_f16 v22, v22, v190, v194
  v_pk_fma_f16 v23, v23, v191, v195
  s_waitcnt lgkmcnt(5)
  s_nop 0
  v_mfma_f32_32x32x16_f16 v[204:219], v[156:159], v[20:23], v[204:219]
  ds_read_b128 v[180:183], v14 offset:1120
  ds_read_b128 v[184:187], v14 offset:96
  ds_read_b128 v[144:147], v12 offset:3456
  v_mfma_f32_32x32x16_f16 v[220:235], v[160:163], v[20:23], v[220:235]
  ds_read_b128 v[148:151], v13 offset:3456
  ds_read_b128 v[152:155], v15 offset:3456
  v_mfma_f32_32x32x16_f16 v[236:251], v[20:23], v[164:167], v[236:251]
  s_waitcnt lgkmcnt(8)
  v_pk_fma_f16 v24, v24, v196, v200
  v_pk_fma_f16 v25, v25, v197, v201
  v_pk_fma_f16 v26, v26, v198, v202
  v_pk_fma_f16 v27, v27, v199, v203
  s_waitcnt lgkmcnt(5)
  s_nop 0
  v_mfma_f32_32x32x16_f16 v[204:219], v[168:171], v[24:27], v[204:219]
  ds_read_b128 v[188:191], v14 offset:1152
  ds_read_b128 v[192:195], v14 offset:128
  ds_read_b128 v[156:159], v12 offset:4608
  v_mfma_f32_32x32x16_f16 v[220:235], v[172:175], v[24:27], v[220:235]
  ds_read_b128 v[160:163], v13 offset:4608
  ds_read_b128 v[164:167], v15 offset:4608
  v_mfma_f32_32x32x16_f16 v[236:251], v[24:27], v[176:179], v[236:251]
  s_waitcnt lgkmcnt(8)
  v_pk_fma_f16 v28, v28, v180, v184
  v_pk_fma_f16 v29, v29, v181, v185
  v_pk_fma_f16 v30, v30, v182, v186
  v_pk_fma_f16 v31, v31, v183, v187
  s_waitcnt lgkmcnt(5)
  s_nop 0
  v_mfma_f32_32x32x16_f16 v[204:219], v[144:147], v[28:31], v[204:219]
  ds_read_b128 v[196:199], v14 offset:1184
  ds_read_b128 v[200:203], v14 offset:160
  ds_read_b128 v[168:171], v12 offset:5760
  v_mfma_f32_32x32x16_f16 v[220:235], v[148:151], v[28:31], v[220:235]
  ds_read_b128 v[172:175], v13 offset:5760
  ds_read_b128 v[176:179], v15 offset:5760
  v_mfma_f32_32x32x16_f16 v[236:251], v[28:31], v[152:155], v[236:251]
  s_waitcnt lgkmcnt(8)
  v_pk_fma_f16 v32, v32, v188, v192
  v_pk_fma_f16 v33, v33, v189, v193
  v_pk_fma_f16 v34, v34, v190, v194
  v_pk_fma_f16 v35, v35, v191, v195
  s_waitcnt lgkmcnt(5)
  s_nop 0
  v_mfma_f32_32x32x16_f16 v[204:219], v[156:159], v[32:35], v[204:219]
  ds_read_b128 v[180:183], v14 offset:1216
  ds_read_b128 v[184:187], v14 offset:192
  ds_read_b128 v[144:147], v12 offset:6912
  v_mfma_f32_32x32x16_f16 v[220:235], v[160:163], v[32:35], v[220:235]
  ds_read_b128 v[148:151], v13 offset:6912
  ds_read_b128 v[152:155], v15 offset:6912
  v_mfma_f32_32x32x16_f16 v[236:251], v[32:35], v[164:167], v[236:251]
  s_waitcnt lgkmcnt(8)
  v_pk_fma_f16 v36, v36, v196, v200
  v_pk_fma_f16 v37, v37, v197, v201
  v_pk_fma_f16 v38, v38, v198, v202
  v_pk_fma_f16 v39, v39, v199, v203
  s_waitcnt lgkmcnt(5)
  s_nop 0
  v_mfma_f32_32x32x16_f16 v[204:219], v[168:171], v[36:39], v[204:219]
  ds_read_b128 v[188:191], v14 offset:1248
  ds_read_b128 v[192:195], v14 offset:224
  ds_read_b128 v[156:159], v12 offset:8064
  v_mfma_f32_32x32x16_f16 v[220:235], v[172:175], v[36:39], v[220:235]
  ds_read_b128 v[160:163], v13 offset:8064
  ds_read_b128 v[164:167], v15 offset:8064
  v_mfma_f32_32x32x16_f16 v[236:251], v[36:39], v[176:179], v[236:251]
  s_waitcnt lgkmcnt(8)
  v_pk_fma_f16 v40, v40, v180, v184
  v_pk_fma_f16 v41, v41, v181, v185
  v_pk_fma_f16 v42, v42, v182, v186
  v_pk_fma_f16 v43, v43, v183, v187
  s_waitcnt lgkmcnt(5)
  s_nop 0
  v_mfma_f32_32x32x16_f16 v[204:219], v[144:147], v[40:43], v[204:219]
  ds_read_b128 v[196:199], v14 offset:1280
  ds_read_b128 v[200:203], v14 offset:256
  ds_read_b128 v[168:171], v12 offset:9216
  v_mfma_f32_32x32x16_f16 v[220:235], v[148:151], v[40:43], v[220:235]
  ds_read_b128 v[172:175], v13 offset:9216
  ds_read_b128 v[176:179], v15 offset:9216
  v_mfma_f32_32x32x16_f16 v[236:251], v[40:43], v[152:155], v[236:251]
  s_waitcnt lgkmcnt(8)
  v_pk_fma_f16 v44, v44, v188, v192
  v_pk_fma_f16 v45, v45, v189, v193
  v_pk_fma_f16 v46, v46, v190, v194
  v_pk_fma_f16 v47, v47, v191, v195
  s_waitcnt lgkmcnt(5)
  s_nop 0
  v_mfma_f32_32x32x16_f16 v[204:219], v[156:159], v[44:47], v[204:219]
  ds_read_b128 v[180:183], v14 offset:1312
  ds_read_b128 v[184:187], v14 offset:288
  ds_read_b128 v[144:147], v12 offset:10368
  v_mfma_f32_32x32x16_f16 v[220:235], v[160:163], v[44:47], v[220:235]
  ds_read_b128 v[148:151], v13 offset:10368
  ds_read_b128 v[152:155], v15 offset:10368
  v_mfma_f32_32x32x16_f16 v[236:251], v[44:47], v[164:167], v[236:251]
  s_waitcnt lgkmcnt(8)
  v_pk_fma_f16 v48, v48, v196, v200
  v_pk_fma_f16 v49, v49, v197, v201
  v_pk_fma_f16 v50, v50, v198, v202
  v_pk_fma_f16 v51, v51, v199, v203
  s_waitcnt lgkmcnt(5)
  s_nop 0
  v_mfma_f32_32x32x16_f16 v[204:219], v[168:171], v[48:51], v[204:219]
  ds_read_b128 v[188:191], v14 offset:1344
  ds_read_b128 v[192:195], v14 offset:320
  ds_read_b128 v[156:159], v12 offset:11520
  v_mfma_f32_32x32x16_f16 v[220:235], v[172:175], v[48:51], v[220:235]
  ds_read_b128 v[160:163], v13 offset:11520
  ds_read_b128 v[164:167], v15 offset:11520
  v_mfma_f32_32x32x16_f16 v[236:251], v[48:51], v[176:179], v[236:251]
  s_waitcnt lgkmcnt(8)
  v_pk_fma_f16 v52, v52, v180, v184
  v_pk_fma_f16 v53, v53, v181, v185
  v_pk_fma_f16 v54, v54, v182, v186
  v_pk_fma_f16 v55, v55, v183, v187
  s_waitcnt lgkmcnt(5)
  s_nop 0
  v_mfma_f32_32x32x16_f16 v[204:219], v[144:147], v[52:55], v[204:219]
  ds_read_b128 v[196:199], v14 offset:1376
  ds_read_b128 v[200:203], v14 offset:352
  ds_read_b128 v[168:171], v12 offset:12672
  v_mfma_f32_32x32x16_f16 v[220:235], v[148:151], v[52:55], v[220:235]
  ds_read_b128 v[172:175], v13 offset:12672
  ds_read_b128 v[176:179], v15 offset:12672
  v_mfma_f32_32x32x16_f16 v[236:251], v[52:55], v[152:155], v[236:251]
  s_waitcnt lgkmcnt(8)
  v_pk_fma_f16 v56, v56, v188, v192
  v_pk_fma_f16 v57, v57, v189, v193
  v_pk_fma_f16 v58, v58, v190, v194
  v_pk_fma_f16 v59, v59, v191, v195
  s_waitcnt lgkmcnt(5)
  s_nop 0
  v_mfma_f32_32x32x16_f16 v[204:219], v[156:159], v[56:59], v[204:219]
  ds_read_b128 v[180:183], v14 offset:1408
  ds_read_b128 v[184:187], v14 offset:384
  ds_read_b128 v[144:147], v12 offset:13824
  v_mfma_f32_32x32x16_f16 v[220:235], v[160:163], v[56:59], v[220:235]
  ds_read_b128 v[148:151], v13 offset:13824
  ds_read_b128 v[152:155], v15 offset:13824
  v_mfma_f32_32x32x16_f16 v[236:251], v[56:59], v[164:167], v[236:251]
  s_waitcnt lgkmcnt(8)
  v_pk_fma_f16 v60, v60, v196, v200
  v_pk_fma_f16 v61, v61, v197, v201
  v_pk_fma_f16 v62, v62, v198, v202
  v_pk_fma_f16 v63, v63, v199, v203
  s_waitcnt lgkmcnt(5)
  s_nop 0
  v_mfma_f32_32x32x16_f16 v[204:219], v[168:171], v[60:63], v[204:219]
  ds_read_b128 v[188:191], v14 offset:1440
  ds_read_b128 v[192:195], v14 offset:416
  ds_read_b128 v[156:159], v12 offset:14976
  v_mfma_f32_32x32x16_f16 v[220:235], v[172:175], v[60:63], v[220:235]
  ds_read_b128 v[160:163], v13 offset:14976
  ds_read_b128 v[164:167], v15 offset:14976
  v_mfma_f32_32x32x16_f16 v[236:251], v[60:63], v[176:179], v[236:251]
  s_waitcnt lgkmcnt(8)
  v_pk_fma_f16 v64, v64, v180, v184
  v_pk_fma_f16 v65, v65, v181, v185
  v_pk_fma_f16 v66, v66, v182, v186
  v_pk_fma_f16 v67, v67, v183, v187
  s_waitcnt lgkmcnt(5)
  s_nop 0
  v_mfma_f32_32x32x16_f16 v[204:219], v[144:147], v[64:67], v[204:219]
  ds_read_b128 v[196:199], v14 offset:1472
  ds_read_b128 v[200:203], v14 offset:448
  ds_read_b128 v[168:171], v12 offset:16128
  v_mfma_f32_32x32x16_f16 v[220:235], v[148:151], v[64:67], v[220:235]
  ds_read_b128 v[172:175], v13 offset:16128
  ds_read_b128 v[176:179], v15 offset:16128
  v_mfma_f32_32x32x16_f16 v[236:251], v[64:67], v[152:155], v[236:251]
  s_waitcnt lgkmcnt(8)
  v_pk_fma_f16 v68, v68, v188, v192
  v_pk_fma_f16 v69, v69, v189, v193
  v_pk_fma_f16 v70, v70, v190, v194
  v_pk_fma_f16 v71, v71, v191, v195
  s_waitcnt lgkmcnt(5)
  s_nop 0
  v_mfma_f32_32x32x16_f16 v[204:219], v[156:159], v[68:71], v[204:219]
  ds_read_b128 v[180:183], v14 offset:1504
  ds_read_b128 v[184:187], v14 offset:480
  ds_read_b128 v[144:147], v12 offset:17280
  v_mfma_f32_32x32x16_f16 v[220:235], v[160:163], v[68:71], v[220:235]
  ds_read_b128 v[148:151], v13 offset:17280
  ds_read_b128 v[152:155], v15 offset:17280
  v_mfma_f32_32x32x16_f16 v[236:251], v[68:71], v[164:167], v[236:251]
  s_waitcnt lgkmcnt(8)
  v_pk_fma_f16 v72, v72, v196, v200
  v_pk_fma_f16 v73, v73, v197, v201
  v_pk_fma_f16 v74, v74, v198, v202
  v_pk_fma_f16 v75, v75, v199, v203
  s_waitcnt lgkmcnt(5)
  s_nop 0
  v_mfma_f32_32x32x16_f16 v[204:219], v[168:171], v[72:75], v[204:219]
  ds_read_b128 v[188:191], v14 offset:1536
  ds_read_b128 v[192:195], v14 offset:512
  ds_read_b128 v[156:159], v12 offset:18432
  v_mfma_f32_32x32x16_f16 v[220:235], v[172:175], v[72:75], v[220:235]
  ds_read_b128 v[160:163], v13 offset:18432
  ds_read_b128 v[164:167], v15 offset:18432
  v_mfma_f32_32x32x16_f16 v[236:251], v[72:75], v[176:179], v[236:251]
  s_waitcnt lgkmcnt(8)
  v_pk_fma_f16 v76, v76, v180, v184
  v_pk_fma_f16 v77, v77, v181, v185
  v_pk_fma_f16 v78, v78, v182, v186
  v_pk_fma_f16 v79, v79, v183, v187
  s_waitcnt lgkmcnt(5)
  s_nop 0
  v_mfma_f32_32x32x16_f16 v[204:219], v[144:147], v[76:79], v[204:219]
  ds_read_b128 v[196:199], v14 offset:1568
  ds_read_b128 v[200:203], v14 offset:544
  ds_read_b128 v[168:171], v12 offset:19584
  v_mfma_f32_32x32x16_f16 v[220:235], v[148:151], v[76:79], v[220:235]
  ds_read_b128 v[172:175], v13 offset:19584
  ds_read_b128 v[176:179], v15 offset:19584
  v_mfma_f32_32x32x16_f16 v[236:251], v[76:79], v[152:155], v[236:251]
  s_waitcnt lgkmcnt(8)
  v_pk_fma_f16 v80, v80, v188, v192
  v_pk_fma_f16 v81, v81, v189, v193
  v_pk_fma_f16 v82, v82, v190, v194
  v_pk_fma_f16 v83, v83, v191, v195
  s_waitcnt lgkmcnt(5)
  s_nop 0
  v_mfma_f32_32x32x16_f16 v[204:219], v[156:159], v[80:83], v[204:219]
  ds_read_b128 v[180:183], v14 offset:1600
  ds_read_b128 v[184:187], v14 offset:576
  ds_read_b128 v[144:147], v12 offset:20736
  v_mfma_f32_32x32x16_f16 v[220:235], v[160:163], v[80:83], v[220:235]
  ds_read_b128 v[148:151], v13 offset:20736
  ds_read_b128 v[152:155], v15 offset:20736
  v_mfma_f32_32x32x16_f16 v[236:251], v[80:83], v[164:167], v[236:251]
  s_waitcnt lgkmcnt(8)
  v_pk_fma_f16 v84, v84, v196, v200
  v_pk_fma_f16 v85, v85, v197, v201
  v_pk_fma_f16 v86, v86, v198, v202
  v_pk_fma_f16 v87, v87, v199, v203
  s_waitcnt lgkmcnt(5)
  s_nop 0
  v_mfma_f32_32x32x16_f16 v[204:219], v[168:171], v[84:87], v[204:219]
  ds_read_b128 v[188:191], v14 offset:1632
  ds_read_b128 v[192:195], v14 offset:608
  ds_read_b128 v[156:159], v12 offset:21888
  v_mfma_f32_32x32x16_f16 v[220:235], v[172:175], v[84:87], v[220:235]
  ds_read_b128 v[160:163], v13 offset:21888
  ds_read_b128 v[164:167], v15 offset:21888
  v_mfma_f32_32x32x16_f16 v[236:251], v[84:87], v[176:179], v[236:251]
  s_waitcnt lgkmcnt(8)
  v_pk_fma_f16 v88, v88, v180, v184
  v_pk_fma_f16 v89, v89, v181, v185
  v_pk_fma_f16 v90, v90, v182, v186
  v_pk_fma_f16 v91, v91, v183, v187
  s_waitcnt lgkmcnt(5)
  s_nop 0
  v_mfma_f32_32x32x16_f16 v[204:219], v[144:147], v[88:91], v[204:219]
  ds_read_b128 v[196:199], v14 offset:1664
  ds_read_b128 v[200:203], v14 offset:640
  ds_read_b128 v[168:171], v12 offset:23040
  v_mfma_f32_32x32x16_f16 v[220:235], v[148:151], v[88:91], v[220:235]
  ds_read_b128 v[172:175], v13 offset:23040
  ds_read_b128 v[176:179], v15 offset:23040
  v_mfma_f32_32x32x16_f16 v[236:251], v[88:91], v[152:155], v[236:251]
  s_waitcnt lgkmcnt(8)
  v_pk_fma_f16 v92, v92, v188, v192
  v_pk_fma_f16 v93, v93, v189, v193
  v_pk_fma_f16 v94, v94, v190, v194
  v_pk_fma_f16 v95, v95, v191, v195
  s_waitcnt lgkmcnt(5)
  s_nop 0
  v_mfma_f32_32x32x16_f16 v[204:219], v[156:159], v[92:95], v[204:219]
  ds_read_b128 v[180:183], v14 offset:1696
  ds_read_b128 v[184:187], v14 offset:672
  ds_read_b128 v[144:147], v12 offset:24192
  v_mfma_f32_32x32x16_f16 v[220:235], v[160:163], v[92:95], v[220:235]
  ds_read_b128 v[148:151], v13 offset:24192
  ds_read_b128 v[152:155], v15 offset:24192
  v_mfma_f32_32x32x16_f16 v[236:251], v[92:95], v[164:167], v[236:251]
  s_waitcnt lgkmcnt(8)
  v_pk_fma_f16 v96, v96, v196, v200
  v_pk_fma_f16 v97, v97, v197, v201
  v_pk_fma_f16 v98, v98, v198, v202
  v_pk_fma_f16 v99, v99, v199, v203
  s_waitcnt lgkmcnt(5)
  s_nop 0
  v_mfma_f32_32x32x16_f16 v[204:219], v[168:171], v[96:99], v[204:219]
  ds_read_b128 v[188:191], v14 offset:1728
  ds_read_b128 v[192:195], v14 offset:704
  ds_read_b128 v[156:159], v12 offset:25344
  v_mfma_f32_32x32x16_f16 v[220:235], v[172:175], v[96:99], v[220:235]
  ds_read_b128 v[160:163], v13 offset:25344
  ds_read_b128 v[164:167], v15 offset:25344
  v_mfma_f32_32x32x16_f16 v[236:251], v[96:99], v[176:179], v[236:251]
  s_waitcnt lgkmcnt(8)
  v_pk_fma_f16 v100, v100, v180, v184
  v_pk_fma_f16 v101, v101, v181, v185
  v_pk_fma_f16 v102, v102, v182, v186
  v_pk_fma_f16 v103, v103, v183, v187
  s_waitcnt lgkmcnt(5)
  s_nop 0
  v_mfma_f32_32x32x16_f16 v[204:219], v[144:147], v[100:103], v[204:219]
  ds_read_b128 v[196:199], v14 offset:1760
  ds_read_b128 v[200:203], v14 offset:736
  ds_read_b128 v[168:171], v12 offset:26496
  v_mfma_f32_32x32x16_f16 v[220:235], v[148:151], v[100:103], v[220:235]
  ds_read_b128 v[172:175], v13 offset:26496
  ds_read_b128 v[176:179], v15 offset:26496
  v_mfma_f32_32x32x16_f16 v[236:251], v[100:103], v[152:155], v[236:251]
  s_waitcnt lgkmcnt(8)
  v_pk_fma_f16 v104, v104, v188, v192
  v_pk_fma_f16 v105, v105, v189, v193
  v_pk_fma_f16 v106, v106, v190, v194
  v_pk_fma_f16 v107, v107, v191, v195
  s_waitcnt lgkmcnt(5)
  s_nop 0
  v_mfma_f32_32x32x16_f16 v[204:219], v[156:159], v[104:107], v[204:219]
  ds_read_b128 v[180:183], v14 offset:1792
  ds_read_b128 v[184:187], v14 offset:768
  ds_read_b128 v[144:147], v12 offset:27648
  v_mfma_f32_32x32x16_f16 v[220:235], v[160:163], v[104:107], v[220:235]
  ds_read_b128 v[148:151], v13 offset:27648
  ds_read_b128 v[152:155], v15 offset:27648
  v_mfma_f32_32x32x16_f16 v[236:251], v[104:107], v[164:167], v[236:251]
  s_waitcnt lgkmcnt(8)
  v_pk_fma_f16 v108, v108, v196, v200
  v_pk_fma_f16 v109, v109, v197, v201
  v_pk_fma_f16 v110, v110, v198, v202
  v_pk_fma_f16 v111, v111, v199, v203
  s_waitcnt lgkmcnt(5)
  s_nop 0
  v_mfma_f32_32x32x16_f16 v[204:219], v[168:171], v[108:111], v[204:219]
  ds_read_b128 v[188:191], v14 offset:1824
  ds_read_b128 v[192:195], v14 offset:800
  ds_read_b128 v[156:159], v12 offset:28800
  v_mfma_f32_32x32x16_f16 v[220:235], v[172:175], v[108:111], v[220:235]
  ds_read_b128 v[160:163], v13 offset:28800
  ds_read_b128 v[164:167], v15 offset:28800
  v_mfma_f32_32x32x16_f16 v[236:251], v[108:111], v[176:179], v[236:251]
  s_waitcnt lgkmcnt(8)
  v_pk_fma_f16 v112, v112, v180, v184
  v_pk_fma_f16 v113, v113, v181, v185
  v_pk_fma_f16 v114, v114, v182, v186
  v_pk_fma_f16 v115, v115, v183, v187
  s_waitcnt lgkmcnt(5)
  s_nop 0
  v_mfma_f32_32x32x16_f16 v[204:219], v[144:147], v[112:115], v[204:219]
  ds_read_b128 v[196:199], v14 offset:1856
  ds_read_b128 v[200:203], v14 offset:832
  ds_read_b128 v[168:171], v12 offset:29952
  v_mfma_f32_32x32x16_f16 v[220:235], v[148:151], v[112:115], v[220:235]
  ds_read_b128 v[172:175], v13 offset:29952
  ds_read_b128 v[176:179], v15 offset:29952
  v_mfma_f32_32x32x16_f16 v[236:251], v[112:115], v[152:155], v[236:251]
  s_waitcnt lgkmcnt(8)
  v_pk_fma_f16 v116, v116, v188, v192
  v_pk_fma_f16 v117, v117, v189, v193
  v_pk_fma_f16 v118, v118, v190, v194
  v_pk_fma_f16 v119, v119, v191, v195
  s_waitcnt lgkmcnt(5)
  s_nop 0
  v_mfma_f32_32x32x16_f16 v[204:219], v[156:159], v[116:119], v[204:219]
  ds_read_b128 v[180:183], v14 offset:1888
  ds_read_b128 v[184:187], v14 offset:864
  ds_read_b128 v[144:147], v12 offset:31104
  v_mfma_f32_32x32x16_f16 v[220:235], v[160:163], v[116:119], v[220:235]
  ds_read_b128 v[148:151], v13 offset:31104
  ds_read_b128 v[152:155], v15 offset:31104
  v_mfma_f32_32x32x16_f16 v[236:251], v[116:119], v[164:167], v[236:251]
  s_waitcnt lgkmcnt(8)
  v_pk_fma_f16 v120, v120, v196, v200
  v_pk_fma_f16 v121, v121, v197, v201
  v_pk_fma_f16 v122, v122, v198, v202
  v_pk_fma_f16 v123, v123, v199, v203
  s_waitcnt lgkmcnt(5)
  s_nop 0
  v_mfma_f32_32x32x16_f16 v[204:219], v[168:171], v[120:123], v[204:219]
  ds_read_b128 v[188:191], v14 offset:1920
  ds_read_b128 v[192:195], v14 offset:896
  ds_read_b128 v[156:159], v12 offset:32256
  v_mfma_f32_32x32x16_f16 v[220:235], v[172:175], v[120:123], v[220:235]
  ds_read_b128 v[160:163], v13 offset:32256
  ds_read_b128 v[164:167], v15 offset:32256
  v_mfma_f32_32x32x16_f16 v[236:251], v[120:123], v[176:179], v[236:251]
  s_waitcnt lgkmcnt(8)
  v_pk_fma_f16 v124, v124, v180, v184
  v_pk_fma_f16 v125, v125, v181, v185
  v_pk_fma_f16 v126, v126, v182, v186
  v_pk_fma_f16 v127, v127, v183, v187
  s_waitcnt lgkmcnt(5)
  s_nop 0
  v_mfma_f32_32x32x16_f16 v[204:219], v[144:147], v[124:127], v[204:219]
  ds_read_b128 v[196:199], v14 offset:1952
  ds_read_b128 v[200:203], v14 offset:928
  ds_read_b128 v[168:171], v12 offset:33408
  v_mfma_f32_32x32x16_f16 v[220:235], v[148:151], v[124:127], v[220:235]
  ds_read_b128 v[172:175], v13 offset:33408
  ds_read_b128 v[176:179], v15 offset:33408
  v_mfma_f32_32x32x16_f16 v[236:251], v[124:127], v[152:155], v[236:251]
  s_waitcnt lgkmcnt(8)
  v_pk_fma_f16 v128, v128, v188, v192
  v_pk_fma_f16 v129, v129, v189, v193
  v_pk_fma_f16 v130, v130, v190, v194
  v_pk_fma_f16 v131, v131, v191, v195
  s_waitcnt lgkmcnt(5)
  s_nop 0
  v_mfma_f32_32x32x16_f16 v[204:219], v[156:159], v[128:131], v[204:219]
  ds_read_b128 v[180:183], v14 offset:1984
  ds_read_b128 v[184:187], v14 offset:960
  ds_read_b128 v[144:147], v12 offset:34560
  v_mfma_f32_32x32x16_f16 v[220:235], v[160:163], v[128:131], v[220:235]
  ds_read_b128 v[148:151], v13 offset:34560
  ds_read_b128 v[152:155], v15 offset:34560
  v_mfma_f32_32x32x16_f16 v[236:251], v[128:131], v[164:167], v[236:251]
  s_waitcnt lgkmcnt(8)
  v_pk_fma_f16 v132, v132, v196, v200
  v_pk_fma_f16 v133, v133, v197, v201
  v_pk_fma_f16 v134, v134, v198, v202
  v_pk_fma_f16 v135, v135, v199, v203
  s_waitcnt lgkmcnt(5)
  s_nop 0
  v_mfma_f32_32x32x16_f16 v[204:219], v[168:171], v[132:135], v[204:219]
  ds_read_b128 v[188:191], v14 offset:2016
  ds_read_b128 v[192:195], v14 offset:992
  ds_read_b128 v[156:159], v12 offset:35712
  v_mfma_f32_32x32x16_f16 v[220:235], v[172:175], v[132:135], v[220:235]
  ds_read_b128 v[160:163], v13 offset:35712
  ds_read_b128 v[164:167], v15 offset:35712
  v_mfma_f32_32x32x16_f16 v[236:251], v[132:135], v[176:179], v[236:251]
  s_waitcnt lgkmcnt(8)
  v_pk_fma_f16 v136, v136, v180, v184
  v_pk_fma_f16 v137, v137, v181, v185
  v_pk_fma_f16 v138, v138, v182, v186
  v_pk_fma_f16 v139, v139, v183, v187
  s_waitcnt lgkmcnt(5)
  s_nop 0
  v_mfma_f32_32x32x16_f16 v[204:219], v[144:147], v[136:139], v[204:219]
  v_mfma_f32_32x32x16_f16 v[220:235], v[148:151], v[136:139], v[220:235]
  v_mfma_f32_32x32x16_f16 v[236:251], v[136:139], v[152:155], v[236:251]
  s_waitcnt lgkmcnt(3)
  v_pk_fma_f16 v140, v140, v188, v192
  v_pk_fma_f16 v141, v141, v189, v193
  v_pk_fma_f16 v142, v142, v190, v194
  v_pk_fma_f16 v143, v143, v191, v195
  s_waitcnt lgkmcnt(0)
  s_nop 0
  v_mfma_f32_32x32x16_f16 v[204:219], v[156:159], v[140:143], v[204:219]
  v_mfma_f32_32x32x16_f16 v[220:235], v[160:163], v[140:143], v[220:235]
  v_mfma_f32_32x32x16_f16 v[236:251], v[140:143], v[164:167], v[236:251]
  s_lshl_b32 s36, s27, 17
  s_lshl_b32 s37, s32, 10
  s_add_u32 s36, s36, s37
  s_add_u32 s36, s36, 3145728
  s_add_u32 s37, s36, 65536
  s_add_u32 s38, s36, 0x200000
  s_add_u32 s39, s37, 0x200000
  v_lshlrev_b32 v15, 16, v9
  v_lshl_add_u32 v15, v8, 8, v15
  v_and_b32 v11, 15, v1
  v_lshl_add_u32 v15, v11, 4, v15
  s_add_u32 s40, s36, 0x400000
  s_nop 4
  v_mul_f32 v204, 0.36067376022224085, v204
  v_mul_f32 v205, 0.36067376022224085, v205
  v_mul_f32 v206, 0.36067376022224085, v206
  v_mul_f32 v207, 0.36067376022224085, v207
  v_mul_f32 v208, 0.36067376022224085, v208
  v_mul_f32 v209, 0.36067376022224085, v209
  v_mul_f32 v210, 0.36067376022224085, v210
  v_mul_f32 v211, 0.36067376022224085, v211
  v_mul_f32 v212, 0.36067376022224085, v212
  v_mul_f32 v213, 0.36067376022224085, v213
  v_mul_f32 v214, 0.36067376022224085, v214
  v_mul_f32 v215, 0.36067376022224085, v215
  v_mul_f32 v216, 0.36067376022224085, v216
  v_mul_f32 v217, 0.36067376022224085, v217
  v_mul_f32 v218, 0.36067376022224085, v218
  v_mul_f32 v219, 0.36067376022224085, v219
  v_cvt_pk_bf16_f32 v16, v204, v205
  v_cvt_pk_bf16_f32 v17, v206, v207
  v_cvt_pk_bf16_f32 v18, v208, v209
  v_cvt_pk_bf16_f32 v19, v210, v211
  v_cvt_pk_bf16_f32 v20, v212, v213
  v_cvt_pk_bf16_f32 v21, v214, v215
  v_cvt_pk_bf16_f32 v22, v216, v217
  v_cvt_pk_bf16_f32 v23, v218, v219
  buffer_store_dwordx4 v[16:19], v3, s[16:19], s36 offen
  buffer_store_dwordx4 v[20:23], v3, s[16:19], s37 offen
  v_cvt_pk_bf16_f32 v24, v220, v221
  v_cvt_pk_bf16_f32 v25, v222, v223
  v_cvt_pk_bf16_f32 v26, v224, v225
  v_cvt_pk_bf16_f32 v27, v226, v227
  v_cvt_pk_bf16_f32 v28, v228, v229
  v_cvt_pk_bf16_f32 v29, v230, v231
  v_cvt_pk_bf16_f32 v30, v232, v233
  v_cvt_pk_bf16_f32 v31, v234, v235
  buffer_store_dwordx4 v[24:27], v3, s[16:19], s38 offen
  buffer_store_dwordx4 v[28:31], v3, s[16:19], s39 offen
  v_cvt_pk_bf16_f32 v32, v236, v237
  v_cvt_pk_bf16_f32 v33, v238, v239
  v_cvt_pk_bf16_f32 v34, v240, v241
  v_cvt_pk_bf16_f32 v35, v242, v243
  v_cvt_pk_bf16_f32 v36, v244, v245
  v_cvt_pk_bf16_f32 v37, v246, v247
  v_cvt_pk_bf16_f32 v38, v248, v249
  v_cvt_pk_bf16_f32 v39, v250, v251
  buffer_store_dwordx4 v[32:35], v15, s[16:19], s40 offen
  buffer_store_dwordx4 v[36:39], v15, s[16:19], s40 offen offset:512
fr_end:
  s_endpgm
fr_h1:
  s_setprio 2
  v_lshrrev_b32 v8, 4, v1
  v_lshlrev_b32 v8, 7, v8
  v_lshl_add_u32 v8, v16, 5, v8
  s_lshl_b32 s34, s31, 9
  s_add_u32 s34, s34, 133120
  v_add_u32 v8, s34, v8
  v_lshrrev_b32 v9, 5, v1
  v_and_b32 v10, 31, v1
  v_lshlrev_b32 v11, 10, v9
  v_lshl_add_u32 v11, v10, 2, v11
  v_add_u32 v11, 133120, v11
  v_mov_b32 v4, 1
  s_cmp_lt_u32 s39, 12
  s_cbranch_scc0 fr_ng
  s_waitcnt vmcnt(8)
  v_lshlrev_b32 v24, 16, v20
  v_and_b32 v25, 0xffff0000, v20
  v_lshlrev_b32 v26, 16, v21
  v_and_b32 v27, 0xffff0000, v21
  v_lshlrev_b32 v28, 16, v22
  v_and_b32 v29, 0xffff0000, v22
  v_lshlrev_b32 v30, 16, v23
  v_and_b32 v31, 0xffff0000, v23
  v_mul_f32 v32, -1.4426950408889634, v24
  v_mul_f32 v33, -1.4426950408889634, v25
  v_mul_f32 v34, -1.4426950408889634, v26
  v_mul_f32 v35, -1.4426950408889634, v27
  v_mul_f32 v36, -1.4426950408889634, v28
  v_mul_f32 v37, -1.4426950408889634, v29
  v_mul_f32 v38, -1.4426950408889634, v30
  v_mul_f32 v39, -1.4426950408889634, v31
  v_exp_f32 v32, v32
  v_exp_f32 v33, v33
  v_exp_f32 v34, v34
  v_exp_f32 v35, v35
  v_exp_f32 v36, v36
  v_exp_f32 v37, v37
  v_exp_f32 v38, v38
  v_exp_f32 v39, v39
  v_add_f32 v32, 1.0, v32
  v_add_f32 v33, 1.0, v33
  v_add_f32 v34, 1.0, v34
  v_add_f32 v35, 1.0, v35
  v_add_f32 v36, 1.0, v36
  v_add_f32 v37, 1.0, v37
  v_add_f32 v38, 1.0, v38
  v_add_f32 v39, 1.0, v39
  v_rcp_f32 v32, v32
  v_rcp_f32 v33, v33
  v_rcp_f32 v34, v34
  v_rcp_f32 v35, v35
  v_rcp_f32 v36, v36
  v_rcp_f32 v37, v37
  v_rcp_f32 v38, v38
  v_rcp_f32 v39, v39
  v_mul_f32 v24, v24, v32
  v_mul_f32 v25, v25, v33
  v_mul_f32 v26, v26, v34
  v_mul_f32 v27, v27, v35
  v_mul_f32 v28, v28, v36
  v_mul_f32 v29, v29, v37
  v_mul_f32 v30, v30, v38
  v_mul_f32 v31, v31, v39
  v_cvt_pk_bf16_f32 v24, v24, v24
  v_cvt_pk_bf16_f32 v25, v25, v25
  v_cvt_pk_bf16_f32 v26, v26, v26
  v_cvt_pk_bf16_f32 v27, v27, v27
  v_cvt_pk_bf16_f32 v28, v28, v28
  v_cvt_pk_bf16_f32 v29, v29, v29
  v_cvt_pk_bf16_f32 v30, v30, v30
  v_cvt_pk_bf16_f32 v31, v31, v31
  v_lshlrev_b32 v24, 16, v24
  v_lshlrev_b32 v25, 16, v25
  v_lshlrev_b32 v26, 16, v26
  v_lshlrev_b32 v27, 16, v27
  v_lshlrev_b32 v28, 16, v28
  v_lshlrev_b32 v29, 16, v29
  v_lshlrev_b32 v30, 16, v30
  v_lshlrev_b32 v31, 16, v31
  v_mov_b32 v32, 0
  v_mov_b32 v33, 0
  v_mov_b32 v34, 0
  v_mov_b32 v35, 0
  v_mov_b32 v36, 0
  v_mov_b32 v37, 0
  v_mov_b32 v38, 0
  v_mov_b32 v39, 0
  s_waitcnt vmcnt(7)
  v_lshlrev_b32 v40, 16, v44
  v_and_b32 v41, 0xffff0000, v44
  v_fmac_f32 v32, v40, v24
  v_fmac_f32 v33, v41, v24
  v_lshlrev_b32 v42, 16, v45
  v_and_b32 v43, 0xffff0000, v45
  v_fmac_f32 v34, v42, v24
  v_fmac_f32 v35, v43, v24
  v_lshlrev_b32 v40, 16, v46
  v_and_b32 v41, 0xffff0000, v46
  v_fmac_f32 v36, v40, v24
  v_fmac_f32 v37, v41, v24
  v_lshlrev_b32 v42, 16, v47
  v_and_b32 v43, 0xffff0000, v47
  v_fmac_f32 v38, v42, v24
  v_fmac_f32 v39, v43, v24
  s_waitcnt vmcnt(6)
  v_lshlrev_b32 v40, 16, v48
  v_and_b32 v41, 0xffff0000, v48
  v_fmac_f32 v32, v40, v25
  v_fmac_f32 v33, v41, v25
  v_lshlrev_b32 v42, 16, v49
  v_and_b32 v43, 0xffff0000, v49
  v_fmac_f32 v34, v42, v25
  v_fmac_f32 v35, v43, v25
  v_lshlrev_b32 v40, 16, v50
  v_and_b32 v41, 0xffff0000, v50
  v_fmac_f32 v36, v40, v25
  v_fmac_f32 v37, v41, v25
  v_lshlrev_b32 v42, 16, v51
  v_and_b32 v43, 0xffff0000, v51
  v_fmac_f32 v38, v42, v25
  v_fmac_f32 v39, v43, v25
  s_waitcnt vmcnt(5)
  v_lshlrev_b32 v40, 16, v52
  v_and_b32 v41, 0xffff0000, v52
  v_fmac_f32 v32, v40, v26
  v_fmac_f32 v33, v41, v26
  v_lshlrev_b32 v42, 16, v53
  v_and_b32 v43, 0xffff0000, v53
  v_fmac_f32 v34, v42, v26
  v_fmac_f32 v35, v43, v26
  v_lshlrev_b32 v40, 16, v54
  v_and_b32 v41, 0xffff0000, v54
  v_fmac_f32 v36, v40, v26
  v_fmac_f32 v37, v41, v26
  v_lshlrev_b32 v42, 16, v55
  v_and_b32 v43, 0xffff0000, v55
  v_fmac_f32 v38, v42, v26
  v_fmac_f32 v39, v43, v26
  s_waitcnt vmcnt(4)
  v_lshlrev_b32 v40, 16, v56
  v_and_b32 v41, 0xffff0000, v56
  v_fmac_f32 v32, v40, v27
  v_fmac_f32 v33, v41, v27
  v_lshlrev_b32 v42, 16, v57
  v_and_b32 v43, 0xffff0000, v57
  v_fmac_f32 v34, v42, v27
  v_fmac_f32 v35, v43, v27
  v_lshlrev_b32 v40, 16, v58
  v_and_b32 v41, 0xffff0000, v58
  v_fmac_f32 v36, v40, v27
  v_fmac_f32 v37, v41, v27
  v_lshlrev_b32 v42, 16, v59
  v_and_b32 v43, 0xffff0000, v59
  v_fmac_f32 v38, v42, v27
  v_fmac_f32 v39, v43, v27
  s_waitcnt vmcnt(3)
  v_lshlrev_b32 v40, 16, v60
  v_and_b32 v41, 0xffff0000, v60
  v_fmac_f32 v32, v40, v28
  v_fmac_f32 v33, v41, v28
  v_lshlrev_b32 v42, 16, v61
  v_and_b32 v43, 0xffff0000, v61
  v_fmac_f32 v34, v42, v28
  v_fmac_f32 v35, v43, v28
  v_lshlrev_b32 v40, 16, v62
  v_and_b32 v41, 0xffff0000, v62
  v_fmac_f32 v36, v40, v28
  v_fmac_f32 v37, v41, v28
  v_lshlrev_b32 v42, 16, v63
  v_and_b32 v43, 0xffff0000, v63
  v_fmac_f32 v38, v42, v28
  v_fmac_f32 v39, v43, v28
  s_waitcnt vmcnt(2)
  v_lshlrev_b32 v40, 16, v64
  v_and_b32 v41, 0xffff0000, v64
  v_fmac_f32 v32, v40, v29
  v_fmac_f32 v33, v41, v29
  v_lshlrev_b32 v42, 16, v65
  v_and_b32 v43, 0xffff0000, v65
  v_fmac_f32 v34, v42, v29
  v_fmac_f32 v35, v43, v29
  v_lshlrev_b32 v40, 16, v66
  v_and_b32 v41, 0xffff0000, v66
  v_fmac_f32 v36, v40, v29
  v_fmac_f32 v37, v41, v29
  v_lshlrev_b32 v42, 16, v67
  v_and_b32 v43, 0xffff0000, v67
  v_fmac_f32 v38, v42, v29
  v_fmac_f32 v39, v43, v29
  s_waitcnt vmcnt(1)
  v_lshlrev_b32 v40, 16, v68
  v_and_b32 v41, 0xffff0000, v68
  v_fmac_f32 v32, v40, v30
  v_fmac_f32 v33, v41, v30
  v_lshlrev_b32 v42, 16, v69
  v_and_b32 v43, 0xffff0000, v69
  v_fmac_f32 v34, v42, v30
  v_fmac_f32 v35, v43, v30
  v_lshlrev_b32 v40, 16, v70
  v_and_b32 v41, 0xffff0000, v70
  v_fmac_f32 v36, v40, v30
  v_fmac_f32 v37, v41, v30
  v_lshlrev_b32 v42, 16, v71
  v_and_b32 v43, 0xffff0000, v71
  v_fmac_f32 v38, v42, v30
  v_fmac_f32 v39, v43, v30
  s_waitcnt vmcnt(0)
  v_lshlrev_b32 v40, 16, v72
  v_and_b32 v41, 0xffff0000, v72
  v_fmac_f32 v32, v40, v31
  v_fmac_f32 v33, v41, v31
  v_lshlrev_b32 v42, 16, v73
  v_and_b32 v43, 0xffff0000, v73
  v_fmac_f32 v34, v42, v31
  v_fmac_f32 v35, v43, v31
  v_lshlrev_b32 v40, 16, v74
  v_and_b32 v41, 0xffff0000, v74
  v_fmac_f32 v36, v40, v31
  v_fmac_f32 v37, v41, v31
  v_lshlrev_b32 v42, 16, v75
  v_and_b32 v43, 0xffff0000, v75
  v_fmac_f32 v38, v42, v31
  v_fmac_f32 v39, v43, v31
  s_nop 1
  v_add_f32_dpp v32, v32, v32 row_ror:4 row_mask:0xf bank_mask:0xf
  v_add_f32_dpp v33, v33, v33 row_ror:4 row_mask:0xf bank_mask:0xf
  v_add_f32_dpp v34, v34, v34 row_ror:4 row_mask:0xf bank_mask:0xf
  v_add_f32_dpp v35, v35, v35 row_ror:4 row_mask:0xf bank_mask:0xf
  v_add_f32_dpp v36, v36, v36 row_ror:4 row_mask:0xf bank_mask:0xf
  v_add_f32_dpp v37, v37, v37 row_ror:4 row_mask:0xf bank_mask:0xf
  v_add_f32_dpp v38, v38, v38 row_ror:4 row_mask:0xf bank_mask:0xf
  v_add_f32_dpp v39, v39, v39 row_ror:4 row_mask:0xf bank_mask:0xf
  v_add_f32_dpp v32, v32, v32 row_ror:8 row_mask:0xf bank_mask:0xf
  v_add_f32_dpp v33, v33, v33 row_ror:8 row_mask:0xf bank_mask:0xf
  v_add_f32_dpp v34, v34, v34 row_ror:8 row_mask:0xf bank_mask:0xf
  v_add_f32_dpp v35, v35, v35 row_ror:8 row_mask:0xf bank_mask:0xf
  v_add_f32_dpp v36, v36, v36 row_ror:8 row_mask:0xf bank_mask:0xf
  v_add_f32_dpp v37, v37, v37 row_ror:8 row_mask:0xf bank_mask:0xf
  v_add_f32_dpp v38, v38, v38 row_ror:8 row_mask:0xf bank_mask:0xf
  v_add_f32_dpp v39, v39, v39 row_ror:8 row_mask:0xf bank_mask:0xf
  s_mov_b32 s40, 0x000f000f
  s_mov_b32 s41, 0x000f000f
  s_mov_b64 exec, s[40:41]
  ds_write_b128 v8, v[32:35] offset:0
  ds_write_b128 v8, v[36:39] offset:16
  s_mov_b64 exec, 1
  s_waitcnt lgkmcnt(0)
  ds_add_rtn_u32 v2, v6, v4 offset:4
  s_mov_b64 exec, -1
  s_waitcnt lgkmcnt(0)
  v_readfirstlane_b32 s40, v2
  s_cmp_eq_u32 s40, 3
  s_cbranch_scc0 fr_g2d
  ds_read_b32 v32, v11 offset:0
  ds_read_b32 v33, v11 offset:128
  ds_read_b32 v34, v11 offset:256
  ds_read_b32 v35, v11 offset:384
  ds_read_b32 v36, v11 offset:512
  ds_read_b32 v37, v11 offset:640
  ds_read_b32 v38, v11 offset:768
  ds_read_b32 v39, v11 offset:896
  s_waitcnt lgkmcnt(0)
  v_add_f32 v32, v32, v36
  v_add_f32 v33, v33, v37
  v_add_f32 v34, v34, v38
  v_add_f32 v35, v35, v39
  v_add_f32 v32, v32, v34
  v_add_f32 v33, v33, v35
  v_add_f32 v32, v32, v33
  v_mov_b32 v33, v32
  s_nop 1
  v_permlane32_swap_b32 v32, v33
  s_nop 1
  v_add_f32 v32, v32, v33
  v_cvt_pk_bf16_f32 v32, v32, v32
  v_lshlrev_b32 v32, 16, v32
  v_add_f32 v33, 1.0, v32
  v_cvt_pk_bf16_f32 v33, v33, v33
  v_lshlrev_b32 v33, 16, v33
  s_cmp_lt_u32 s39, 4
  s_cbranch_scc0 fr_gs
  s_cmp_ge_u32 s24, 4
  s_cbranch_scc0 fr_g1a
  v_mov_b32 v32, v33
fr_g1a:
  v_cvt_f16_f32 v33, v32
  v_lshlrev_b32 v2, 1, v10
  s_lshl_b32 s40, s36, 1
  s_add_u32 s40, s40, 16384
  buffer_store_short v33, v2, s[16:19], s40 offen sc1
  s_lshr_b32 s40, s36, 3
  s_waitcnt vmcnt(0)
  s_mov_b64 exec, 1
  buffer_store_dword v4, v5, s[56:59], s40 offen offset:128 sc1
  s_mov_b64 exec, -1
  s_branch fr_g2d
fr_gs:
  s_cmp_eq_u32 s35, 4
  s_cbranch_scc0 fr_g2a
  v_mov_b32 v32, v33
fr_g2a:
  v_lshlrev_b32 v2, 2, v10
  s_lshl_b32 s40, s36, 2
  buffer_store_dword v32, v2, s[16:19], s40 offen
  s_sub_u32 s40, 4, s35
  s_cmp_gt_u32 s40, 1
  s_cbranch_scc1 fr_g2b
  s_lshl_b32 s40, s40, 5
  s_lshl_b32 s41, s37, 2
  s_add_u32 s40, s40, s41
  s_add_u32 s40, s40, 24576
  v_lshrrev_b32 v2, 4, v10
  v_lshlrev_b32 v2, 6, v2
  v_bfe_u32 v40, v10, 2, 1
  v_lshl_add_u32 v2, v40, 4, v2
  v_bfe_u32 v40, v10, 3, 1
  v_lshl_add_u32 v2, v40, 3, v2
  v_and_b32 v40, 3, v10
  v_lshl_add_u32 v2, v40, 1, v2
  buffer_store_short_d16_hi v32, v2, s[16:19], s40 offen
fr_g2b:
  s_waitcnt vmcnt(0)
  s_mov_b64 exec, 1
  buffer_atomic_add v4, v5, s[56:59], s62 offen offset:4
  s_mov_b64 exec, -1
fr_g2d:
fr_ng:
  s_mul_i32 s34, s31, 393216
  s_lshl_b32 s40, s27, 6
  s_add_u32 s34, s34, s40
  buffer_load_dwordx4 v[76:79], v19, s[20:23], s34 offen offset:0
  s_add_u32 s34, s34, 3072
  buffer_load_dwordx4 v[80:83], v19, s[20:23], s34 offen offset:0
  s_add_u32 s34, s34, 3072
  buffer_load_dwordx4 v[84:87], v19, s[20:23], s34 offen offset:0
  s_add_u32 s34, s34, 3072
  buffer_load_dwordx4 v[88:91], v19, s[20:23], s34 offen offset:0
  s_add_u32 s34, s34, 3072
  buffer_load_dwordx4 v[92:95], v19, s[20:23], s34 offen offset:0
  s_add_u32 s34, s34, 3072
  buffer_load_dwordx4 v[96:99], v19, s[20:23], s34 offen offset:0
  s_add_u32 s34, s34, 3072
  buffer_load_dwordx4 v[100:103], v19, s[20:23], s34 offen offset:0
  s_add_u32 s34, s34, 3072
  buffer_load_dwordx4 v[104:107], v19, s[20:23], s34 offen offset:0
  s_add_u32 s34, s34, 3072
  s_mov_b32 s60, 0
fr_tw:
  ds_read_b32 v2, v6 offset:12
  s_waitcnt lgkmcnt(0)
  v_readfirstlane_b32 s40, v2
  s_cmp_ge_u32 s40, 4
  s_cbranch_scc1 fr_twok
  s_sleep 2
  s_add_u32 s60, s60, 1
  s_cmp_lt_u32 s60, 160000
  s_cbranch_scc1 fr_tw
fr_twok:
  s_mul_i32 s34, s31, 393216
  s_lshl_b32 s40, s27, 6
  s_add_u32 s34, s34, s40
  buffer_load_dwordx4 v[108:111], v19, s[20:23], s34 offen offset:1024
  s_add_u32 s34, s34, 3072
  buffer_load_dwordx4 v[112:115], v19, s[20:23], s34 offen offset:1024
  s_add_u32 s34, s34, 3072
  buffer_load_dwordx4 v[116:119], v19, s[20:23], s34 offen offset:1024
  s_add_u32 s34, s34, 3072
  buffer_load_dwordx4 v[120:123], v19, s[20:23], s34 offen offset:1024
  s_add_u32 s34, s34, 3072
  buffer_load_dwordx4 v[124:127], v19, s[20:23], s34 offen offset:1024
  s_add_u32 s34, s34, 3072
  buffer_load_dwordx4 v[128:131], v19, s[20:23], s34 offen offset:1024
  s_add_u32 s34, s34, 3072
  buffer_load_dwordx4 v[132:135], v19, s[20:23], s34 offen offset:1024
  s_add_u32 s34, s34, 3072
  buffer_load_dwordx4 v[136:139], v19, s[20:23], s34 offen offset:1024
  s_add_u32 s34, s34, 3072
  s_mul_i32 s34, s31, 393216
  s_lshl_b32 s40, s27, 6
  s_add_u32 s34, s34, s40
  buffer_load_dwordx4 v[140:143], v19, s[20:23], s34 offen offset:2048
  s_add_u32 s34, s34, 3072
  buffer_load_dwordx4 v[144:147], v19, s[20:23], s34 offen offset:2048
  s_add_u32 s34, s34, 3072
  buffer_load_dwordx4 v[148:151], v19, s[20:23], s34 offen offset:2048
  s_add_u32 s34, s34, 3072
  buffer_load_dwordx4 v[152:155], v19, s[20:23], s34 offen offset:2048
  s_add_u32 s34, s34, 3072
  buffer_load_dwordx4 v[156:159], v19, s[20:23], s34 offen offset:2048
  s_add_u32 s34, s34, 3072
  buffer_load_dwordx4 v[160:163], v19, s[20:23], s34 offen offset:2048
  s_add_u32 s34, s34, 3072
  buffer_load_dwordx4 v[164:167], v19, s[20:23], s34 offen offset:2048
  s_add_u32 s34, s34, 3072
  buffer_load_dwordx4 v[168:171], v19, s[20:23], s34 offen offset:2048
  s_add_u32 s34, s34, 3072
  v_lshrrev_b32 v12, 1, v17
  v_mul_u32_u24 v12, 1152, v12
  v_and_b32 v13, 1, v17
  v_mul_u32_u24 v13, 576, v13
  v_add_u32 v12, v12, v13
  v_mul_u32_u24 v13, 144, v16
  s_mul_i32 s34, s31, 9216
  v_add3_u32 v12, v12, v13, s34
  v_add_u32 v13, 73728, v12
  s_waitcnt vmcnt(16)
  v_lshlrev_b32 v32, 16, v76
  v_lshlrev_b32 v33, 16, v80
  v_and_b32 v34, 0xffff0000, v76
  v_and_b32 v35, 0xffff0000, v80
  v_cvt_pk_f16_f32 v44, v32, v33
  v_cvt_pk_f16_f32 v48, v34, v35
  v_lshlrev_b32 v36, 16, v77
  v_lshlrev_b32 v37, 16, v81
  v_and_b32 v38, 0xffff0000, v77
  v_and_b32 v39, 0xffff0000, v81
  v_cvt_pk_f16_f32 v52, v36, v37
  v_cvt_pk_f16_f32 v56, v38, v39
  v_lshlrev_b32 v32, 16, v78
  v_lshlrev_b32 v33, 16, v82
  v_and_b32 v34, 0xffff0000, v78
  v_and_b32 v35, 0xffff0000, v82
  v_cvt_pk_f16_f32 v60, v32, v33
  v_cvt_pk_f16_f32 v64, v34, v35
  v_lshlrev_b32 v36, 16, v79
  v_lshlrev_b32 v37, 16, v83
  v_and_b32 v38, 0xffff0000, v79
  v_and_b32 v39, 0xffff0000, v83
  v_cvt_pk_f16_f32 v68, v36, v37
  v_cvt_pk_f16_f32 v72, v38, v39
  v_lshlrev_b32 v32, 16, v84
  v_lshlrev_b32 v33, 16, v88
  v_and_b32 v34, 0xffff0000, v84
  v_and_b32 v35, 0xffff0000, v88
  v_cvt_pk_f16_f32 v45, v32, v33
  v_cvt_pk_f16_f32 v49, v34, v35
  v_lshlrev_b32 v36, 16, v85
  v_lshlrev_b32 v37, 16, v89
  v_and_b32 v38, 0xffff0000, v85
  v_and_b32 v39, 0xffff0000, v89
  v_cvt_pk_f16_f32 v53, v36, v37
  v_cvt_pk_f16_f32 v57, v38, v39
  v_lshlrev_b32 v32, 16, v86
  v_lshlrev_b32 v33, 16, v90
  v_and_b32 v34, 0xffff0000, v86
  v_and_b32 v35, 0xffff0000, v90
  v_cvt_pk_f16_f32 v61, v32, v33
  v_cvt_pk_f16_f32 v65, v34, v35
  v_lshlrev_b32 v36, 16, v87
  v_lshlrev_b32 v37, 16, v91
  v_and_b32 v38, 0xffff0000, v87
  v_and_b32 v39, 0xffff0000, v91
  v_cvt_pk_f16_f32 v69, v36, v37
  v_cvt_pk_f16_f32 v73, v38, v39
  v_lshlrev_b32 v32, 16, v92
  v_lshlrev_b32 v33, 16, v96
  v_and_b32 v34, 0xffff0000, v92
  v_and_b32 v35, 0xffff0000, v96
  v_cvt_pk_f16_f32 v46, v32, v33
  v_cvt_pk_f16_f32 v50, v34, v35
  v_lshlrev_b32 v36, 16, v93
  v_lshlrev_b32 v37, 16, v97
  v_and_b32 v38, 0xffff0000, v93
  v_and_b32 v39, 0xffff0000, v97
  v_cvt_pk_f16_f32 v54, v36, v37
  v_cvt_pk_f16_f32 v58, v38, v39
  v_lshlrev_b32 v32, 16, v94
  v_lshlrev_b32 v33, 16, v98
  v_and_b32 v34, 0xffff0000, v94
  v_and_b32 v35, 0xffff0000, v98
  v_cvt_pk_f16_f32 v62, v32, v33
  v_cvt_pk_f16_f32 v66, v34, v35
  v_lshlrev_b32 v36, 16, v95
  v_lshlrev_b32 v37, 16, v99
  v_and_b32 v38, 0xffff0000, v95
  v_and_b32 v39, 0xffff0000, v99
  v_cvt_pk_f16_f32 v70, v36, v37
  v_cvt_pk_f16_f32 v74, v38, v39
  v_lshlrev_b32 v32, 16, v100
  v_lshlrev_b32 v33, 16, v104
  v_and_b32 v34, 0xffff0000, v100
  v_and_b32 v35, 0xffff0000, v104
  v_cvt_pk_f16_f32 v47, v32, v33
  v_cvt_pk_f16_f32 v51, v34, v35
  v_lshlrev_b32 v36, 16, v101
  v_lshlrev_b32 v37, 16, v105
  v_and_b32 v38, 0xffff0000, v101
  v_and_b32 v39, 0xffff0000, v105
  v_cvt_pk_f16_f32 v55, v36, v37
  v_cvt_pk_f16_f32 v59, v38, v39
  v_lshlrev_b32 v32, 16, v102
  v_lshlrev_b32 v33, 16, v106
  v_and_b32 v34, 0xffff0000, v102
  v_and_b32 v35, 0xffff0000, v106
  v_cvt_pk_f16_f32 v63, v32, v33
  v_cvt_pk_f16_f32 v67, v34, v35
  v_lshlrev_b32 v36, 16, v103
  v_lshlrev_b32 v37, 16, v107
  v_and_b32 v38, 0xffff0000, v103
  v_and_b32 v39, 0xffff0000, v107
  v_cvt_pk_f16_f32 v71, v36, v37
  v_cvt_pk_f16_f32 v75, v38, v39
  s_mov_b32 s60, 0
fr_xw:
  ds_read_b32 v2, v6 offset:8
  s_waitcnt lgkmcnt(0)
  v_readfirstlane_b32 s40, v2
  s_cmp_eq_u32 s40, 4
  s_cbranch_scc1 fr_xwok
  s_sleep 1
  s_add_u32 s60, s60, 1
  s_cmp_lt_u32 s60, 160000
  s_cbranch_scc1 fr_xw
fr_xwok:
  ds_write_b128 v12, v[44:47] offset:0
  ds_write_b128 v12, v[48:51] offset:16
  ds_write_b128 v12, v[52:55] offset:32
  ds_write_b128 v12, v[56:59] offset:48
  ds_write_b128 v12, v[60:63] offset:64
  ds_write_b128 v12, v[64:67] offset:80
  ds_write_b128 v12, v[68:71] offset:96
  ds_write_b128 v12, v[72:75] offset:112
  s_waitcnt vmcnt(8)
  v_lshlrev_b32 v32, 16, v108
  v_lshlrev_b32 v33, 16, v112
  v_and_b32 v34, 0xffff0000, v108
  v_and_b32 v35, 0xffff0000, v112
  v_cvt_pk_f16_f32 v76, v32, v33
  v_cvt_pk_f16_f32 v80, v34, v35
  v_lshlrev_b32 v36, 16, v109
  v_lshlrev_b32 v37, 16, v113
  v_and_b32 v38, 0xffff0000, v109
  v_and_b32 v39, 0xffff0000, v113
  v_cvt_pk_f16_f32 v84, v36, v37
  v_cvt_pk_f16_f32 v88, v38, v39
  v_lshlrev_b32 v32, 16, v110
  v_lshlrev_b32 v33, 16, v114
  v_and_b32 v34, 0xffff0000, v110
  v_and_b32 v35, 0xffff0000, v114
  v_cvt_pk_f16_f32 v92, v32, v33
  v_cvt_pk_f16_f32 v96, v34, v35
  v_lshlrev_b32 v36, 16, v111
  v_lshlrev_b32 v37, 16, v115
  v_and_b32 v38, 0xffff0000, v111
  v_and_b32 v39, 0xffff0000, v115
  v_cvt_pk_f16_f32 v100, v36, v37
  v_cvt_pk_f16_f32 v104, v38, v39
  v_lshlrev_b32 v32, 16, v116
  v_lshlrev_b32 v33, 16, v120
  v_and_b32 v34, 0xffff0000, v116
  v_and_b32 v35, 0xffff0000, v120
  v_cvt_pk_f16_f32 v77, v32, v33
  v_cvt_pk_f16_f32 v81, v34, v35
  v_lshlrev_b32 v36, 16, v117
  v_lshlrev_b32 v37, 16, v121
  v_and_b32 v38, 0xffff0000, v117
  v_and_b32 v39, 0xffff0000, v121
  v_cvt_pk_f16_f32 v85, v36, v37
  v_cvt_pk_f16_f32 v89, v38, v39
  v_lshlrev_b32 v32, 16, v118
  v_lshlrev_b32 v33, 16, v122
  v_and_b32 v34, 0xffff0000, v118
  v_and_b32 v35, 0xffff0000, v122
  v_cvt_pk_f16_f32 v93, v32, v33
  v_cvt_pk_f16_f32 v97, v34, v35
  v_lshlrev_b32 v36, 16, v119
  v_lshlrev_b32 v37, 16, v123
  v_and_b32 v38, 0xffff0000, v119
  v_and_b32 v39, 0xffff0000, v123
  v_cvt_pk_f16_f32 v101, v36, v37
  v_cvt_pk_f16_f32 v105, v38, v39
  v_lshlrev_b32 v32, 16, v124
  v_lshlrev_b32 v33, 16, v128
  v_and_b32 v34, 0xffff0000, v124
  v_and_b32 v35, 0xffff0000, v128
  v_cvt_pk_f16_f32 v78, v32, v33
  v_cvt_pk_f16_f32 v82, v34, v35
  v_lshlrev_b32 v36, 16, v125
  v_lshlrev_b32 v37, 16, v129
  v_and_b32 v38, 0xffff0000, v125
  v_and_b32 v39, 0xffff0000, v129
  v_cvt_pk_f16_f32 v86, v36, v37
  v_cvt_pk_f16_f32 v90, v38, v39
  v_lshlrev_b32 v32, 16, v126
  v_lshlrev_b32 v33, 16, v130
  v_and_b32 v34, 0xffff0000, v126
  v_and_b32 v35, 0xffff0000, v130
  v_cvt_pk_f16_f32 v94, v32, v33
  v_cvt_pk_f16_f32 v98, v34, v35
  v_lshlrev_b32 v36, 16, v127
  v_lshlrev_b32 v37, 16, v131
  v_and_b32 v38, 0xffff0000, v127
  v_and_b32 v39, 0xffff0000, v131
  v_cvt_pk_f16_f32 v102, v36, v37
  v_cvt_pk_f16_f32 v106, v38, v39
  v_lshlrev_b32 v32, 16, v132
  v_lshlrev_b32 v33, 16, v136
  v_and_b32 v34, 0xffff0000, v132
  v_and_b32 v35, 0xffff0000, v136
  v_cvt_pk_f16_f32 v79, v32, v33
  v_cvt_pk_f16_f32 v83, v34, v35
  v_lshlrev_b32 v36, 16, v133
  v_lshlrev_b32 v37, 16, v137
  v_and_b32 v38, 0xffff0000, v133
  v_and_b32 v39, 0xffff0000, v137
  v_cvt_pk_f16_f32 v87, v36, v37
  v_cvt_pk_f16_f32 v91, v38, v39
  v_lshlrev_b32 v32, 16, v134
  v_lshlrev_b32 v33, 16, v138
  v_and_b32 v34, 0xffff0000, v134
  v_and_b32 v35, 0xffff0000, v138
  v_cvt_pk_f16_f32 v95, v32, v33
  v_cvt_pk_f16_f32 v99, v34, v35
  v_lshlrev_b32 v36, 16, v135
  v_lshlrev_b32 v37, 16, v139
  v_and_b32 v38, 0xffff0000, v135
  v_and_b32 v39, 0xffff0000, v139
  v_cvt_pk_f16_f32 v103, v36, v37
  v_cvt_pk_f16_f32 v107, v38, v39
  ds_write_b128 v12, v[76:79] offset:36864
  ds_write_b128 v12, v[80:83] offset:36880
  ds_write_b128 v12, v[84:87] offset:36896
  ds_write_b128 v12, v[88:91] offset:36912
  ds_write_b128 v12, v[92:95] offset:36928
  ds_write_b128 v12, v[96:99] offset:36944
  ds_write_b128 v12, v[100:103] offset:36960
  ds_write_b128 v12, v[104:107] offset:36976
  s_waitcnt vmcnt(0)
  v_lshlrev_b32 v32, 16, v140
  v_lshlrev_b32 v33, 16, v144
  v_and_b32 v34, 0xffff0000, v140
  v_and_b32 v35, 0xffff0000, v144
  v_cvt_pk_f16_f32 v108, v32, v33
  v_cvt_pk_f16_f32 v112, v34, v35
  v_lshlrev_b32 v36, 16, v141
  v_lshlrev_b32 v37, 16, v145
  v_and_b32 v38, 0xffff0000, v141
  v_and_b32 v39, 0xffff0000, v145
  v_cvt_pk_f16_f32 v116, v36, v37
  v_cvt_pk_f16_f32 v120, v38, v39
  v_lshlrev_b32 v32, 16, v142
  v_lshlrev_b32 v33, 16, v146
  v_and_b32 v34, 0xffff0000, v142
  v_and_b32 v35, 0xffff0000, v146
  v_cvt_pk_f16_f32 v124, v32, v33
  v_cvt_pk_f16_f32 v128, v34, v35
  v_lshlrev_b32 v36, 16, v143
  v_lshlrev_b32 v37, 16, v147
  v_and_b32 v38, 0xffff0000, v143
  v_and_b32 v39, 0xffff0000, v147
  v_cvt_pk_f16_f32 v132, v36, v37
  v_cvt_pk_f16_f32 v136, v38, v39
  v_lshlrev_b32 v32, 16, v148
  v_lshlrev_b32 v33, 16, v152
  v_and_b32 v34, 0xffff0000, v148
  v_and_b32 v35, 0xffff0000, v152
  v_cvt_pk_f16_f32 v109, v32, v33
  v_cvt_pk_f16_f32 v113, v34, v35
  v_lshlrev_b32 v36, 16, v149
  v_lshlrev_b32 v37, 16, v153
  v_and_b32 v38, 0xffff0000, v149
  v_and_b32 v39, 0xffff0000, v153
  v_cvt_pk_f16_f32 v117, v36, v37
  v_cvt_pk_f16_f32 v121, v38, v39
  v_lshlrev_b32 v32, 16, v150
  v_lshlrev_b32 v33, 16, v154
  v_and_b32 v34, 0xffff0000, v150
  v_and_b32 v35, 0xffff0000, v154
  v_cvt_pk_f16_f32 v125, v32, v33
  v_cvt_pk_f16_f32 v129, v34, v35
  v_lshlrev_b32 v36, 16, v151
  v_lshlrev_b32 v37, 16, v155
  v_and_b32 v38, 0xffff0000, v151
  v_and_b32 v39, 0xffff0000, v155
  v_cvt_pk_f16_f32 v133, v36, v37
  v_cvt_pk_f16_f32 v137, v38, v39
  v_lshlrev_b32 v32, 16, v156
  v_lshlrev_b32 v33, 16, v160
  v_and_b32 v34, 0xffff0000, v156
  v_and_b32 v35, 0xffff0000, v160
  v_cvt_pk_f16_f32 v110, v32, v33
  v_cvt_pk_f16_f32 v114, v34, v35
  v_lshlrev_b32 v36, 16, v157
  v_lshlrev_b32 v37, 16, v161
  v_and_b32 v38, 0xffff0000, v157
  v_and_b32 v39, 0xffff0000, v161
  v_cvt_pk_f16_f32 v118, v36, v37
  v_cvt_pk_f16_f32 v122, v38, v39
  v_lshlrev_b32 v32, 16, v158
  v_lshlrev_b32 v33, 16, v162
  v_and_b32 v34, 0xffff0000, v158
  v_and_b32 v35, 0xffff0000, v162
  v_cvt_pk_f16_f32 v126, v32, v33
  v_cvt_pk_f16_f32 v130, v34, v35
  v_lshlrev_b32 v36, 16, v159
  v_lshlrev_b32 v37, 16, v163
  v_and_b32 v38, 0xffff0000, v159
  v_and_b32 v39, 0xffff0000, v163
  v_cvt_pk_f16_f32 v134, v36, v37
  v_cvt_pk_f16_f32 v138, v38, v39
  v_lshlrev_b32 v32, 16, v164
  v_lshlrev_b32 v33, 16, v168
  v_and_b32 v34, 0xffff0000, v164
  v_and_b32 v35, 0xffff0000, v168
  v_cvt_pk_f16_f32 v111, v32, v33
  v_cvt_pk_f16_f32 v115, v34, v35
  v_lshlrev_b32 v36, 16, v165
  v_lshlrev_b32 v37, 16, v169
  v_and_b32 v38, 0xffff0000, v165
  v_and_b32 v39, 0xffff0000, v169
  v_cvt_pk_f16_f32 v119, v36, v37
  v_cvt_pk_f16_f32 v123, v38, v39
  v_lshlrev_b32 v32, 16, v166
  v_lshlrev_b32 v33, 16, v170
  v_and_b32 v34, 0xffff0000, v166
  v_and_b32 v35, 0xffff0000, v170
  v_cvt_pk_f16_f32 v127, v32, v33
  v_cvt_pk_f16_f32 v131, v34, v35
  v_lshlrev_b32 v36, 16, v167
  v_lshlrev_b32 v37, 16, v171
  v_and_b32 v38, 0xffff0000, v167
  v_and_b32 v39, 0xffff0000, v171
  v_cvt_pk_f16_f32 v135, v36, v37
  v_cvt_pk_f16_f32 v139, v38, v39
  ds_write_b128 v13, v[108:111] offset:0
  ds_write_b128 v13, v[112:115] offset:16
  ds_write_b128 v13, v[116:119] offset:32
  ds_write_b128 v13, v[120:123] offset:48
  ds_write_b128 v13, v[124:127] offset:64
  ds_write_b128 v13, v[128:131] offset:80
  ds_write_b128 v13, v[132:135] offset:96
  ds_write_b128 v13, v[136:139] offset:112
  s_waitcnt lgkmcnt(0)
  s_barrier
  s_setprio 0
  s_lshl_b32 s30, s25, 2
  s_add_u32 s30, s30, s31
  v_lshlrev_b32 v14, 12, v9
  v_lshl_add_u32 v14, v10, 1, v14
  v_mul_u32_u24 v15, 11008, v9
  v_lshl_add_u32 v15, v10, 1, v15
  s_cmp_ge_u32 s30, 86
  s_cbranch_scc1 fr_bd
  s_cmp_ge_u32 s30, 43
  s_cselect_b32 s44, s50, s48
  s_cselect_b32 s45, s51, s49
  s_mov_b32 s46, 1409024
  s_cselect_b32 s38, 1, 0
  s_cselect_b32 s39, 43, 0
  s_sub_u32 s39, s30, s39
  s_mul_i32 s40, s24, 176128
  s_lshl_b32 s41, s39, 6
  s_add_u32 s40, s40, s41
  s_add_u32 s41, s40, 0
  buffer_load_ushort v204, v15, s[44:47], s41 offen
  s_add_u32 s41, s40, 2752
  buffer_load_ushort v205, v15, s[44:47], s41 offen
  s_add_u32 s41, s40, 5504
  buffer_load_ushort v206, v15, s[44:47], s41 offen
  s_add_u32 s41, s40, 8256
  buffer_load_ushort v207, v15, s[44:47], s41 offen
  s_add_u32 s41, s40, 22016
  buffer_load_ushort v208, v15, s[44:47], s41 offen
  s_add_u32 s41, s40, 24768
  buffer_load_ushort v209, v15, s[44:47], s41 offen
  s_add_u32 s41, s40, 27520
  buffer_load_ushort v210, v15, s[44:47], s41 offen
  s_add_u32 s41, s40, 30272
  buffer_load_ushort v211, v15, s[44:47], s41 offen
  s_add_u32 s41, s40, 44032
  buffer_load_ushort v212, v15, s[44:47], s41 offen
  s_add_u32 s41, s40, 46784
  buffer_load_ushort v213, v15, s[44:47], s41 offen
  s_add_u32 s41, s40, 49536
  buffer_load_ushort v214, v15, s[44:47], s41 offen
  s_add_u32 s41, s40, 52288
  buffer_load_ushort v215, v15, s[44:47], s41 offen
  s_add_u32 s41, s40, 66048
  buffer_load_ushort v216, v15, s[44:47], s41 offen
  s_add_u32 s41, s40, 68800
  buffer_load_ushort v217, v15, s[44:47], s41 offen
  s_add_u32 s41, s40, 71552
  buffer_load_ushort v218, v15, s[44:47], s41 offen
  s_add_u32 s41, s40, 74304
  buffer_load_ushort v219, v15, s[44:47], s41 offen
  s_add_u32 s41, s40, 88064
  buffer_load_ushort v220, v15, s[44:47], s41 offen
  s_add_u32 s41, s40, 90816
  buffer_load_ushort v221, v15, s[44:47], s41 offen
  s_add_u32 s41, s40, 93568
  buffer_load_ushort v222, v15, s[44:47], s41 offen
  s_add_u32 s41, s40, 96320
  buffer_load_ushort v223, v15, s[44:47], s41 offen
  s_add_u32 s41, s40, 110080
  buffer_load_ushort v224, v15, s[44:47], s41 offen
  s_add_u32 s41, s40, 112832
  buffer_load_ushort v225, v15, s[44:47], s41 offen
  s_add_u32 s41, s40, 115584
  buffer_load_ushort v226, v15, s[44:47], s41 offen
  s_add_u32 s41, s40, 118336
  buffer_load_ushort v227, v15, s[44:47], s41 offen
  s_add_u32 s41, s40, 132096
  buffer_load_ushort v228, v15, s[44:47], s41 offen
  s_add_u32 s41, s40, 134848
  buffer_load_ushort v229, v15, s[44:47], s41 offen
  s_add_u32 s41, s40, 137600
  buffer_load_ushort v230, v15, s[44:47], s41 offen
  s_add_u32 s41, s40, 140352
  buffer_load_ushort v231, v15, s[44:47], s41 offen
  s_add_u32 s41, s40, 154112
  buffer_load_ushort v232, v15, s[44:47], s41 offen
  s_add_u32 s41, s40, 156864
  buffer_load_ushort v233, v15, s[44:47], s41 offen
  s_add_u32 s41, s40, 159616
  buffer_load_ushort v234, v15, s[44:47], s41 offen
  s_add_u32 s41, s40, 162368
  buffer_load_ushort v235, v15, s[44:47], s41 offen
  s_branch fr_b2
fr_bd:
  s_sub_u32 s61, s30, 86
  s_mul_i32 s40, s24, 59
  s_add_u32 s40, s40, s61
  s_cmp_ge_u32 s40, 344
  s_cselect_b32 s44, s54, s52
  s_cselect_b32 s45, s55, s53
  s_cselect_b32 s39, 32, 86
  s_cselect_b32 s38, 0, 524288
  s_cselect_b32 s41, 344, 0
  s_sub_u32 s40, s40, s41
  s_lshl_b32 s46, s39, 14
  s_add_u32 s38, s38, 19922944
  s_lshr_b32 s41, s40, 2
  s_and_b32 s40, s40, 3
  s_lshl_b32 s42, s41, 14
  s_lshl_b32 s43, s40, 8
  s_add_u32 s42, s42, s43
  s_add_u32 s43, s42, 8192
  buffer_load_ushort v204, v14, s[44:47], s42 offen offset:0
  buffer_load_ushort v205, v14, s[44:47], s42 offen offset:1024
  buffer_load_ushort v206, v14, s[44:47], s42 offen offset:2048
  buffer_load_ushort v207, v14, s[44:47], s42 offen offset:3072
  buffer_load_ushort v208, v14, s[44:47], s43 offen offset:0
  buffer_load_ushort v209, v14, s[44:47], s43 offen offset:1024
  buffer_load_ushort v210, v14, s[44:47], s43 offen offset:2048
  buffer_load_ushort v211, v14, s[44:47], s43 offen offset:3072
  buffer_load_ushort v212, v14, s[44:47], s42 offen offset:64
  buffer_load_ushort v213, v14, s[44:47], s42 offen offset:1088
  buffer_load_ushort v214, v14, s[44:47], s42 offen offset:2112
  buffer_load_ushort v215, v14, s[44:47], s42 offen offset:3136
  buffer_load_ushort v216, v14, s[44:47], s43 offen offset:64
  buffer_load_ushort v217, v14, s[44:47], s43 offen offset:1088
  buffer_load_ushort v218, v14, s[44:47], s43 offen offset:2112
  buffer_load_ushort v219, v14, s[44:47], s43 offen offset:3136
  buffer_load_ushort v220, v14, s[44:47], s42 offen offset:128
  buffer_load_ushort v221, v14, s[44:47], s42 offen offset:1152
  buffer_load_ushort v222, v14, s[44:47], s42 offen offset:2176
  buffer_load_ushort v223, v14, s[44:47], s42 offen offset:3200
  buffer_load_ushort v224, v14, s[44:47], s43 offen offset:128
  buffer_load_ushort v225, v14, s[44:47], s43 offen offset:1152
  buffer_load_ushort v226, v14, s[44:47], s43 offen offset:2176
  buffer_load_ushort v227, v14, s[44:47], s43 offen offset:3200
  buffer_load_ushort v228, v14, s[44:47], s42 offen offset:192
  buffer_load_ushort v229, v14, s[44:47], s42 offen offset:1216
  buffer_load_ushort v230, v14, s[44:47], s42 offen offset:2240
  buffer_load_ushort v231, v14, s[44:47], s42 offen offset:3264
  buffer_load_ushort v232, v14, s[44:47], s43 offen offset:192
  buffer_load_ushort v233, v14, s[44:47], s43 offen offset:1216
  buffer_load_ushort v234, v14, s[44:47], s43 offen offset:2240
  buffer_load_ushort v235, v14, s[44:47], s43 offen offset:3264
  s_lshl_b32 s40, s40, 2
  s_mul_i32 s40, s40, s39
  s_add_u32 s40, s40, s41
  s_lshl_b32 s40, s40, 10
  s_add_u32 s38, s38, s40
  s_lshl_b32 s39, s39, 10
fr_b2:
  s_cmp_eq_u32 s28, 4
  s_cbranch_scc0 fr_m1
  s_getreg_b32 s40, hwreg(HW_REG_HW_ID, 8, 8)
  s_lshl_b32 s40, s40, 2
  s_lshl_b32 s41, s24, 10
  s_add_u32 s40, s40, s41
  s_add_u32 s40, s40, 2621440
  v_mov_b32 v2, s25
  s_mov_b64 exec, 1
  buffer_store_dword v2, v5, s[16:19], s40 offen
  s_mov_b64 exec, -1
fr_m1:
  s_sub_u32 s61, s30, 32
  s_cmp_lt_u32 s61, 17
  s_cbranch_scc0 fr_a3
  s_add_u32 s61, s61, 42
  s_mul_i32 s40, s24, 59
  s_add_u32 s40, s40, s61
  s_cmp_ge_u32 s40, 344
  s_cselect_b32 s44, s54, s52
  s_cselect_b32 s45, s55, s53
  s_cselect_b32 s35, 32, 86
  s_cselect_b32 s34, 0, 524288
  s_cselect_b32 s41, 344, 0
  s_sub_u32 s40, s40, s41
  s_lshl_b32 s46, s35, 14
  s_add_u32 s34, s34, 19922944
  s_lshr_b32 s41, s40, 2
  s_and_b32 s40, s40, 3
  s_lshl_b32 s42, s41, 14
  s_lshl_b32 s43, s40, 8
  s_add_u32 s42, s42, s43
  s_add_u32 s43, s42, 8192
  buffer_load_ushort v172, v14, s[44:47], s42 offen offset:0
  buffer_load_ushort v173, v14, s[44:47], s42 offen offset:1024
  buffer_load_ushort v174, v14, s[44:47], s42 offen offset:2048
  buffer_load_ushort v175, v14, s[44:47], s42 offen offset:3072
  buffer_load_ushort v176, v14, s[44:47], s43 offen offset:0
  buffer_load_ushort v177, v14, s[44:47], s43 offen offset:1024
  buffer_load_ushort v178, v14, s[44:47], s43 offen offset:2048
  buffer_load_ushort v179, v14, s[44:47], s43 offen offset:3072
  buffer_load_ushort v180, v14, s[44:47], s42 offen offset:64
  buffer_load_ushort v181, v14, s[44:47], s42 offen offset:1088
  buffer_load_ushort v182, v14, s[44:47], s42 offen offset:2112
  buffer_load_ushort v183, v14, s[44:47], s42 offen offset:3136
  buffer_load_ushort v184, v14, s[44:47], s43 offen offset:64
  buffer_load_ushort v185, v14, s[44:47], s43 offen offset:1088
  buffer_load_ushort v186, v14, s[44:47], s43 offen offset:2112
  buffer_load_ushort v187, v14, s[44:47], s43 offen offset:3136
  buffer_load_ushort v188, v14, s[44:47], s42 offen offset:128
  buffer_load_ushort v189, v14, s[44:47], s42 offen offset:1152
  buffer_load_ushort v190, v14, s[44:47], s42 offen offset:2176
  buffer_load_ushort v191, v14, s[44:47], s42 offen offset:3200
  buffer_load_ushort v192, v14, s[44:47], s43 offen offset:128
  buffer_load_ushort v193, v14, s[44:47], s43 offen offset:1152
  buffer_load_ushort v194, v14, s[44:47], s43 offen offset:2176
  buffer_load_ushort v195, v14, s[44:47], s43 offen offset:3200
  buffer_load_ushort v196, v14, s[44:47], s42 offen offset:192
  buffer_load_ushort v197, v14, s[44:47], s42 offen offset:1216
  buffer_load_ushort v198, v14, s[44:47], s42 offen offset:2240
  buffer_load_ushort v199, v14, s[44:47], s42 offen offset:3264
  buffer_load_ushort v200, v14, s[44:47], s43 offen offset:192
  buffer_load_ushort v201, v14, s[44:47], s43 offen offset:1216
  buffer_load_ushort v202, v14, s[44:47], s43 offen offset:2240
  buffer_load_ushort v203, v14, s[44:47], s43 offen offset:3264
  s_lshl_b32 s40, s40, 2
  s_mul_i32 s40, s40, s35
  s_add_u32 s40, s40, s41
  s_lshl_b32 s40, s40, 10
  s_add_u32 s34, s34, s40
  s_lshl_b32 s35, s35, 10
  s_waitcnt vmcnt(0)
  v_lshl_or_b32 v140, v173, 16, v172
  v_lshl_or_b32 v141, v175, 16, v174
  v_lshl_or_b32 v142, v177, 16, v176
  v_lshl_or_b32 v143, v179, 16, v178
  buffer_store_dwordx4 v[140:143], v3, s[16:19], s34 offen
  s_add_u32 s34, s34, s35
  v_lshl_or_b32 v144, v181, 16, v180
  v_lshl_or_b32 v145, v183, 16, v182
  v_lshl_or_b32 v146, v185, 16, v184
  v_lshl_or_b32 v147, v187, 16, v186
  buffer_store_dwordx4 v[144:147], v3, s[16:19], s34 offen
  s_add_u32 s34, s34, s35
  v_lshl_or_b32 v148, v189, 16, v188
  v_lshl_or_b32 v149, v191, 16, v190
  v_lshl_or_b32 v150, v193, 16, v192
  v_lshl_or_b32 v151, v195, 16, v194
  buffer_store_dwordx4 v[148:151], v3, s[16:19], s34 offen
  s_add_u32 s34, s34, s35
  v_lshl_or_b32 v152, v197, 16, v196
  v_lshl_or_b32 v153, v199, 16, v198
  v_lshl_or_b32 v154, v201, 16, v200
  v_lshl_or_b32 v155, v203, 16, v202
  buffer_store_dwordx4 v[152:155], v3, s[16:19], s34 offen
  s_add_u32 s34, s34, s35
  s_branch fr_a9
fr_a3:
  s_cmp_eq_u32 s25, 31
  s_cbranch_scc0 fr_a9
  v_mov_b32 v32, 0
  v_mov_b32 v33, 0
  v_mov_b32 v34, 0
  v_mov_b32 v35, 0
  s_lshl_b32 s40, s24, 12
  s_lshl_b32 s41, s31, 10
  s_add_u32 s40, s40, s41
  s_add_u32 s40, s40, 32768
  buffer_store_dwordx4 v[32:35], v3, s[16:19], s40 offen
fr_a9:
  s_cmp_ge_u32 s30, 86
  s_cbranch_scc0 fr_gu
  s_waitcnt vmcnt(0)
  s_nop 0
  v_lshl_or_b32 v140, v205, 16, v204
  v_lshl_or_b32 v141, v207, 16, v206
  v_lshl_or_b32 v142, v209, 16, v208
  v_lshl_or_b32 v143, v211, 16, v210
  buffer_store_dwordx4 v[140:143], v3, s[16:19], s38 offen
  s_add_u32 s38, s38, s39
  v_lshl_or_b32 v144, v213, 16, v212
  v_lshl_or_b32 v145, v215, 16, v214
  v_lshl_or_b32 v146, v217, 16, v216
  v_lshl_or_b32 v147, v219, 16, v218
  buffer_store_dwordx4 v[144:147], v3, s[16:19], s38 offen
  s_add_u32 s38, s38, s39
  v_lshl_or_b32 v148, v221, 16, v220
  v_lshl_or_b32 v149, v223, 16, v222
  v_lshl_or_b32 v150, v225, 16, v224
  v_lshl_or_b32 v151, v227, 16, v226
  buffer_store_dwordx4 v[148:151], v3, s[16:19], s38 offen
  s_add_u32 s38, s38, s39
  v_lshl_or_b32 v152, v229, 16, v228
  v_lshl_or_b32 v153, v231, 16, v230
  v_lshl_or_b32 v154, v233, 16, v232
  v_lshl_or_b32 v155, v235, 16, v234
  buffer_store_dwordx4 v[152:155], v3, s[16:19], s38 offen
  s_add_u32 s38, s38, s39
  s_branch fr_hend
fr_gu:
  v_lshrrev_b32 v12, 4, v10
  v_lshlrev_b32 v13, 15, v12
  v_lshl_add_u32 v13, v9, 9, v13
  v_and_b32 v7, 15, v10
  v_lshl_add_u32 v13, v7, 4, v13
  s_lshl_b32 s40, s39, 16
  s_lshl_b32 s41, s24, 12
  s_add_u32 s40, s40, s41
  s_lshl_b32 s41, s38, 8
  s_add_u32 s40, s40, s41
  s_add_u32 s40, s40, 23068672
  v_lshlrev_b32 v12, 11, v12
  v_lshl_add_u32 v12, v9, 6, v12
  v_lshl_add_u32 v12, v7, 2, v12
  s_lshl_b32 s42, s39, 12
  s_lshl_b32 s41, s38, 7
  s_add_u32 s42, s42, s41
  s_lshl_b32 s41, s24, 8
  s_add_u32 s42, s42, s41
  s_add_u32 s42, s42, 29360128
  s_add_u32 s43, s41, 24576
  v_and_b32 v8, 1, v1
  v_lshlrev_b32 v8, 5, v8
  v_lshl_add_u32 v8, v9, 4, v8
  s_waitcnt vmcnt(0)
  v_lshl_or_b32 v140, v205, 16, v204
  v_lshl_or_b32 v141, v207, 16, v206
  v_lshl_or_b32 v142, v209, 16, v208
  v_lshl_or_b32 v143, v211, 16, v210
  buffer_store_dwordx4 v[140:143], v13, s[16:19], s40 offen offset:0
  v_lshl_or_b32 v144, v213, 16, v212
  v_lshl_or_b32 v145, v215, 16, v214
  v_lshl_or_b32 v146, v217, 16, v216
  v_lshl_or_b32 v147, v219, 16, v218
  buffer_store_dwordx4 v[144:147], v13, s[16:19], s40 offen offset:1024
  v_lshl_or_b32 v148, v221, 16, v220
  v_lshl_or_b32 v149, v223, 16, v222
  v_lshl_or_b32 v150, v225, 16, v224
  v_lshl_or_b32 v151, v227, 16, v226
  buffer_store_dwordx4 v[148:151], v13, s[16:19], s40 offen offset:2048
  v_lshl_or_b32 v152, v229, 16, v228
  v_lshl_or_b32 v153, v231, 16, v230
  v_lshl_or_b32 v154, v233, 16, v232
  v_lshl_or_b32 v155, v235, 16, v234
  buffer_store_dwordx4 v[152:155], v13, s[16:19], s40 offen offset:3072
  s_mov_b32 s60, 0
fr_p2:
  buffer_load_dword v2, v5, s[56:59], s62 offen offset:4 sc1
  s_waitcnt vmcnt(0)
  v_readfirstlane_b32 s41, v2
  s_cmp_ge_u32 s41, 8
  s_cbranch_scc1 fr_p2ok
  s_sleep 2
  s_add_u32 s60, s60, 1
  s_cmp_lt_u32 s60, 40000
  s_cbranch_scc1 fr_p2
fr_p2ok:
  buffer_load_dwordx4 v[236:239], v8, s[16:19], s43 offen offset:0 sc1
  buffer_load_dwordx4 v[240:243], v8, s[16:19], s43 offen offset:64 sc1
  buffer_load_dwordx4 v[244:247], v8, s[16:19], s43 offen offset:128 sc1
  buffer_load_dwordx4 v[248:251], v8, s[16:19], s43 offen offset:192 sc1
  s_mov_b32 s38, 0
  s_mov_b32 s39, -1
  s_waitcnt vmcnt(3)
  v_mfma_f32_32x32x16_bf16 v[44:59], v[236:239], v[140:143], 0
  s_waitcnt vmcnt(2)
  v_mfma_f32_32x32x16_bf16 v[44:59], v[240:243], v[144:147], v[44:59]
  s_waitcnt vmcnt(1)
  v_mfma_f32_32x32x16_bf16 v[44:59], v[244:247], v[148:151], v[44:59]
  s_waitcnt vmcnt(0)
  v_mfma_f32_32x32x16_bf16 v[44:59], v[248:251], v[152:155], v[44:59]
  s_nop 15
  v_cndmask_b32 v44, v44, v45, s[38:39]
  buffer_store_dword v44, v12, s[16:19], s42 offen
fr_hend:
  s_endpgm
.globl fused_kernel
.p2align 8
.type fused_kernel,@function
fused_kernel:
  s_cmp_ge_u32 s2, 256
  s_cbranch_scc1 f_end
  s_load_dwordx2 s[62:63], s[0:1], 40
  s_load_dwordx2 s[64:65], s[0:1], 48
  s_load_dwordx2 s[8:9], s[0:1], 88
  s_load_dwordx2 s[12:13], s[0:1], 0
  s_load_dwordx2 s[16:17], s[0:1], 72
  s_load_dwordx2 s[4:5], s[0:1], 32
  s_mov_b32 s10, 33554432
  s_mov_b32 s11, 0x00020000
  s_mov_b32 s14, 2097152
  s_mov_b32 s15, 0x00020000
  s_mov_b32 s18, 2097152
  s_mov_b32 s19, 0x00020000
  s_mov_b32 s6, 1409024
  s_mov_b32 s7, 0x00020000
  s_waitcnt lgkmcnt(0)
  s_getreg_b32 s20, hwreg(HW_REG_XCC_ID, 0, 4)
  s_and_b32 s20, s20, 7
  s_getreg_b32 s21, hwreg(HW_REG_HW_ID, 8, 8)
  s_lshl_b32 s21, s21, 2
  s_lshl_b32 s26, s20, 10
  s_add_u32 s21, s21, s26
  s_add_u32 s21, s21, 2621440
  s_load_dword s21, s[8:9], s21
  v_and_b32 v1, 63, v0
  v_lshrrev_b32 v2, 6, v0
  v_lshlrev_b32 v3, 4, v1
  v_readfirstlane_b32 s22, v2
  s_lshl_b32 s23, s20, 12
  s_add_u32 s23, s23, 32768
  s_mov_b32 s25, 0
  v_mov_b32 v115, 0
  s_waitcnt lgkmcnt(0)
  s_and_b32 s21, s21, 31
  s_cmp_eq_u32 s22, 0
  s_cbranch_scc0 f_start
  s_lshl_b32 s26, 1, s21
  v_mov_b32 v119, s26
  s_mov_b64 exec, 1
  buffer_atomic_or v119, v115, s[8:11], s23 offen sc0
  s_mov_b64 exec, -1
f_start:
  s_lshl_b32 s27, s20, 3
  s_add_u32 s27, s27, s22
  s_lshl_b32 s28, s21, 16
  s_lshl_b32 s29, s27, 10
  s_add_u32 s29, s29, s28
  s_add_u32 s29, s29, 3145728
  buffer_load_dwordx4 v[4:7], v3, s[8:11], s29 offen
  s_lshl_b32 s30, s22, 10
  s_add_u32 s31, s28, s30
  s_add_u32 s31, s31, 5242880
  s_add_u32 s32, s31, 0x200000
  s_add_u32 m0, s30, 0
  s_add_u32 s33, s31, 0
  buffer_load_dwordx4 v3, s[8:11], s33 offen lds
  s_add_u32 m0, s30, 65536
  s_add_u32 s33, s32, 0
  buffer_load_dwordx4 v3, s[8:11], s33 offen lds
  s_and_b32 s38, s22, 3
  s_lshl_b32 s38, s38, 11
  s_add_u32 s39, s28, s38
  s_add_u32 s39, s39, 5242880
  v_and_b32 v109, 11, v0
  v_cmp_eq_u32 vcc, 0, v109
  v_mov_b32 v111, 0x3f803f80
  s_movk_i32 s33, 176
  v_cmp_gt_u32 s[34:35], s33, v0
  s_and_b64 vcc, vcc, s[34:35]
  s_nop 1
  v_cndmask_b32 v110, 0, v111, vcc
  v_cndmask_b32 v112, 0, v111, vcc
  v_cndmask_b32 v113, 0, v111, vcc
  v_cndmask_b32 v111, 0, v111, vcc
  v_lshlrev_b32 v109, 4, v0
  v_add_u32 v114, 160768, v109
  v_add_u32 v109, 131072, v109
  v_cndmask_b32 v109, v114, v109, s[34:35]
  v_cmp_gt_u32 vcc, 184, v0
  s_and_saveexec_b64 s[34:35], vcc
  ds_write_b128 v109, v[110:113]
  s_mov_b64 exec, s[34:35]
  v_lshrrev_b32 v109, 5, v1
  v_and_b32 v110, 15, v1
  v_lshlrev_b32 v110, 4, v110
  v_lshl_add_u32 v111, v109, 8, v110
  v_add_u32 v111, 65536, v111
  v_add_u32 v112, 131072, v110
  v_and_b32 v113, 16, v1
  v_cmp_eq_u32 vcc, 0, v113
  v_mov_b32 v113, 2048
  s_nop 1
  v_cndmask_b32 v114, v112, v111, vcc
  v_cndmask_b32 v106, 0, v113, vcc
  s_lshr_b32 s40, s21, 3
  s_and_b32 s41, s21, 7
  s_and_b32 s42, s22, 3
  s_lshr_b32 s43, s22, 2
  s_lshl_b32 s44, s20, 3
  s_lshl_b32 s45, s43, 2
  s_add_u32 s45, s45, s40
  s_add_u32 s44, s44, s45
  s_lshl_b32 s46, s41, 2
  s_add_u32 s46, s46, s42
  s_mul_i32 s47, s21, 3
  s_min_u32 s47, s47, 83
  s_lshl_b32 s48, s41, 16
  s_lshl_b32 s49, s42, 13
  s_add_u32 s48, s48, s49
  s_add_u32 s48, s48, 19922944
  s_lshr_b32 s49, s42, 1
  s_lshl_b32 s49, s49, 15
  s_add_u32 s48, s48, s49
  s_xor_b32 s53, s48, 0x8000
  s_and_b32 s49, s42, 1
  s_lshl_b32 s49, s49, 8
  v_xor_b32 v2, s49, v3
  s_lshl_b32 s49, s44, 15
  s_lshl_b32 s50, s46, 5
  s_add_u32 s49, s49, s50
  s_lshl_b32 s50, s46, 6
  s_lshl_b32 s51, s47, 15
  s_add_u32 s51, s51, 23068672
  s_mul_i32 s52, s41, 176128
  s_add_u32 s52, s52, 20447232
  v_and_b32 v116, 31, v1
  v_lshlrev_b32 v116, 10, v116
  v_lshl_add_u32 v116, v109, 3, v116
  v_lshlrev_b32 v117, 4, v109
  s_cmp_ge_u32 s22, 4
  s_cbranch_scc1 f_nb1
  s_add_u32 m0, s38, 8192
  s_add_u32 s33, s39, 8192
  buffer_load_dwordx4 v3, s[8:11], s33 offen offset:0 lds
  buffer_load_dwordx4 v3, s[8:11], s33 offen offset:1024 lds
  s_add_u32 m0, s38, 73728
  s_add_u32 s33, s39, 2105344
  buffer_load_dwordx4 v3, s[8:11], s33 offen offset:0 lds
  buffer_load_dwordx4 v3, s[8:11], s33 offen offset:1024 lds
  s_waitcnt vmcnt(4)
  s_branch f_nb2
f_nb1:
  s_waitcnt vmcnt(0)
f_nb2:
  s_cmp_eq_u32 s22, 0
  s_cbranch_scc0 f_cl2
  s_mov_b32 s26, s21
  s_cmp_eq_u32 s25, 0
  s_cbranch_scc0 f_cl1
f_cl0:
  v_readfirstlane_b32 s33, v119
  s_bitcmp1_b32 s33, s26
  s_cbranch_scc0 f_cl1
  s_ff0_i32_b32 s26, s33
  s_cmp_lt_i32 s26, 0
  s_cbranch_scc1 f_cl1
  s_lshl_b32 s33, 1, s26
  v_mov_b32 v119, s33
  s_mov_b64 exec, 1
  buffer_atomic_or v119, v115, s[8:11], s23 offen sc0
  s_mov_b64 exec, -1
  s_waitcnt vmcnt(0)
  s_branch f_cl0
f_cl1:
  v_mov_b32 v118, s26
  v_mov_b32 v119, 163712
  ds_write_b32 v119, v118
f_cl2:
  v_mov_b32 v119, 163712
  s_waitcnt lgkmcnt(0)
  s_barrier
  ds_read_b32 v118, v119
  s_waitcnt lgkmcnt(0)
  v_readfirstlane_b32 s26, v118
  s_cmp_eq_u32 s26, s21
  s_cbranch_scc1 f_go
  s_cmp_lt_i32 s26, 0
  s_cbranch_scc1 f_end
  s_mov_b32 s21, s26
  s_mov_b32 s25, 1
  s_waitcnt vmcnt(0)
  s_barrier
  s_branch f_start
f_go:
  s_add_u32 s36, s51, s38
  v_lshlrev_b32 v118, 2, v1
  s_lshl_b32 s33, s22, 2
  s_add_u32 s33, s33, 163584
  v_mov_b32 v109, s33
  v_and_b32 v110, 28, v118
  v_add_u32 v110, 163584, v110
  v_and_b32 v111, -17, v110
  s_setprio 1
  s_cmp_ge_u32 s22, 4
  s_cbranch_scc1 f_nb4
  s_setprio 3
f_nb4:
  v_mov_b32 v107, 0xff800000
  ds_read_b128 v[80:83], v3
  v_mov_b32 v105, v114
  ds_read_b128 v[84:87], v3 offset:1024
  ds_read_b128 v[88:91], v105
  ds_read_b128 v[92:95], v105 offset:512
  s_waitcnt lgkmcnt(3)
  v_mfma_f32_32x32x16_bf16 v[24:39], v[80:83], v[4:7], 0
  s_nop 11
  v_max3_f32 v107, v24, v25, v107
  v_max3_f32 v107, v26, v27, v107
  v_max3_f32 v107, v28, v29, v107
  v_max3_f32 v107, v30, v31, v107
  v_max3_f32 v107, v32, v33, v107
  v_max3_f32 v107, v34, v35, v107
  v_max3_f32 v107, v36, v37, v107
  v_max3_f32 v107, v38, v39, v107
  v_mov_b32 v108, v107
  s_nop 1
  v_permlane32_swap_b32 v107, v108
  v_max_f32 v107, v107, v108
  v_sub_f32 v8, 0, v107
  v_sub_f32 v9, 0, v107
  v_sub_f32 v10, 0, v107
  v_sub_f32 v11, 0, v107
  v_sub_f32 v12, 0, v107
  v_sub_f32 v13, 0, v107
  v_sub_f32 v14, 0, v107
  v_sub_f32 v15, 0, v107
  v_sub_f32 v16, 0, v107
  v_sub_f32 v17, 0, v107
  v_sub_f32 v18, 0, v107
  v_sub_f32 v19, 0, v107
  v_sub_f32 v20, 0, v107
  v_sub_f32 v21, 0, v107
  v_sub_f32 v22, 0, v107
  v_sub_f32 v23, 0, v107
  v_mov_b32 v64, 0
  v_mov_b32 v65, 0
  v_mov_b32 v66, 0
  v_mov_b32 v67, 0
  v_mov_b32 v68, 0
  v_mov_b32 v69, 0
  v_mov_b32 v70, 0
  v_mov_b32 v71, 0
  v_mov_b32 v72, 0
  v_mov_b32 v73, 0
  v_mov_b32 v74, 0
  v_mov_b32 v75, 0
  v_mov_b32 v76, 0
  v_mov_b32 v77, 0
  v_mov_b32 v78, 0
  v_mov_b32 v79, 0
  s_nop 1
  v_mfma_f32_32x32x16_bf16 v[24:39], v[80:83], v[4:7], v[8:23]
  s_branch attn_fast
attn_slow:
  v_mov_b32 v107, 0xff800000
  s_sub_u32 s62, s31, s30
  s_mov_b32 s61, 0
attn_smax:
  buffer_load_dwordx4 v[80:83], v3, s[8:11], s62 offen
  s_add_u32 s62, s62, 1024
  s_waitcnt vmcnt(0)
  v_mfma_f32_32x32x16_bf16 v[24:39], v[80:83], v[4:7], 0
  s_add_u32 s61, s61, 1
  s_nop 11
  v_max3_f32 v107, v24, v25, v107
  v_max3_f32 v107, v26, v27, v107
  v_max3_f32 v107, v28, v29, v107
  v_max3_f32 v107, v30, v31, v107
  v_max3_f32 v107, v32, v33, v107
  v_max3_f32 v107, v34, v35, v107
  v_max3_f32 v107, v36, v37, v107
  v_max3_f32 v107, v38, v39, v107
  s_cmp_lt_u32 s61, 64
  s_cbranch_scc1 attn_smax
  v_mov_b32 v108, v107
  s_nop 1
  v_permlane32_swap_b32 v107, v108
  v_max_f32 v107, v107, v108
  v_sub_f32 v8, 0, v107
  v_sub_f32 v9, 0, v107
  v_sub_f32 v10, 0, v107
  v_sub_f32 v11, 0, v107
  v_sub_f32 v12, 0, v107
  v_sub_f32 v13, 0, v107
  v_sub_f32 v14, 0, v107
  v_sub_f32 v15, 0, v107
  v_sub_f32 v16, 0, v107
  v_sub_f32 v17, 0, v107
  v_sub_f32 v18, 0, v107
  v_sub_f32 v19, 0, v107
  v_sub_f32 v20, 0, v107
  v_sub_f32 v21, 0, v107
  v_sub_f32 v22, 0, v107
  v_sub_f32 v23, 0, v107
  v_mov_b32 v64, 0
  v_mov_b32 v65, 0
  v_mov_b32 v66, 0
  v_mov_b32 v67, 0
  v_mov_b32 v68, 0
  v_mov_b32 v69, 0
  v_mov_b32 v70, 0
  v_mov_b32 v71, 0
  v_mov_b32 v72, 0
  v_mov_b32 v73, 0
  v_mov_b32 v74, 0
  v_mov_b32 v75, 0
  v_mov_b32 v76, 0
  v_mov_b32 v77, 0
  v_mov_b32 v78, 0
  v_mov_b32 v79, 0
  v_lshrrev_b32 v104, 5, v1
  v_and_b32 v105, 15, v1
  v_lshlrev_b32 v105, 4, v105
  v_lshl_add_u32 v105, v104, 8, v105
  s_sub_u32 s62, s31, s30
  s_sub_u32 s63, s32, s30
  s_mov_b32 s61, 0
attn_sloop:
  buffer_load_dwordx4 v[80:83], v3, s[8:11], s62 offen
  s_mov_b32 exec_lo, 0xffff
  s_mov_b32 exec_hi, 0xffff
  buffer_load_dwordx4 v[88:91], v105, s[8:11], s63 offen
  buffer_load_dwordx4 v[92:95], v105, s[8:11], s63 offen offset:512
  s_mov_b64 exec, -1
  s_add_u32 s62, s62, 1024
  s_add_u32 s63, s63, 1024
  s_waitcnt vmcnt(0)
  v_mfma_f32_32x32x16_bf16 v[24:39], v[80:83], v[4:7], v[8:23]
  s_add_u32 s61, s61, 1
  s_nop 11
  v_exp_f32 v24, v24
  v_exp_f32 v25, v25
  v_exp_f32 v26, v26
  v_exp_f32 v27, v27
  v_exp_f32 v28, v28
  v_exp_f32 v29, v29
  v_exp_f32 v30, v30
  v_exp_f32 v31, v31
  v_exp_f32 v32, v32
  v_exp_f32 v33, v33
  v_exp_f32 v34, v34
  v_exp_f32 v35, v35
  v_exp_f32 v36, v36
  v_exp_f32 v37, v37
  v_exp_f32 v38, v38
  v_exp_f32 v39, v39
  s_nop 0
  v_cvt_pk_bf16_f32 v56, v24, v25
  v_cvt_pk_bf16_f32 v57, v26, v27
  v_cvt_pk_bf16_f32 v58, v28, v29
  v_cvt_pk_bf16_f32 v59, v30, v31
  v_cvt_pk_bf16_f32 v60, v32, v33
  v_cvt_pk_bf16_f32 v61, v34, v35
  v_cvt_pk_bf16_f32 v62, v36, v37
  v_cvt_pk_bf16_f32 v63, v38, v39
  s_nop 1
  v_mfma_f32_32x32x16_bf16 v[64:79], v[88:91], v[56:59], v[64:79]
  v_mfma_f32_32x32x16_bf16 v[64:79], v[92:95], v[60:63], v[64:79]
  s_nop 7
  s_cmp_lt_u32 s61, 64
  s_cbranch_scc1 attn_sloop
  s_nop 11
  s_branch attn_fin
attn_fast:
  ds_read_b128 v[80:83], v3 offset:2048
  s_nop 5
  s_waitcnt lgkmcnt(3)
  v_exp_f32 v24, v24
  v_exp_f32 v25, v25
  v_exp_f32 v26, v26
  v_exp_f32 v27, v27
  v_cvt_pk_bf16_f32 v56, v24, v25
  v_exp_f32 v28, v28
  v_exp_f32 v29, v29
  v_cvt_pk_bf16_f32 v57, v26, v27
  ds_read_b128 v[96:99], v105 offset:1024
  ds_read_b128 v[100:103], v105 offset:1536
  v_exp_f32 v30, v30
  v_exp_f32 v31, v31
  v_cvt_pk_bf16_f32 v58, v28, v29
  v_exp_f32 v32, v32
  v_exp_f32 v33, v33
  v_cvt_pk_bf16_f32 v59, v30, v31
  v_mfma_f32_32x32x16_bf16 v[40:55], v[84:87], v[4:7], v[8:23]
  ds_read_b128 v[84:87], v3 offset:3072
  v_exp_f32 v34, v34
  v_exp_f32 v35, v35
  v_cvt_pk_bf16_f32 v60, v32, v33
  v_exp_f32 v36, v36
  v_exp_f32 v37, v37
  v_cvt_pk_bf16_f32 v61, v34, v35
  s_cmp_ge_u32 s22, 4
  s_cbranch_scc1 fused_kernel_g_1
  s_add_u32 m0, s38, 16384
  s_add_u32 s33, s39, 16384
  buffer_load_dwordx4 v3, s[8:11], s33 offen lds
fused_kernel_g_1:
  v_exp_f32 v38, v38
  v_exp_f32 v39, v39
  v_cvt_pk_bf16_f32 v62, v36, v37
  v_cvt_pk_bf16_f32 v63, v38, v39
  s_waitcnt lgkmcnt(3)
  s_cmp_lt_u32 s22, 4
  s_cbranch_scc1 fused_kernel_g_2
  v_mov_b32 v112, 8
  s_mov_b64 exec, 1
  ds_write_b32 v109, v112 offset:64
  s_mov_b64 exec, -1
fused_kernel_g_2:
  v_exp_f32 v40, v40
  v_exp_f32 v41, v41
  v_mfma_f32_32x32x16_bf16 v[64:79], v[88:91], v[56:59], v[64:79]
  v_exp_f32 v42, v42
  v_exp_f32 v43, v43
  v_cvt_pk_bf16_f32 v56, v40, v41
  v_exp_f32 v44, v44
  v_exp_f32 v45, v45
  v_cvt_pk_bf16_f32 v57, v42, v43
  v_mfma_f32_32x32x16_bf16 v[64:79], v[92:95], v[60:63], v[64:79]
  ds_read_b128 v[88:91], v105 offset:2048
  ds_read_b128 v[92:95], v105 offset:2560
  v_exp_f32 v46, v46
  v_exp_f32 v47, v47
  v_cvt_pk_bf16_f32 v58, v44, v45
  v_exp_f32 v48, v48
  v_exp_f32 v49, v49
  v_cvt_pk_bf16_f32 v59, v46, v47
  v_mfma_f32_32x32x16_bf16 v[24:39], v[80:83], v[4:7], v[8:23]
  ds_read_b128 v[80:83], v3 offset:4096
  v_exp_f32 v50, v50
  v_exp_f32 v51, v51
  v_cvt_pk_bf16_f32 v60, v48, v49
  v_exp_f32 v52, v52
  v_exp_f32 v53, v53
  v_cvt_pk_bf16_f32 v61, v50, v51
  s_cmp_ge_u32 s22, 4
  s_cbranch_scc1 fused_kernel_g_3
  s_add_u32 m0, s38, 17408
  s_add_u32 s33, s39, 17408
  buffer_load_dwordx4 v3, s[8:11], s33 offen lds
fused_kernel_g_3:
  v_exp_f32 v54, v54
  v_exp_f32 v55, v55
  v_cvt_pk_bf16_f32 v62, v52, v53
  v_cvt_pk_bf16_f32 v63, v54, v55
  v_add_u32 v105, v106, v105
  s_waitcnt lgkmcnt(3)
  v_exp_f32 v24, v24
  v_exp_f32 v25, v25
  v_mfma_f32_32x32x16_bf16 v[64:79], v[96:99], v[56:59], v[64:79]
  v_exp_f32 v26, v26
  v_exp_f32 v27, v27
  v_cvt_pk_bf16_f32 v56, v24, v25
  v_exp_f32 v28, v28
  v_exp_f32 v29, v29
  v_cvt_pk_bf16_f32 v57, v26, v27
  v_mfma_f32_32x32x16_bf16 v[64:79], v[100:103], v[60:63], v[64:79]
  ds_read_b128 v[96:99], v105 offset:1024
  ds_read_b128 v[100:103], v105 offset:1536
  v_exp_f32 v30, v30
  v_exp_f32 v31, v31
  v_cvt_pk_bf16_f32 v58, v28, v29
  v_exp_f32 v32, v32
  v_exp_f32 v33, v33
  v_cvt_pk_bf16_f32 v59, v30, v31
  v_mfma_f32_32x32x16_bf16 v[40:55], v[84:87], v[4:7], v[8:23]
  ds_read_b128 v[84:87], v3 offset:5120
  v_exp_f32 v34, v34
  v_exp_f32 v35, v35
  v_cvt_pk_bf16_f32 v60, v32, v33
  v_exp_f32 v36, v36
  v_exp_f32 v37, v37
  v_cvt_pk_bf16_f32 v61, v34, v35
  s_cmp_ge_u32 s22, 4
  s_cbranch_scc1 fused_kernel_g_4
  s_add_u32 m0, s38, 81920
  s_add_u32 s33, s39, 2113536
  buffer_load_dwordx4 v3, s[8:11], s33 offen lds
fused_kernel_g_4:
  v_exp_f32 v38, v38
  v_exp_f32 v39, v39
  v_cvt_pk_bf16_f32 v62, v36, v37
  v_cvt_pk_bf16_f32 v63, v38, v39
  s_waitcnt lgkmcnt(3)
  s_cmp_ge_u32 s22, 4
  s_cbranch_scc1 fused_kernel_g_5
  s_waitcnt vmcnt(3)
  v_mov_b32 v112, 1
  s_mov_b64 exec, 1
  ds_write_b32 v109, v112 offset:64
  s_mov_b64 exec, -1
fused_kernel_g_5:
  v_exp_f32 v40, v40
  v_exp_f32 v41, v41
  v_mfma_f32_32x32x16_bf16 v[64:79], v[88:91], v[56:59], v[64:79]
  v_exp_f32 v42, v42
  v_exp_f32 v43, v43
  v_cvt_pk_bf16_f32 v56, v40, v41
  v_exp_f32 v44, v44
  v_exp_f32 v45, v45
  v_cvt_pk_bf16_f32 v57, v42, v43
  v_mfma_f32_32x32x16_bf16 v[64:79], v[92:95], v[60:63], v[64:79]
  ds_read_b128 v[88:91], v105 offset:2048
  ds_read_b128 v[92:95], v105 offset:2560
  v_exp_f32 v46, v46
  v_exp_f32 v47, v47
  v_cvt_pk_bf16_f32 v58, v44, v45
  v_exp_f32 v48, v48
  v_exp_f32 v49, v49
  v_cvt_pk_bf16_f32 v59, v46, v47
  v_mfma_f32_32x32x16_bf16 v[24:39], v[80:83], v[4:7], v[8:23]
  ds_read_b128 v[80:83], v3 offset:6144
  v_exp_f32 v50, v50
  v_exp_f32 v51, v51
  v_cvt_pk_bf16_f32 v60, v48, v49
  v_exp_f32 v52, v52
  v_exp_f32 v53, v53
  v_cvt_pk_bf16_f32 v61, v50, v51
  s_cmp_ge_u32 s22, 4
  s_cbranch_scc1 fused_kernel_g_6
  s_add_u32 m0, s38, 82944
  s_add_u32 s33, s39, 2114560
  buffer_load_dwordx4 v3, s[8:11], s33 offen lds
fused_kernel_g_6:
  v_exp_f32 v54, v54
  v_exp_f32 v55, v55
  v_cvt_pk_bf16_f32 v62, v52, v53
  v_cvt_pk_bf16_f32 v63, v54, v55
  v_add_u32 v105, v106, v105
  s_waitcnt lgkmcnt(3)
  v_exp_f32 v24, v24
  v_exp_f32 v25, v25
  v_mfma_f32_32x32x16_bf16 v[64:79], v[96:99], v[56:59], v[64:79]
  v_exp_f32 v26, v26
  v_exp_f32 v27, v27
  v_cvt_pk_bf16_f32 v56, v24, v25
  ds_read_b32 v113, v111 offset:64
  v_exp_f32 v28, v28
  v_exp_f32 v29, v29
  v_cvt_pk_bf16_f32 v57, v26, v27
  v_mfma_f32_32x32x16_bf16 v[64:79], v[100:103], v[60:63], v[64:79]
  ds_read_b128 v[96:99], v105 offset:1024
  ds_read_b128 v[100:103], v105 offset:1536
  v_exp_f32 v30, v30
  v_exp_f32 v31, v31
  v_cvt_pk_bf16_f32 v58, v28, v29
  v_exp_f32 v32, v32
  v_exp_f32 v33, v33
  v_cvt_pk_bf16_f32 v59, v30, v31
  v_mfma_f32_32x32x16_bf16 v[40:55], v[84:87], v[4:7], v[8:23]
  ds_read_b128 v[84:87], v3 offset:7168
  v_exp_f32 v34, v34
  v_exp_f32 v35, v35
  v_cvt_pk_bf16_f32 v60, v32, v33
  v_exp_f32 v36, v36
  v_exp_f32 v37, v37
  v_cvt_pk_bf16_f32 v61, v34, v35
  s_cmp_ge_u32 s22, 4
  s_cbranch_scc1 fused_kernel_g_7
  s_add_u32 m0, s38, 24576
  s_add_u32 s33, s39, 24576
  buffer_load_dwordx4 v3, s[8:11], s33 offen lds
fused_kernel_g_7:
  v_exp_f32 v38, v38
  v_exp_f32 v39, v39
  v_cvt_pk_bf16_f32 v62, v36, v37
  v_cvt_pk_bf16_f32 v63, v38, v39
  s_waitcnt lgkmcnt(3)
  v_cmp_gt_u32 vcc, 1, v113
  s_cmp_eq_u64 vcc, 0
  s_cbranch_scc1 fused_kernel_ck_8_ok
  s_mov_b32 s60, 0
fused_kernel_ck_8:
  ds_read_b32 v113, v111 offset:64
  s_waitcnt lgkmcnt(0)
  v_cmp_gt_u32 vcc, 1, v113
  s_cmp_eq_u64 vcc, 0
  s_cbranch_scc1 fused_kernel_ck_8_ok
  s_add_u32 s60, s60, 1
  s_cmp_lt_u32 s60, 640000
  s_cbranch_scc1 fused_kernel_ck_8
fused_kernel_ck_8_ok:
  v_exp_f32 v40, v40
  v_exp_f32 v41, v41
  v_mfma_f32_32x32x16_bf16 v[64:79], v[88:91], v[56:59], v[64:79]
  v_exp_f32 v42, v42
  v_exp_f32 v43, v43
  v_cvt_pk_bf16_f32 v56, v40, v41
  v_exp_f32 v44, v44
  v_exp_f32 v45, v45
  v_cvt_pk_bf16_f32 v57, v42, v43
  v_mfma_f32_32x32x16_bf16 v[64:79], v[92:95], v[60:63], v[64:79]
  ds_read_b128 v[88:91], v105 offset:2048
  ds_read_b128 v[92:95], v105 offset:2560
  v_exp_f32 v46, v46
  v_exp_f32 v47, v47
  v_cvt_pk_bf16_f32 v58, v44, v45
  v_exp_f32 v48, v48
  v_exp_f32 v49, v49
  v_cvt_pk_bf16_f32 v59, v46, v47
  v_mfma_f32_32x32x16_bf16 v[24:39], v[80:83], v[4:7], v[8:23]
  ds_read_b128 v[80:83], v3 offset:8192
  v_exp_f32 v50, v50
  v_exp_f32 v51, v51
  v_cvt_pk_bf16_f32 v60, v48, v49
  v_exp_f32 v52, v52
  v_exp_f32 v53, v53
  v_cvt_pk_bf16_f32 v61, v50, v51
  s_cmp_ge_u32 s22, 4
  s_cbranch_scc1 fused_kernel_g_9
  s_add_u32 m0, s38, 25600
  s_add_u32 s33, s39, 25600
  buffer_load_dwordx4 v3, s[8:11], s33 offen lds
fused_kernel_g_9:
  v_exp_f32 v54, v54
  v_exp_f32 v55, v55
  v_cvt_pk_bf16_f32 v62, v52, v53
  v_cvt_pk_bf16_f32 v63, v54, v55
  v_add_u32 v105, v106, v105
  s_waitcnt lgkmcnt(3)
  v_exp_f32 v24, v24
  v_exp_f32 v25, v25
  v_mfma_f32_32x32x16_bf16 v[64:79], v[96:99], v[56:59], v[64:79]
  v_exp_f32 v26, v26
  v_exp_f32 v27, v27
  v_cvt_pk_bf16_f32 v56, v24, v25
  v_exp_f32 v28, v28
  v_exp_f32 v29, v29
  v_cvt_pk_bf16_f32 v57, v26, v27
  v_mfma_f32_32x32x16_bf16 v[64:79], v[100:103], v[60:63], v[64:79]
  ds_read_b128 v[96:99], v105 offset:1024
  ds_read_b128 v[100:103], v105 offset:1536
  v_exp_f32 v30, v30
  v_exp_f32 v31, v31
  v_cvt_pk_bf16_f32 v58, v28, v29
  v_exp_f32 v32, v32
  v_exp_f32 v33, v33
  v_cvt_pk_bf16_f32 v59, v30, v31
  v_mfma_f32_32x32x16_bf16 v[40:55], v[84:87], v[4:7], v[8:23]
  ds_read_b128 v[84:87], v3 offset:9216
  v_exp_f32 v34, v34
  v_exp_f32 v35, v35
  v_cvt_pk_bf16_f32 v60, v32, v33
  v_exp_f32 v36, v36
  v_exp_f32 v37, v37
  v_cvt_pk_bf16_f32 v61, v34, v35
  s_cmp_ge_u32 s22, 4
  s_cbranch_scc1 fused_kernel_g_10
  s_add_u32 m0, s38, 90112
  s_add_u32 s33, s39, 2121728
  buffer_load_dwordx4 v3, s[8:11], s33 offen lds
fused_kernel_g_10:
  v_exp_f32 v38, v38
  v_exp_f32 v39, v39
  v_cvt_pk_bf16_f32 v62, v36, v37
  v_cvt_pk_bf16_f32 v63, v38, v39
  s_waitcnt lgkmcnt(3)
  v_exp_f32 v40, v40
  v_exp_f32 v41, v41
  v_mfma_f32_32x32x16_bf16 v[64:79], v[88:91], v[56:59], v[64:79]
  v_exp_f32 v42, v42
  v_exp_f32 v43, v43
  v_cvt_pk_bf16_f32 v56, v40, v41
  v_exp_f32 v44, v44
  v_exp_f32 v45, v45
  v_cvt_pk_bf16_f32 v57, v42, v43
  v_mfma_f32_32x32x16_bf16 v[64:79], v[92:95], v[60:63], v[64:79]
  ds_read_b128 v[88:91], v105 offset:2048
  ds_read_b128 v[92:95], v105 offset:2560
  v_exp_f32 v46, v46
  v_exp_f32 v47, v47
  v_cvt_pk_bf16_f32 v58, v44, v45
  v_exp_f32 v48, v48
  v_exp_f32 v49, v49
  v_cvt_pk_bf16_f32 v59, v46, v47
  v_mfma_f32_32x32x16_bf16 v[24:39], v[80:83], v[4:7], v[8:23]
  ds_read_b128 v[80:83], v3 offset:10240
  v_exp_f32 v50, v50
  v_exp_f32 v51, v51
  v_cvt_pk_bf16_f32 v60, v48, v49
  v_exp_f32 v52, v52
  v_exp_f32 v53, v53
  v_cvt_pk_bf16_f32 v61, v50, v51
  s_cmp_ge_u32 s22, 4
  s_cbranch_scc1 fused_kernel_g_11
  s_add_u32 m0, s38, 91136
  s_add_u32 s33, s39, 2122752
  buffer_load_dwordx4 v3, s[8:11], s33 offen lds
fused_kernel_g_11:
  v_exp_f32 v54, v54
  v_exp_f32 v55, v55
  v_cvt_pk_bf16_f32 v62, v52, v53
  v_cvt_pk_bf16_f32 v63, v54, v55
  v_add_u32 v105, v106, v105
  s_waitcnt lgkmcnt(3)
  v_mov_b32 v112, 1
  s_mov_b64 exec, 1
  ds_write_b32 v109, v112 offset:0
  s_mov_b64 exec, -1
  v_exp_f32 v24, v24
  v_exp_f32 v25, v25
  v_mfma_f32_32x32x16_bf16 v[64:79], v[96:99], v[56:59], v[64:79]
  v_exp_f32 v26, v26
  v_exp_f32 v27, v27
  v_cvt_pk_bf16_f32 v56, v24, v25
  v_exp_f32 v28, v28
  v_exp_f32 v29, v29
  v_cvt_pk_bf16_f32 v57, v26, v27
  v_mfma_f32_32x32x16_bf16 v[64:79], v[100:103], v[60:63], v[64:79]
  ds_read_b128 v[96:99], v105 offset:1024
  ds_read_b128 v[100:103], v105 offset:1536
  v_exp_f32 v30, v30
  v_exp_f32 v31, v31
  v_cvt_pk_bf16_f32 v58, v28, v29
  v_exp_f32 v32, v32
  v_exp_f32 v33, v33
  v_cvt_pk_bf16_f32 v59, v30, v31
  v_mfma_f32_32x32x16_bf16 v[40:55], v[84:87], v[4:7], v[8:23]
  ds_read_b128 v[84:87], v3 offset:11264
  v_exp_f32 v34, v34
  v_exp_f32 v35, v35
  v_cvt_pk_bf16_f32 v60, v32, v33
  v_exp_f32 v36, v36
  v_exp_f32 v37, v37
  v_cvt_pk_bf16_f32 v61, v34, v35
  s_cmp_lt_u32 s22, 4
  s_cbranch_scc1 fused_kernel_g_12_a
  s_lshl_b32 s33, s47, 11
  v_bfe_u32 v246, v1, 4, 1
  v_lshlrev_b32 v246, 7, v246
  v_lshl_add_u32 v246, v117, 2, v246
  v_and_b32 v247, 15, v1
  v_lshl_add_u32 v246, v247, 2, v246
  s_add_u32 s33, s33, 29360128
  buffer_load_dword v204, v246, s[8:11], s33 offen offset:0
  buffer_load_dword v205, v246, s[8:11], s33 offen offset:256
  buffer_load_dword v206, v246, s[8:11], s33 offen offset:512
  buffer_load_dword v207, v246, s[8:11], s33 offen offset:768
  buffer_load_dword v208, v246, s[8:11], s33 offen offset:1024
  buffer_load_dword v209, v246, s[8:11], s33 offen offset:1280
  buffer_load_dword v210, v246, s[8:11], s33 offen offset:1536
  buffer_load_dword v211, v246, s[8:11], s33 offen offset:1792
  s_branch fused_kernel_g_12
fused_kernel_g_12_a:
  s_add_u32 m0, s38, 32768
  s_add_u32 s33, s39, 32768
  buffer_load_dwordx4 v3, s[8:11], s33 offen lds
fused_kernel_g_12:
  v_exp_f32 v38, v38
  v_exp_f32 v39, v39
  v_cvt_pk_bf16_f32 v62, v36, v37
  v_cvt_pk_bf16_f32 v63, v38, v39
  s_waitcnt lgkmcnt(4)
  v_exp_f32 v40, v40
  v_exp_f32 v41, v41
  v_mfma_f32_32x32x16_bf16 v[64:79], v[88:91], v[56:59], v[64:79]
  v_exp_f32 v42, v42
  v_exp_f32 v43, v43
  v_cvt_pk_bf16_f32 v56, v40, v41
  ds_read_b32 v113, v110 offset:0
  v_exp_f32 v44, v44
  v_exp_f32 v45, v45
  v_cvt_pk_bf16_f32 v57, v42, v43
  v_mfma_f32_32x32x16_bf16 v[64:79], v[92:95], v[60:63], v[64:79]
  ds_read_b128 v[88:91], v105 offset:2048
  ds_read_b128 v[92:95], v105 offset:2560
  v_exp_f32 v46, v46
  v_exp_f32 v47, v47
  v_cvt_pk_bf16_f32 v58, v44, v45
  v_exp_f32 v48, v48
  v_exp_f32 v49, v49
  v_cvt_pk_bf16_f32 v59, v46, v47
  v_mfma_f32_32x32x16_bf16 v[24:39], v[80:83], v[4:7], v[8:23]
  ds_read_b128 v[80:83], v3 offset:12288
  v_exp_f32 v50, v50
  v_exp_f32 v51, v51
  v_cvt_pk_bf16_f32 v60, v48, v49
  v_exp_f32 v52, v52
  v_exp_f32 v53, v53
  v_cvt_pk_bf16_f32 v61, v50, v51
  s_cmp_lt_u32 s22, 4
  s_cbranch_scc1 fused_kernel_g_13_a
  s_lshl_b32 s33, s47, 11
  v_bfe_u32 v246, v1, 4, 1
  v_lshlrev_b32 v246, 7, v246
  v_lshl_add_u32 v246, v117, 2, v246
  v_and_b32 v247, 15, v1
  v_lshl_add_u32 v246, v247, 2, v246
  s_add_u32 s33, s33, 29362176
  buffer_load_dword v212, v246, s[8:11], s33 offen offset:0
  buffer_load_dword v213, v246, s[8:11], s33 offen offset:256
  buffer_load_dword v214, v246, s[8:11], s33 offen offset:512
  buffer_load_dword v215, v246, s[8:11], s33 offen offset:768
  buffer_load_dword v216, v246, s[8:11], s33 offen offset:1024
  buffer_load_dword v217, v246, s[8:11], s33 offen offset:1280
  buffer_load_dword v218, v246, s[8:11], s33 offen offset:1536
  buffer_load_dword v219, v246, s[8:11], s33 offen offset:1792
  s_branch fused_kernel_g_13
fused_kernel_g_13_a:
  s_add_u32 m0, s38, 33792
  s_add_u32 s33, s39, 33792
  buffer_load_dwordx4 v3, s[8:11], s33 offen lds
fused_kernel_g_13:
  v_exp_f32 v54, v54
  v_exp_f32 v55, v55
  v_cvt_pk_bf16_f32 v62, v52, v53
  v_cvt_pk_bf16_f32 v63, v54, v55
  v_add_u32 v105, v106, v105
  s_waitcnt lgkmcnt(3)
  s_cmp_lt_u32 s22, 4
  s_cbranch_scc1 fused_kernel_g_14
  v_cmp_gt_u32 vcc, 1, v113
  s_cmp_eq_u64 vcc, 0
  s_cbranch_scc1 fused_kernel_ck_15_ok
  s_mov_b32 s60, 0
fused_kernel_ck_15:
  ds_read_b32 v113, v110 offset:0
  s_waitcnt lgkmcnt(0)
  v_cmp_gt_u32 vcc, 1, v113
  s_cmp_eq_u64 vcc, 0
  s_cbranch_scc1 fused_kernel_ck_15_ok
  s_add_u32 s60, s60, 1
  s_cmp_lt_u32 s60, 640000
  s_cbranch_scc1 fused_kernel_ck_15
fused_kernel_ck_15_ok:
fused_kernel_g_14:
  v_exp_f32 v24, v24
  v_exp_f32 v25, v25
  v_mfma_f32_32x32x16_bf16 v[64:79], v[96:99], v[56:59], v[64:79]
  v_exp_f32 v26, v26
  v_exp_f32 v27, v27
  v_cvt_pk_bf16_f32 v56, v24, v25
  v_exp_f32 v28, v28
  v_exp_f32 v29, v29
  v_cvt_pk_bf16_f32 v57, v26, v27
  v_mfma_f32_32x32x16_bf16 v[64:79], v[100:103], v[60:63], v[64:79]
  ds_read_b128 v[96:99], v105 offset:1024
  ds_read_b128 v[100:103], v105 offset:1536
  v_exp_f32 v30, v30
  v_exp_f32 v31, v31
  v_cvt_pk_bf16_f32 v58, v28, v29
  v_exp_f32 v32, v32
  v_exp_f32 v33, v33
  v_cvt_pk_bf16_f32 v59, v30, v31
  v_mfma_f32_32x32x16_bf16 v[40:55], v[84:87], v[4:7], v[8:23]
  ds_read_b128 v[84:87], v3 offset:13312
  v_exp_f32 v34, v34
  v_exp_f32 v35, v35
  v_cvt_pk_bf16_f32 v60, v32, v33
  v_exp_f32 v36, v36
  v_exp_f32 v37, v37
  v_cvt_pk_bf16_f32 v61, v34, v35
  s_cmp_lt_u32 s22, 4
  s_cbranch_scc1 fused_kernel_g_16_a
  s_lshl_b32 s33, s47, 11
  v_bfe_u32 v246, v1, 4, 1
  v_lshlrev_b32 v246, 7, v246
  v_lshl_add_u32 v246, v117, 2, v246
  v_and_b32 v247, 15, v1
  v_lshl_add_u32 v246, v247, 2, v246
  s_add_u32 s33, s33, 29364224
  buffer_load_dword v220, v246, s[8:11], s33 offen offset:0
  buffer_load_dword v221, v246, s[8:11], s33 offen offset:256
  buffer_load_dword v222, v246, s[8:11], s33 offen offset:512
  buffer_load_dword v223, v246, s[8:11], s33 offen offset:768
  buffer_load_dword v224, v246, s[8:11], s33 offen offset:1024
  buffer_load_dword v225, v246, s[8:11], s33 offen offset:1280
  buffer_load_dword v226, v246, s[8:11], s33 offen offset:1536
  buffer_load_dword v227, v246, s[8:11], s33 offen offset:1792
  s_add_u32 m0, s38, 0
  s_add_u32 s33, s36, 0
  buffer_load_dwordx4 v3, s[8:11], s33 offen offset:0 lds
  buffer_load_dwordx4 v3, s[8:11], s33 offen offset:1024 lds
  s_branch fused_kernel_g_16
fused_kernel_g_16_a:
  s_add_u32 m0, s38, 98304
  s_add_u32 s33, s39, 2129920
  buffer_load_dwordx4 v3, s[8:11], s33 offen lds
fused_kernel_g_16:
  v_exp_f32 v38, v38
  v_exp_f32 v39, v39
  v_cvt_pk_bf16_f32 v62, v36, v37
  v_cvt_pk_bf16_f32 v63, v38, v39
  s_waitcnt lgkmcnt(3)
  s_cmp_ge_u32 s22, 4
  s_cbranch_scc1 fused_kernel_g_17
  s_waitcnt vmcnt(7)
  v_mov_b32 v112, 2
  s_mov_b64 exec, 1
  ds_write_b32 v109, v112 offset:64
  s_mov_b64 exec, -1
fused_kernel_g_17:
  v_exp_f32 v40, v40
  v_exp_f32 v41, v41
  v_mfma_f32_32x32x16_bf16 v[64:79], v[88:91], v[56:59], v[64:79]
  v_exp_f32 v42, v42
  v_exp_f32 v43, v43
  v_cvt_pk_bf16_f32 v56, v40, v41
  v_exp_f32 v44, v44
  v_exp_f32 v45, v45
  v_cvt_pk_bf16_f32 v57, v42, v43
  v_mfma_f32_32x32x16_bf16 v[64:79], v[92:95], v[60:63], v[64:79]
  ds_read_b128 v[88:91], v105 offset:2048
  ds_read_b128 v[92:95], v105 offset:2560
  v_exp_f32 v46, v46
  v_exp_f32 v47, v47
  v_cvt_pk_bf16_f32 v58, v44, v45
  v_exp_f32 v48, v48
  v_exp_f32 v49, v49
  v_cvt_pk_bf16_f32 v59, v46, v47
  v_mfma_f32_32x32x16_bf16 v[24:39], v[80:83], v[4:7], v[8:23]
  ds_read_b128 v[80:83], v3 offset:14336
  v_exp_f32 v50, v50
  v_exp_f32 v51, v51
  v_cvt_pk_bf16_f32 v60, v48, v49
  v_exp_f32 v52, v52
  v_exp_f32 v53, v53
  v_cvt_pk_bf16_f32 v61, v50, v51
  s_cmp_lt_u32 s22, 4
  s_cbranch_scc1 fused_kernel_g_18_a
  buffer_load_dwordx2 v[184:185], v116, s[12:15], s49 offen
  buffer_load_dwordx2 v[186:187], v116, s[12:15], s49 offen offset:16
  s_add_u32 m0, s38, 65536
  s_add_u32 s33, s36, 32768
  buffer_load_dwordx4 v3, s[8:11], s33 offen offset:0 lds
  buffer_load_dwordx4 v3, s[8:11], s33 offen offset:1024 lds
  s_branch fused_kernel_g_18
fused_kernel_g_18_a:
  s_add_u32 m0, s38, 99328
  s_add_u32 s33, s39, 2130944
  buffer_load_dwordx4 v3, s[8:11], s33 offen lds
fused_kernel_g_18:
  v_exp_f32 v54, v54
  v_exp_f32 v55, v55
  v_cvt_pk_bf16_f32 v62, v52, v53
  v_cvt_pk_bf16_f32 v63, v54, v55
  v_add_u32 v105, v106, v105
  s_waitcnt lgkmcnt(3)
  v_exp_f32 v24, v24
  v_exp_f32 v25, v25
  v_mfma_f32_32x32x16_bf16 v[64:79], v[96:99], v[56:59], v[64:79]
  v_exp_f32 v26, v26
  v_exp_f32 v27, v27
  v_cvt_pk_bf16_f32 v56, v24, v25
  ds_read_b32 v113, v111 offset:64
  v_exp_f32 v28, v28
  v_exp_f32 v29, v29
  v_cvt_pk_bf16_f32 v57, v26, v27
  v_mfma_f32_32x32x16_bf16 v[64:79], v[100:103], v[60:63], v[64:79]
  ds_read_b128 v[96:99], v105 offset:1024
  ds_read_b128 v[100:103], v105 offset:1536
  v_exp_f32 v30, v30
  v_exp_f32 v31, v31
  v_cvt_pk_bf16_f32 v58, v28, v29
  v_exp_f32 v32, v32
  v_exp_f32 v33, v33
  v_cvt_pk_bf16_f32 v59, v30, v31
  v_mfma_f32_32x32x16_bf16 v[40:55], v[84:87], v[4:7], v[8:23]
  ds_read_b128 v[84:87], v3 offset:15360
  v_exp_f32 v34, v34
  v_exp_f32 v35, v35
  v_cvt_pk_bf16_f32 v60, v32, v33
  v_exp_f32 v36, v36
  v_exp_f32 v37, v37
  v_cvt_pk_bf16_f32 v61, v34, v35
  s_cmp_lt_u32 s22, 4
  s_cbranch_scc1 fused_kernel_g_19_a
  s_add_u32 s33, s50, 4096
  buffer_load_dwordx4 v[188:191], v117, s[8:11], s33 offen
  buffer_load_dwordx4 v[192:195], v117, s[8:11], s33 offen offset:32
  s_branch fused_kernel_g_19
fused_kernel_g_19_a:
  s_add_u32 m0, s38, 40960
  s_add_u32 s33, s39, 40960
  buffer_load_dwordx4 v3, s[8:11], s33 offen lds
fused_kernel_g_19:
  v_exp_f32 v38, v38
  v_exp_f32 v39, v39
  v_cvt_pk_bf16_f32 v62, v36, v37
  v_cvt_pk_bf16_f32 v63, v38, v39
  s_waitcnt lgkmcnt(3)
  v_cmp_gt_u32 vcc, 2, v113
  s_cmp_eq_u64 vcc, 0
  s_cbranch_scc1 fused_kernel_ck_20_ok
  s_mov_b32 s60, 0
fused_kernel_ck_20:
  ds_read_b32 v113, v111 offset:64
  s_waitcnt lgkmcnt(0)
  v_cmp_gt_u32 vcc, 2, v113
  s_cmp_eq_u64 vcc, 0
  s_cbranch_scc1 fused_kernel_ck_20_ok
  s_add_u32 s60, s60, 1
  s_cmp_lt_u32 s60, 640000
  s_cbranch_scc1 fused_kernel_ck_20
fused_kernel_ck_20_ok:
  v_exp_f32 v40, v40
  v_exp_f32 v41, v41
  v_mfma_f32_32x32x16_bf16 v[64:79], v[88:91], v[56:59], v[64:79]
  v_exp_f32 v42, v42
  v_exp_f32 v43, v43
  v_cvt_pk_bf16_f32 v56, v40, v41
  v_exp_f32 v44, v44
  v_exp_f32 v45, v45
  v_cvt_pk_bf16_f32 v57, v42, v43
  v_mfma_f32_32x32x16_bf16 v[64:79], v[92:95], v[60:63], v[64:79]
  ds_read_b128 v[88:91], v105 offset:2048
  ds_read_b128 v[92:95], v105 offset:2560
  v_exp_f32 v46, v46
  v_exp_f32 v47, v47
  v_cvt_pk_bf16_f32 v58, v44, v45
  v_exp_f32 v48, v48
  v_exp_f32 v49, v49
  v_cvt_pk_bf16_f32 v59, v46, v47
  v_mfma_f32_32x32x16_bf16 v[24:39], v[80:83], v[4:7], v[8:23]
  ds_read_b128 v[80:83], v3 offset:16384
  v_exp_f32 v50, v50
  v_exp_f32 v51, v51
  v_cvt_pk_bf16_f32 v60, v48, v49
  v_exp_f32 v52, v52
  v_exp_f32 v53, v53
  v_cvt_pk_bf16_f32 v61, v50, v51
  s_cmp_lt_u32 s22, 4
  s_cbranch_scc1 fused_kernel_g_21_a
  s_add_u32 s33, s50, 8192
  buffer_load_dwordx4 v[196:199], v117, s[8:11], s33 offen
  buffer_load_dwordx4 v[200:203], v117, s[8:11], s33 offen offset:32
  s_branch fused_kernel_g_21
fused_kernel_g_21_a:
  s_add_u32 m0, s38, 41984
  s_add_u32 s33, s39, 41984
  buffer_load_dwordx4 v3, s[8:11], s33 offen lds
fused_kernel_g_21:
  v_exp_f32 v54, v54
  v_exp_f32 v55, v55
  v_cvt_pk_bf16_f32 v62, v52, v53
  v_cvt_pk_bf16_f32 v63, v54, v55
  v_add_u32 v105, v106, v105
  s_waitcnt lgkmcnt(3)
  v_exp_f32 v24, v24
  v_exp_f32 v25, v25
  v_mfma_f32_32x32x16_bf16 v[64:79], v[96:99], v[56:59], v[64:79]
  v_exp_f32 v26, v26
  v_exp_f32 v27, v27
  v_cvt_pk_bf16_f32 v56, v24, v25
  v_exp_f32 v28, v28
  v_exp_f32 v29, v29
  v_cvt_pk_bf16_f32 v57, v26, v27
  v_mfma_f32_32x32x16_bf16 v[64:79], v[100:103], v[60:63], v[64:79]
  ds_read_b128 v[96:99], v105 offset:1024
  ds_read_b128 v[100:103], v105 offset:1536
  v_exp_f32 v30, v30
  v_exp_f32 v31, v31
  v_cvt_pk_bf16_f32 v58, v28, v29
  v_exp_f32 v32, v32
  v_exp_f32 v33, v33
  v_cvt_pk_bf16_f32 v59, v30, v31
  v_mfma_f32_32x32x16_bf16 v[40:55], v[84:87], v[4:7], v[8:23]
  ds_read_b128 v[84:87], v3 offset:17408
  v_exp_f32 v34, v34
  v_exp_f32 v35, v35
  v_cvt_pk_bf16_f32 v60, v32, v33
  v_exp_f32 v36, v36
  v_exp_f32 v37, v37
  v_cvt_pk_bf16_f32 v61, v34, v35
  s_cmp_lt_u32 s22, 4
  s_cbranch_scc1 fused_kernel_g_22_a
  s_add_u32 s33, s48, 0
  buffer_load_dwordx4 v[120:123], v2, s[8:11], s33 offen offset:0
  s_branch fused_kernel_g_22
fused_kernel_g_22_a:
  s_add_u32 m0, s38, 106496
  s_add_u32 s33, s39, 2138112
  buffer_load_dwordx4 v3, s[8:11], s33 offen lds
fused_kernel_g_22:
  v_exp_f32 v38, v38
  v_exp_f32 v39, v39
  v_cvt_pk_bf16_f32 v62, v36, v37
  v_cvt_pk_bf16_f32 v63, v38, v39
  s_waitcnt lgkmcnt(3)
  v_exp_f32 v40, v40
  v_exp_f32 v41, v41
  v_mfma_f32_32x32x16_bf16 v[64:79], v[88:91], v[56:59], v[64:79]
  v_exp_f32 v42, v42
  v_exp_f32 v43, v43
  v_cvt_pk_bf16_f32 v56, v40, v41
  v_exp_f32 v44, v44
  v_exp_f32 v45, v45
  v_cvt_pk_bf16_f32 v57, v42, v43
  v_mfma_f32_32x32x16_bf16 v[64:79], v[92:95], v[60:63], v[64:79]
  ds_read_b128 v[88:91], v105 offset:2048
  ds_read_b128 v[92:95], v105 offset:2560
  v_exp_f32 v46, v46
  v_exp_f32 v47, v47
  v_cvt_pk_bf16_f32 v58, v44, v45
  v_exp_f32 v48, v48
  v_exp_f32 v49, v49
  v_cvt_pk_bf16_f32 v59, v46, v47
  v_mfma_f32_32x32x16_bf16 v[24:39], v[80:83], v[4:7], v[8:23]
  ds_read_b128 v[80:83], v3 offset:18432
  v_exp_f32 v50, v50
  v_exp_f32 v51, v51
  v_cvt_pk_bf16_f32 v60, v48, v49
  v_exp_f32 v52, v52
  v_exp_f32 v53, v53
  v_cvt_pk_bf16_f32 v61, v50, v51
  s_cmp_lt_u32 s22, 4
  s_cbranch_scc1 fused_kernel_g_23_a
  s_add_u32 s33, s48, 0
  buffer_load_dwordx4 v[124:127], v2, s[8:11], s33 offen offset:1024
  s_branch fused_kernel_g_23
fused_kernel_g_23_a:
  s_add_u32 m0, s38, 107520
  s_add_u32 s33, s39, 2139136
  buffer_load_dwordx4 v3, s[8:11], s33 offen lds
fused_kernel_g_23:
  v_exp_f32 v54, v54
  v_exp_f32 v55, v55
  v_cvt_pk_bf16_f32 v62, v52, v53
  v_cvt_pk_bf16_f32 v63, v54, v55
  v_add_u32 v105, v106, v105
  s_waitcnt lgkmcnt(3)
  v_mov_b32 v112, 2
  s_mov_b64 exec, 1
  ds_write_b32 v109, v112 offset:0
  s_mov_b64 exec, -1
  v_exp_f32 v24, v24
  v_exp_f32 v25, v25
  v_mfma_f32_32x32x16_bf16 v[64:79], v[96:99], v[56:59], v[64:79]
  v_exp_f32 v26, v26
  v_exp_f32 v27, v27
  v_cvt_pk_bf16_f32 v56, v24, v25
  v_exp_f32 v28, v28
  v_exp_f32 v29, v29
  v_cvt_pk_bf16_f32 v57, v26, v27
  v_mfma_f32_32x32x16_bf16 v[64:79], v[100:103], v[60:63], v[64:79]
  ds_read_b128 v[96:99], v105 offset:1024
  ds_read_b128 v[100:103], v105 offset:1536
  v_exp_f32 v30, v30
  v_exp_f32 v31, v31
  v_cvt_pk_bf16_f32 v58, v28, v29
  v_exp_f32 v32, v32
  v_exp_f32 v33, v33
  v_cvt_pk_bf16_f32 v59, v30, v31
  v_mfma_f32_32x32x16_bf16 v[40:55], v[84:87], v[4:7], v[8:23]
  ds_read_b128 v[84:87], v3 offset:19456
  v_exp_f32 v34, v34
  v_exp_f32 v35, v35
  v_cvt_pk_bf16_f32 v60, v32, v33
  v_exp_f32 v36, v36
  v_exp_f32 v37, v37
  v_cvt_pk_bf16_f32 v61, v34, v35
  s_cmp_lt_u32 s22, 4
  s_cbranch_scc1 fused_kernel_g_24_a
  s_add_u32 s33, s48, 0
  buffer_load_dwordx4 v[128:131], v2, s[8:11], s33 offen offset:2048
  s_branch fused_kernel_g_24
fused_kernel_g_24_a:
  s_add_u32 m0, s38, 49152
  s_add_u32 s33, s39, 49152
  buffer_load_dwordx4 v3, s[8:11], s33 offen lds
fused_kernel_g_24:
  v_exp_f32 v38, v38
  v_exp_f32 v39, v39
  v_cvt_pk_bf16_f32 v62, v36, v37
  v_cvt_pk_bf16_f32 v63, v38, v39
  s_waitcnt lgkmcnt(4)
  v_exp_f32 v40, v40
  v_exp_f32 v41, v41
  v_mfma_f32_32x32x16_bf16 v[64:79], v[88:91], v[56:59], v[64:79]
  v_exp_f32 v42, v42
  v_exp_f32 v43, v43
  v_cvt_pk_bf16_f32 v56, v40, v41
  ds_read_b32 v113, v110 offset:0
  v_exp_f32 v44, v44
  v_exp_f32 v45, v45
  v_cvt_pk_bf16_f32 v57, v42, v43
  v_mfma_f32_32x32x16_bf16 v[64:79], v[92:95], v[60:63], v[64:79]
  ds_read_b128 v[88:91], v105 offset:2048
  ds_read_b128 v[92:95], v105 offset:2560
  v_exp_f32 v46, v46
  v_exp_f32 v47, v47
  v_cvt_pk_bf16_f32 v58, v44, v45
  v_exp_f32 v48, v48
  v_exp_f32 v49, v49
  v_cvt_pk_bf16_f32 v59, v46, v47
  v_mfma_f32_32x32x16_bf16 v[24:39], v[80:83], v[4:7], v[8:23]
  ds_read_b128 v[80:83], v3 offset:20480
  v_exp_f32 v50, v50
  v_exp_f32 v51, v51
  v_cvt_pk_bf16_f32 v60, v48, v49
  v_exp_f32 v52, v52
  v_exp_f32 v53, v53
  v_cvt_pk_bf16_f32 v61, v50, v51
  s_cmp_lt_u32 s22, 4
  s_cbranch_scc1 fused_kernel_g_25_a
  s_add_u32 s33, s48, 0
  buffer_load_dwordx4 v[132:135], v2, s[8:11], s33 offen offset:3072
  s_branch fused_kernel_g_25
fused_kernel_g_25_a:
  s_add_u32 m0, s38, 50176
  s_add_u32 s33, s39, 50176
  buffer_load_dwordx4 v3, s[8:11], s33 offen lds
fused_kernel_g_25:
  v_exp_f32 v54, v54
  v_exp_f32 v55, v55
  v_cvt_pk_bf16_f32 v62, v52, v53
  v_cvt_pk_bf16_f32 v63, v54, v55
  v_add_u32 v105, v106, v105
  s_waitcnt lgkmcnt(3)
  s_cmp_lt_u32 s22, 4
  s_cbranch_scc1 fused_kernel_g_26
  v_cmp_gt_u32 vcc, 2, v113
  s_cmp_eq_u64 vcc, 0
  s_cbranch_scc1 fused_kernel_ck_27_ok
  s_mov_b32 s60, 0
fused_kernel_ck_27:
  ds_read_b32 v113, v110 offset:0
  s_waitcnt lgkmcnt(0)
  v_cmp_gt_u32 vcc, 2, v113
  s_cmp_eq_u64 vcc, 0
  s_cbranch_scc1 fused_kernel_ck_27_ok
  s_add_u32 s60, s60, 1
  s_cmp_lt_u32 s60, 640000
  s_cbranch_scc1 fused_kernel_ck_27
fused_kernel_ck_27_ok:
fused_kernel_g_26:
  v_exp_f32 v24, v24
  v_exp_f32 v25, v25
  v_mfma_f32_32x32x16_bf16 v[64:79], v[96:99], v[56:59], v[64:79]
  v_exp_f32 v26, v26
  v_exp_f32 v27, v27
  v_cvt_pk_bf16_f32 v56, v24, v25
  v_exp_f32 v28, v28
  v_exp_f32 v29, v29
  v_cvt_pk_bf16_f32 v57, v26, v27
  v_mfma_f32_32x32x16_bf16 v[64:79], v[100:103], v[60:63], v[64:79]
  ds_read_b128 v[96:99], v105 offset:1024
  ds_read_b128 v[100:103], v105 offset:1536
  v_exp_f32 v30, v30
  v_exp_f32 v31, v31
  v_cvt_pk_bf16_f32 v58, v28, v29
  v_exp_f32 v32, v32
  v_exp_f32 v33, v33
  v_cvt_pk_bf16_f32 v59, v30, v31
  v_mfma_f32_32x32x16_bf16 v[40:55], v[84:87], v[4:7], v[8:23]
  ds_read_b128 v[84:87], v3 offset:21504
  v_exp_f32 v34, v34
  v_exp_f32 v35, v35
  v_cvt_pk_bf16_f32 v60, v32, v33
  v_exp_f32 v36, v36
  v_exp_f32 v37, v37
  v_cvt_pk_bf16_f32 v61, v34, v35
  s_cmp_lt_u32 s22, 4
  s_cbranch_scc1 fused_kernel_g_28_a
  s_add_u32 s33, s48, 4096
  buffer_load_dwordx4 v[136:139], v2, s[8:11], s33 offen offset:0
  s_add_u32 m0, s38, 8192
  s_add_u32 s33, s36, 8192
  buffer_load_dwordx4 v3, s[8:11], s33 offen offset:0 lds
  buffer_load_dwordx4 v3, s[8:11], s33 offen offset:1024 lds
  s_branch fused_kernel_g_28
fused_kernel_g_28_a:
  s_add_u32 m0, s38, 114688
  s_add_u32 s33, s39, 2146304
  buffer_load_dwordx4 v3, s[8:11], s33 offen lds
fused_kernel_g_28:
  v_exp_f32 v38, v38
  v_exp_f32 v39, v39
  v_cvt_pk_bf16_f32 v62, v36, v37
  v_cvt_pk_bf16_f32 v63, v38, v39
  s_waitcnt lgkmcnt(3)
  s_cmp_ge_u32 s22, 4
  s_cbranch_scc1 fused_kernel_g_29
  s_waitcnt vmcnt(11)
  v_mov_b32 v112, 3
  s_mov_b64 exec, 1
  ds_write_b32 v109, v112 offset:64
  s_mov_b64 exec, -1
fused_kernel_g_29:
  v_exp_f32 v40, v40
  v_exp_f32 v41, v41
  v_mfma_f32_32x32x16_bf16 v[64:79], v[88:91], v[56:59], v[64:79]
  v_exp_f32 v42, v42
  v_exp_f32 v43, v43
  v_cvt_pk_bf16_f32 v56, v40, v41
  v_exp_f32 v44, v44
  v_exp_f32 v45, v45
  v_cvt_pk_bf16_f32 v57, v42, v43
  v_mfma_f32_32x32x16_bf16 v[64:79], v[92:95], v[60:63], v[64:79]
  ds_read_b128 v[88:91], v105 offset:2048
  ds_read_b128 v[92:95], v105 offset:2560
  v_exp_f32 v46, v46
  v_exp_f32 v47, v47
  v_cvt_pk_bf16_f32 v58, v44, v45
  v_exp_f32 v48, v48
  v_exp_f32 v49, v49
  v_cvt_pk_bf16_f32 v59, v46, v47
  v_mfma_f32_32x32x16_bf16 v[24:39], v[80:83], v[4:7], v[8:23]
  ds_read_b128 v[80:83], v3 offset:22528
  v_exp_f32 v50, v50
  v_exp_f32 v51, v51
  v_cvt_pk_bf16_f32 v60, v48, v49
  v_exp_f32 v52, v52
  v_exp_f32 v53, v53
  v_cvt_pk_bf16_f32 v61, v50, v51
  s_cmp_lt_u32 s22, 4
  s_cbranch_scc1 fused_kernel_g_30_a
  s_add_u32 s33, s48, 4096
  buffer_load_dwordx4 v[140:143], v2, s[8:11], s33 offen offset:1024
  s_add_u32 m0, s38, 73728
  s_add_u32 s33, s36, 40960
  buffer_load_dwordx4 v3, s[8:11], s33 offen offset:0 lds
  buffer_load_dwordx4 v3, s[8:11], s33 offen offset:1024 lds
  s_branch fused_kernel_g_30
fused_kernel_g_30_a:
  s_add_u32 m0, s38, 115712
  s_add_u32 s33, s39, 2147328
  buffer_load_dwordx4 v3, s[8:11], s33 offen lds
fused_kernel_g_30:
  v_exp_f32 v54, v54
  v_exp_f32 v55, v55
  v_cvt_pk_bf16_f32 v62, v52, v53
  v_cvt_pk_bf16_f32 v63, v54, v55
  v_add_u32 v105, v106, v105
  s_waitcnt lgkmcnt(3)
  v_exp_f32 v24, v24
  v_exp_f32 v25, v25
  v_mfma_f32_32x32x16_bf16 v[64:79], v[96:99], v[56:59], v[64:79]
  v_exp_f32 v26, v26
  v_exp_f32 v27, v27
  v_cvt_pk_bf16_f32 v56, v24, v25
  ds_read_b32 v113, v111 offset:64
  v_exp_f32 v28, v28
  v_exp_f32 v29, v29
  v_cvt_pk_bf16_f32 v57, v26, v27
  v_mfma_f32_32x32x16_bf16 v[64:79], v[100:103], v[60:63], v[64:79]
  ds_read_b128 v[96:99], v105 offset:1024
  ds_read_b128 v[100:103], v105 offset:1536
  v_exp_f32 v30, v30
  v_exp_f32 v31, v31
  v_cvt_pk_bf16_f32 v58, v28, v29
  v_exp_f32 v32, v32
  v_exp_f32 v33, v33
  v_cvt_pk_bf16_f32 v59, v30, v31
  v_mfma_f32_32x32x16_bf16 v[40:55], v[84:87], v[4:7], v[8:23]
  ds_read_b128 v[84:87], v3 offset:23552
  v_exp_f32 v34, v34
  v_exp_f32 v35, v35
  v_cvt_pk_bf16_f32 v60, v32, v33
  v_exp_f32 v36, v36
  v_exp_f32 v37, v37
  v_cvt_pk_bf16_f32 v61, v34, v35
  s_cmp_lt_u32 s22, 4
  s_cbranch_scc1 fused_kernel_g_31_a
  s_add_u32 s33, s48, 4096
  buffer_load_dwordx4 v[144:147], v2, s[8:11], s33 offen offset:2048
  s_add_u32 s33, s36, 24576
  buffer_load_dwordx4 v[236:239], v3, s[8:11], s33 offen
  s_branch fused_kernel_g_31
fused_kernel_g_31_a:
  s_add_u32 m0, s38, 57344
  s_add_u32 s33, s39, 57344
  buffer_load_dwordx4 v3, s[8:11], s33 offen lds
fused_kernel_g_31:
  v_exp_f32 v38, v38
  v_exp_f32 v39, v39
  v_cvt_pk_bf16_f32 v62, v36, v37
  v_cvt_pk_bf16_f32 v63, v38, v39
  s_waitcnt lgkmcnt(3)
  v_cmp_gt_u32 vcc, 3, v113
  s_cmp_eq_u64 vcc, 0
  s_cbranch_scc1 fused_kernel_ck_32_ok
  s_mov_b32 s60, 0
fused_kernel_ck_32:
  ds_read_b32 v113, v111 offset:64
  s_waitcnt lgkmcnt(0)
  v_cmp_gt_u32 vcc, 3, v113
  s_cmp_eq_u64 vcc, 0
  s_cbranch_scc1 fused_kernel_ck_32_ok
  s_add_u32 s60, s60, 1
  s_cmp_lt_u32 s60, 640000
  s_cbranch_scc1 fused_kernel_ck_32
fused_kernel_ck_32_ok:
  v_exp_f32 v40, v40
  v_exp_f32 v41, v41
  v_mfma_f32_32x32x16_bf16 v[64:79], v[88:91], v[56:59], v[64:79]
  v_exp_f32 v42, v42
  v_exp_f32 v43, v43
  v_cvt_pk_bf16_f32 v56, v40, v41
  v_exp_f32 v44, v44
  v_exp_f32 v45, v45
  v_cvt_pk_bf16_f32 v57, v42, v43
  v_mfma_f32_32x32x16_bf16 v[64:79], v[92:95], v[60:63], v[64:79]
  ds_read_b128 v[88:91], v105 offset:2048
  ds_read_b128 v[92:95], v105 offset:2560
  v_exp_f32 v46, v46
  v_exp_f32 v47, v47
  v_cvt_pk_bf16_f32 v58, v44, v45
  v_exp_f32 v48, v48
  v_exp_f32 v49, v49
  v_cvt_pk_bf16_f32 v59, v46, v47
  v_mfma_f32_32x32x16_bf16 v[24:39], v[80:83], v[4:7], v[8:23]
  ds_read_b128 v[80:83], v3 offset:24576
  v_exp_f32 v50, v50
  v_exp_f32 v51, v51
  v_cvt_pk_bf16_f32 v60, v48, v49
  v_exp_f32 v52, v52
  v_exp_f32 v53, v53
  v_cvt_pk_bf16_f32 v61, v50, v51
  s_cmp_lt_u32 s22, 4
  s_cbranch_scc1 fused_kernel_g_33_a
  s_add_u32 s33, s48, 4096
  buffer_load_dwordx4 v[148:151], v2, s[8:11], s33 offen offset:3072
  s_add_u32 s33, s36, 25600
  buffer_load_dwordx4 v[236:239], v3, s[8:11], s33 offen
  s_branch fused_kernel_g_33
fused_kernel_g_33_a:
  s_add_u32 m0, s38, 58368
  s_add_u32 s33, s39, 58368
  buffer_load_dwordx4 v3, s[8:11], s33 offen lds
fused_kernel_g_33:
  v_exp_f32 v54, v54
  v_exp_f32 v55, v55
  v_cvt_pk_bf16_f32 v62, v52, v53
  v_cvt_pk_bf16_f32 v63, v54, v55
  v_add_u32 v105, v106, v105
  s_waitcnt lgkmcnt(3)
  v_exp_f32 v24, v24
  v_exp_f32 v25, v25
  v_mfma_f32_32x32x16_bf16 v[64:79], v[96:99], v[56:59], v[64:79]
  v_exp_f32 v26, v26
  v_exp_f32 v27, v27
  v_cvt_pk_bf16_f32 v56, v24, v25
  v_exp_f32 v28, v28
  v_exp_f32 v29, v29
  v_cvt_pk_bf16_f32 v57, v26, v27
  v_mfma_f32_32x32x16_bf16 v[64:79], v[100:103], v[60:63], v[64:79]
  ds_read_b128 v[96:99], v105 offset:1024
  ds_read_b128 v[100:103], v105 offset:1536
  v_exp_f32 v30, v30
  v_exp_f32 v31, v31
  v_cvt_pk_bf16_f32 v58, v28, v29
  v_exp_f32 v32, v32
  v_exp_f32 v33, v33
  v_cvt_pk_bf16_f32 v59, v30, v31
  v_mfma_f32_32x32x16_bf16 v[40:55], v[84:87], v[4:7], v[8:23]
  ds_read_b128 v[84:87], v3 offset:25600
  v_exp_f32 v34, v34
  v_exp_f32 v35, v35
  v_cvt_pk_bf16_f32 v60, v32, v33
  v_exp_f32 v36, v36
  v_exp_f32 v37, v37
  v_cvt_pk_bf16_f32 v61, v34, v35
  s_cmp_lt_u32 s22, 4
  s_cbranch_scc1 fused_kernel_g_34_a
  s_add_u32 s33, s53, 0
  buffer_load_dwordx4 v[152:155], v2, s[8:11], s33 offen offset:0
  s_add_u32 s33, s36, 57344
  buffer_load_dwordx4 v[236:239], v3, s[8:11], s33 offen
  s_branch fused_kernel_g_34
fused_kernel_g_34_a:
  s_add_u32 m0, s38, 122880
  s_add_u32 s33, s39, 2154496
  buffer_load_dwordx4 v3, s[8:11], s33 offen lds
fused_kernel_g_34:
  v_exp_f32 v38, v38
  v_exp_f32 v39, v39
  v_cvt_pk_bf16_f32 v62, v36, v37
  v_cvt_pk_bf16_f32 v63, v38, v39
  s_waitcnt lgkmcnt(3)
  v_exp_f32 v40, v40
  v_exp_f32 v41, v41
  v_mfma_f32_32x32x16_bf16 v[64:79], v[88:91], v[56:59], v[64:79]
  v_exp_f32 v42, v42
  v_exp_f32 v43, v43
  v_cvt_pk_bf16_f32 v56, v40, v41
  v_exp_f32 v44, v44
  v_exp_f32 v45, v45
  v_cvt_pk_bf16_f32 v57, v42, v43
  v_mfma_f32_32x32x16_bf16 v[64:79], v[92:95], v[60:63], v[64:79]
  ds_read_b128 v[88:91], v105 offset:2048
  ds_read_b128 v[92:95], v105 offset:2560
  v_exp_f32 v46, v46
  v_exp_f32 v47, v47
  v_cvt_pk_bf16_f32 v58, v44, v45
  v_exp_f32 v48, v48
  v_exp_f32 v49, v49
  v_cvt_pk_bf16_f32 v59, v46, v47
  v_mfma_f32_32x32x16_bf16 v[24:39], v[80:83], v[4:7], v[8:23]
  ds_read_b128 v[80:83], v3 offset:26624
  v_exp_f32 v50, v50
  v_exp_f32 v51, v51
  v_cvt_pk_bf16_f32 v60, v48, v49
  v_exp_f32 v52, v52
  v_exp_f32 v53, v53
  v_cvt_pk_bf16_f32 v61, v50, v51
  s_cmp_lt_u32 s22, 4
  s_cbranch_scc1 fused_kernel_g_35_a
  s_add_u32 s33, s53, 0
  buffer_load_dwordx4 v[156:159], v2, s[8:11], s33 offen offset:1024
  s_add_u32 s33, s36, 58368
  buffer_load_dwordx4 v[236:239], v3, s[8:11], s33 offen
  s_branch fused_kernel_g_35
fused_kernel_g_35_a:
  s_add_u32 m0, s38, 123904
  s_add_u32 s33, s39, 2155520
  buffer_load_dwordx4 v3, s[8:11], s33 offen lds
fused_kernel_g_35:
  v_exp_f32 v54, v54
  v_exp_f32 v55, v55
  v_cvt_pk_bf16_f32 v62, v52, v53
  v_cvt_pk_bf16_f32 v63, v54, v55
  v_add_u32 v105, v106, v105
  s_waitcnt lgkmcnt(3)
  v_mov_b32 v112, 3
  s_mov_b64 exec, 1
  ds_write_b32 v109, v112 offset:0
  s_mov_b64 exec, -1
  v_exp_f32 v24, v24
  v_exp_f32 v25, v25
  v_mfma_f32_32x32x16_bf16 v[64:79], v[96:99], v[56:59], v[64:79]
  v_exp_f32 v26, v26
  v_exp_f32 v27, v27
  v_cvt_pk_bf16_f32 v56, v24, v25
  v_exp_f32 v28, v28
  v_exp_f32 v29, v29
  v_cvt_pk_bf16_f32 v57, v26, v27
  v_mfma_f32_32x32x16_bf16 v[64:79], v[100:103], v[60:63], v[64:79]
  ds_read_b128 v[96:99], v105 offset:1024
  ds_read_b128 v[100:103], v105 offset:1536
  v_exp_f32 v30, v30
  v_exp_f32 v31, v31
  v_cvt_pk_bf16_f32 v58, v28, v29
  v_exp_f32 v32, v32
  v_exp_f32 v33, v33
  v_cvt_pk_bf16_f32 v59, v30, v31
  v_mfma_f32_32x32x16_bf16 v[40:55], v[84:87], v[4:7], v[8:23]
  ds_read_b128 v[84:87], v3 offset:27648
  v_exp_f32 v34, v34
  v_exp_f32 v35, v35
  v_cvt_pk_bf16_f32 v60, v32, v33
  v_exp_f32 v36, v36
  v_exp_f32 v37, v37
  v_cvt_pk_bf16_f32 v61, v34, v35
  s_cmp_lt_u32 s22, 4
  s_cbranch_scc1 fused_kernel_g_36_a
  s_add_u32 s33, s53, 0
  buffer_load_dwordx4 v[160:163], v2, s[8:11], s33 offen offset:2048
  s_add_u32 s33, s36, 73728
  buffer_load_dwordx4 v[236:239], v3, s[8:11], s33 offen
  s_branch fused_kernel_g_36
fused_kernel_g_36_a:
  s_lshl_b32 s33, s47, 11
  v_bfe_u32 v246, v1, 4, 1
  v_lshlrev_b32 v246, 7, v246
  v_lshl_add_u32 v246, v117, 2, v246
  v_and_b32 v247, 15, v1
  v_lshl_add_u32 v246, v247, 2, v246
  s_add_u32 s33, s33, 29360128
  buffer_load_dword v204, v246, s[8:11], s33 offen offset:0
  buffer_load_dword v205, v246, s[8:11], s33 offen offset:256
  buffer_load_dword v206, v246, s[8:11], s33 offen offset:512
  buffer_load_dword v207, v246, s[8:11], s33 offen offset:768
  buffer_load_dword v208, v246, s[8:11], s33 offen offset:1024
  buffer_load_dword v209, v246, s[8:11], s33 offen offset:1280
  buffer_load_dword v210, v246, s[8:11], s33 offen offset:1536
  buffer_load_dword v211, v246, s[8:11], s33 offen offset:1792
fused_kernel_g_36:
  v_exp_f32 v38, v38
  v_exp_f32 v39, v39
  v_cvt_pk_bf16_f32 v62, v36, v37
  v_cvt_pk_bf16_f32 v63, v38, v39
  s_waitcnt lgkmcnt(4)
  v_exp_f32 v40, v40
  v_exp_f32 v41, v41
  v_mfma_f32_32x32x16_bf16 v[64:79], v[88:91], v[56:59], v[64:79]
  v_exp_f32 v42, v42
  v_exp_f32 v43, v43
  v_cvt_pk_bf16_f32 v56, v40, v41
  ds_read_b32 v113, v110 offset:0
  v_exp_f32 v44, v44
  v_exp_f32 v45, v45
  v_cvt_pk_bf16_f32 v57, v42, v43
  v_mfma_f32_32x32x16_bf16 v[64:79], v[92:95], v[60:63], v[64:79]
  ds_read_b128 v[88:91], v105 offset:2048
  ds_read_b128 v[92:95], v105 offset:2560
  v_exp_f32 v46, v46
  v_exp_f32 v47, v47
  v_cvt_pk_bf16_f32 v58, v44, v45
  v_exp_f32 v48, v48
  v_exp_f32 v49, v49
  v_cvt_pk_bf16_f32 v59, v46, v47
  v_mfma_f32_32x32x16_bf16 v[24:39], v[80:83], v[4:7], v[8:23]
  ds_read_b128 v[80:83], v3 offset:28672
  v_exp_f32 v50, v50
  v_exp_f32 v51, v51
  v_cvt_pk_bf16_f32 v60, v48, v49
  v_exp_f32 v52, v52
  v_exp_f32 v53, v53
  v_cvt_pk_bf16_f32 v61, v50, v51
  s_cmp_lt_u32 s22, 4
  s_cbranch_scc1 fused_kernel_g_37_a
  s_add_u32 s33, s53, 0
  buffer_load_dwordx4 v[164:167], v2, s[8:11], s33 offen offset:3072
  s_add_u32 s33, s36, 74752
  buffer_load_dwordx4 v[236:239], v3, s[8:11], s33 offen
  s_branch fused_kernel_g_37
fused_kernel_g_37_a:
  s_lshl_b32 s33, s47, 11
  v_bfe_u32 v246, v1, 4, 1
  v_lshlrev_b32 v246, 7, v246
  v_lshl_add_u32 v246, v117, 2, v246
  v_and_b32 v247, 15, v1
  v_lshl_add_u32 v246, v247, 2, v246
  s_add_u32 s33, s33, 29362176
  buffer_load_dword v212, v246, s[8:11], s33 offen offset:0
  buffer_load_dword v213, v246, s[8:11], s33 offen offset:256
  buffer_load_dword v214, v246, s[8:11], s33 offen offset:512
  buffer_load_dword v215, v246, s[8:11], s33 offen offset:768
  buffer_load_dword v216, v246, s[8:11], s33 offen offset:1024
  buffer_load_dword v217, v246, s[8:11], s33 offen offset:1280
  buffer_load_dword v218, v246, s[8:11], s33 offen offset:1536
  buffer_load_dword v219, v246, s[8:11], s33 offen offset:1792
fused_kernel_g_37:
  v_exp_f32 v54, v54
  v_exp_f32 v55, v55
  v_cvt_pk_bf16_f32 v62, v52, v53
  v_cvt_pk_bf16_f32 v63, v54, v55
  v_add_u32 v105, v106, v105
  s_waitcnt lgkmcnt(3)
  s_cmp_lt_u32 s22, 4
  s_cbranch_scc1 fused_kernel_g_38
  v_cmp_gt_u32 vcc, 3, v113
  s_cmp_eq_u64 vcc, 0
  s_cbranch_scc1 fused_kernel_ck_39_ok
  s_mov_b32 s60, 0
fused_kernel_ck_39:
  ds_read_b32 v113, v110 offset:0
  s_waitcnt lgkmcnt(0)
  v_cmp_gt_u32 vcc, 3, v113
  s_cmp_eq_u64 vcc, 0
  s_cbranch_scc1 fused_kernel_ck_39_ok
  s_add_u32 s60, s60, 1
  s_cmp_lt_u32 s60, 640000
  s_cbranch_scc1 fused_kernel_ck_39
fused_kernel_ck_39_ok:
fused_kernel_g_38:
  v_exp_f32 v24, v24
  v_exp_f32 v25, v25
  v_mfma_f32_32x32x16_bf16 v[64:79], v[96:99], v[56:59], v[64:79]
  v_exp_f32 v26, v26
  v_exp_f32 v27, v27
  v_cvt_pk_bf16_f32 v56, v24, v25
  v_exp_f32 v28, v28
  v_exp_f32 v29, v29
  v_cvt_pk_bf16_f32 v57, v26, v27
  v_mfma_f32_32x32x16_bf16 v[64:79], v[100:103], v[60:63], v[64:79]
  ds_read_b128 v[96:99], v105 offset:1024
  ds_read_b128 v[100:103], v105 offset:1536
  v_exp_f32 v30, v30
  v_exp_f32 v31, v31
  v_cvt_pk_bf16_f32 v58, v28, v29
  v_exp_f32 v32, v32
  v_exp_f32 v33, v33
  v_cvt_pk_bf16_f32 v59, v30, v31
  v_mfma_f32_32x32x16_bf16 v[40:55], v[84:87], v[4:7], v[8:23]
  ds_read_b128 v[84:87], v3 offset:29696
  v_exp_f32 v34, v34
  v_exp_f32 v35, v35
  v_cvt_pk_bf16_f32 v60, v32, v33
  v_exp_f32 v36, v36
  v_exp_f32 v37, v37
  v_cvt_pk_bf16_f32 v61, v34, v35
  s_cmp_lt_u32 s22, 4
  s_cbranch_scc1 fused_kernel_g_40_a
  s_add_u32 s33, s53, 4096
  buffer_load_dwordx4 v[168:171], v2, s[8:11], s33 offen offset:0
  s_add_u32 m0, s38, 16384
  s_add_u32 s33, s36, 16384
  buffer_load_dwordx4 v3, s[8:11], s33 offen offset:0 lds
  buffer_load_dwordx4 v3, s[8:11], s33 offen offset:1024 lds
  s_add_u32 s33, s36, 90112
  buffer_load_dwordx4 v[236:239], v3, s[8:11], s33 offen
  s_branch fused_kernel_g_40
fused_kernel_g_40_a:
  s_lshl_b32 s33, s47, 11
  v_bfe_u32 v246, v1, 4, 1
  v_lshlrev_b32 v246, 7, v246
  v_lshl_add_u32 v246, v117, 2, v246
  v_and_b32 v247, 15, v1
  v_lshl_add_u32 v246, v247, 2, v246
  s_add_u32 s33, s33, 29364224
  buffer_load_dword v220, v246, s[8:11], s33 offen offset:0
  buffer_load_dword v221, v246, s[8:11], s33 offen offset:256
  buffer_load_dword v222, v246, s[8:11], s33 offen offset:512
  buffer_load_dword v223, v246, s[8:11], s33 offen offset:768
  buffer_load_dword v224, v246, s[8:11], s33 offen offset:1024
  buffer_load_dword v225, v246, s[8:11], s33 offen offset:1280
  buffer_load_dword v226, v246, s[8:11], s33 offen offset:1536
  buffer_load_dword v227, v246, s[8:11], s33 offen offset:1792
fused_kernel_g_40:
  v_exp_f32 v38, v38
  v_exp_f32 v39, v39
  v_cvt_pk_bf16_f32 v62, v36, v37
  v_cvt_pk_bf16_f32 v63, v38, v39
  s_waitcnt lgkmcnt(3)
  s_cmp_ge_u32 s22, 4
  s_cbranch_scc1 fused_kernel_g_41
  s_waitcnt vmcnt(36)
  v_mov_b32 v112, 4
  s_mov_b64 exec, 1
  ds_write_b32 v109, v112 offset:64
  s_mov_b64 exec, -1
fused_kernel_g_41:
  v_exp_f32 v40, v40
  v_exp_f32 v41, v41
  v_mfma_f32_32x32x16_bf16 v[64:79], v[88:91], v[56:59], v[64:79]
  v_exp_f32 v42, v42
  v_exp_f32 v43, v43
  v_cvt_pk_bf16_f32 v56, v40, v41
  v_exp_f32 v44, v44
  v_exp_f32 v45, v45
  v_cvt_pk_bf16_f32 v57, v42, v43
  v_mfma_f32_32x32x16_bf16 v[64:79], v[92:95], v[60:63], v[64:79]
  ds_read_b128 v[88:91], v105 offset:2048
  ds_read_b128 v[92:95], v105 offset:2560
  v_exp_f32 v46, v46
  v_exp_f32 v47, v47
  v_cvt_pk_bf16_f32 v58, v44, v45
  v_exp_f32 v48, v48
  v_exp_f32 v49, v49
  v_cvt_pk_bf16_f32 v59, v46, v47
  v_mfma_f32_32x32x16_bf16 v[24:39], v[80:83], v[4:7], v[8:23]
  ds_read_b128 v[80:83], v3 offset:30720
  v_exp_f32 v50, v50
  v_exp_f32 v51, v51
  v_cvt_pk_bf16_f32 v60, v48, v49
  v_exp_f32 v52, v52
  v_exp_f32 v53, v53
  v_cvt_pk_bf16_f32 v61, v50, v51
  s_cmp_lt_u32 s22, 4
  s_cbranch_scc1 fused_kernel_g_42_a
  s_add_u32 s33, s53, 4096
  buffer_load_dwordx4 v[172:175], v2, s[8:11], s33 offen offset:1024
  s_add_u32 m0, s38, 81920
  s_add_u32 s33, s36, 49152
  buffer_load_dwordx4 v3, s[8:11], s33 offen offset:0 lds
  buffer_load_dwordx4 v3, s[8:11], s33 offen offset:1024 lds
  s_add_u32 s33, s36, 91136
  buffer_load_dwordx4 v[236:239], v3, s[8:11], s33 offen
  s_branch fused_kernel_g_42
fused_kernel_g_42_a:
  buffer_load_dwordx2 v[184:185], v116, s[12:15], s49 offen
  buffer_load_dwordx2 v[186:187], v116, s[12:15], s49 offen offset:16
fused_kernel_g_42:
  v_exp_f32 v54, v54
  v_exp_f32 v55, v55
  v_cvt_pk_bf16_f32 v62, v52, v53
  v_cvt_pk_bf16_f32 v63, v54, v55
  v_add_u32 v105, v106, v105
  s_waitcnt lgkmcnt(3)
  v_exp_f32 v24, v24
  v_exp_f32 v25, v25
  v_mfma_f32_32x32x16_bf16 v[64:79], v[96:99], v[56:59], v[64:79]
  v_exp_f32 v26, v26
  v_exp_f32 v27, v27
  v_cvt_pk_bf16_f32 v56, v24, v25
  ds_read_b32 v113, v111 offset:64
  v_exp_f32 v28, v28
  v_exp_f32 v29, v29
  v_cvt_pk_bf16_f32 v57, v26, v27
  v_mfma_f32_32x32x16_bf16 v[64:79], v[100:103], v[60:63], v[64:79]
  ds_read_b128 v[96:99], v105 offset:1024
  ds_read_b128 v[100:103], v105 offset:1536
  v_exp_f32 v30, v30
  v_exp_f32 v31, v31
  v_cvt_pk_bf16_f32 v58, v28, v29
  v_exp_f32 v32, v32
  v_exp_f32 v33, v33
  v_cvt_pk_bf16_f32 v59, v30, v31
  v_mfma_f32_32x32x16_bf16 v[40:55], v[84:87], v[4:7], v[8:23]
  ds_read_b128 v[84:87], v3 offset:31744
  v_exp_f32 v34, v34
  v_exp_f32 v35, v35
  v_cvt_pk_bf16_f32 v60, v32, v33
  v_exp_f32 v36, v36
  v_exp_f32 v37, v37
  v_cvt_pk_bf16_f32 v61, v34, v35
  s_cmp_lt_u32 s22, 4
  s_cbranch_scc1 fused_kernel_g_43_a
  s_add_u32 s33, s53, 4096
  buffer_load_dwordx4 v[176:179], v2, s[8:11], s33 offen offset:2048
  s_branch fused_kernel_g_43
fused_kernel_g_43_a:
  s_add_u32 s33, s50, 4096
  buffer_load_dwordx4 v[188:191], v117, s[8:11], s33 offen
  buffer_load_dwordx4 v[192:195], v117, s[8:11], s33 offen offset:32
fused_kernel_g_43:
  v_exp_f32 v38, v38
  v_exp_f32 v39, v39
  v_cvt_pk_bf16_f32 v62, v36, v37
  v_cvt_pk_bf16_f32 v63, v38, v39
  s_waitcnt lgkmcnt(3)
  v_cmp_gt_u32 vcc, 4, v113
  s_cmp_eq_u64 vcc, 0
  s_cbranch_scc1 fused_kernel_ck_44_ok
  s_mov_b32 s60, 0
fused_kernel_ck_44:
  ds_read_b32 v113, v111 offset:64
  s_waitcnt lgkmcnt(0)
  v_cmp_gt_u32 vcc, 4, v113
  s_cmp_eq_u64 vcc, 0
  s_cbranch_scc1 fused_kernel_ck_44_ok
  s_add_u32 s60, s60, 1
  s_cmp_lt_u32 s60, 640000
  s_cbranch_scc1 fused_kernel_ck_44
fused_kernel_ck_44_ok:
  v_exp_f32 v40, v40
  v_exp_f32 v41, v41
  v_mfma_f32_32x32x16_bf16 v[64:79], v[88:91], v[56:59], v[64:79]
  v_exp_f32 v42, v42
  v_exp_f32 v43, v43
  v_cvt_pk_bf16_f32 v56, v40, v41
  v_exp_f32 v44, v44
  v_exp_f32 v45, v45
  v_cvt_pk_bf16_f32 v57, v42, v43
  v_mfma_f32_32x32x16_bf16 v[64:79], v[92:95], v[60:63], v[64:79]
  ds_read_b128 v[88:91], v105 offset:2048
  ds_read_b128 v[92:95], v105 offset:2560
  v_exp_f32 v46, v46
  v_exp_f32 v47, v47
  v_cvt_pk_bf16_f32 v58, v44, v45
  v_exp_f32 v48, v48
  v_exp_f32 v49, v49
  v_cvt_pk_bf16_f32 v59, v46, v47
  v_mfma_f32_32x32x16_bf16 v[24:39], v[80:83], v[4:7], v[8:23]
  ds_read_b128 v[80:83], v3 offset:32768
  v_exp_f32 v50, v50
  v_exp_f32 v51, v51
  v_cvt_pk_bf16_f32 v60, v48, v49
  v_exp_f32 v52, v52
  v_exp_f32 v53, v53
  v_cvt_pk_bf16_f32 v61, v50, v51
  s_cmp_lt_u32 s22, 4
  s_cbranch_scc1 fused_kernel_g_45_a
  s_add_u32 s33, s53, 4096
  buffer_load_dwordx4 v[180:183], v2, s[8:11], s33 offen offset:3072
  s_branch fused_kernel_g_45
fused_kernel_g_45_a:
  s_add_u32 s33, s50, 8192
  buffer_load_dwordx4 v[196:199], v117, s[8:11], s33 offen
  buffer_load_dwordx4 v[200:203], v117, s[8:11], s33 offen offset:32
fused_kernel_g_45:
  v_exp_f32 v54, v54
  v_exp_f32 v55, v55
  v_cvt_pk_bf16_f32 v62, v52, v53
  v_cvt_pk_bf16_f32 v63, v54, v55
  v_add_u32 v105, v106, v105
  s_waitcnt lgkmcnt(3)
  v_exp_f32 v24, v24
  v_exp_f32 v25, v25
  v_mfma_f32_32x32x16_bf16 v[64:79], v[96:99], v[56:59], v[64:79]
  v_exp_f32 v26, v26
  v_exp_f32 v27, v27
  v_cvt_pk_bf16_f32 v56, v24, v25
  v_exp_f32 v28, v28
  v_exp_f32 v29, v29
  v_cvt_pk_bf16_f32 v57, v26, v27
  v_mfma_f32_32x32x16_bf16 v[64:79], v[100:103], v[60:63], v[64:79]
  ds_read_b128 v[96:99], v105 offset:1024
  ds_read_b128 v[100:103], v105 offset:1536
  v_exp_f32 v30, v30
  v_exp_f32 v31, v31
  v_cvt_pk_bf16_f32 v58, v28, v29
  v_exp_f32 v32, v32
  v_exp_f32 v33, v33
  v_cvt_pk_bf16_f32 v59, v30, v31
  v_mfma_f32_32x32x16_bf16 v[40:55], v[84:87], v[4:7], v[8:23]
  ds_read_b128 v[84:87], v3 offset:33792
  v_exp_f32 v34, v34
  v_exp_f32 v35, v35
  v_cvt_pk_bf16_f32 v60, v32, v33
  v_exp_f32 v36, v36
  v_exp_f32 v37, v37
  v_cvt_pk_bf16_f32 v61, v34, v35
  s_cmp_ge_u32 s22, 4
  s_cbranch_scc1 fused_kernel_g_46
  s_add_u32 s33, s48, 0
  buffer_load_dwordx4 v[120:123], v2, s[8:11], s33 offen offset:0
fused_kernel_g_46:
  v_exp_f32 v38, v38
  v_exp_f32 v39, v39
  v_cvt_pk_bf16_f32 v62, v36, v37
  v_cvt_pk_bf16_f32 v63, v38, v39
  s_waitcnt lgkmcnt(3)
  v_exp_f32 v40, v40
  v_exp_f32 v41, v41
  v_mfma_f32_32x32x16_bf16 v[64:79], v[88:91], v[56:59], v[64:79]
  v_exp_f32 v42, v42
  v_exp_f32 v43, v43
  v_cvt_pk_bf16_f32 v56, v40, v41
  v_exp_f32 v44, v44
  v_exp_f32 v45, v45
  v_cvt_pk_bf16_f32 v57, v42, v43
  v_mfma_f32_32x32x16_bf16 v[64:79], v[92:95], v[60:63], v[64:79]
  ds_read_b128 v[88:91], v105 offset:2048
  ds_read_b128 v[92:95], v105 offset:2560
  v_exp_f32 v46, v46
  v_exp_f32 v47, v47
  v_cvt_pk_bf16_f32 v58, v44, v45
  v_exp_f32 v48, v48
  v_exp_f32 v49, v49
  v_cvt_pk_bf16_f32 v59, v46, v47
  v_mfma_f32_32x32x16_bf16 v[24:39], v[80:83], v[4:7], v[8:23]
  ds_read_b128 v[80:83], v3 offset:34816
  v_exp_f32 v50, v50
  v_exp_f32 v51, v51
  v_cvt_pk_bf16_f32 v60, v48, v49
  v_exp_f32 v52, v52
  v_exp_f32 v53, v53
  v_cvt_pk_bf16_f32 v61, v50, v51
  s_cmp_ge_u32 s22, 4
  s_cbranch_scc1 fused_kernel_g_47
  s_add_u32 s33, s48, 0
  buffer_load_dwordx4 v[124:127], v2, s[8:11], s33 offen offset:1024
fused_kernel_g_47:
  v_exp_f32 v54, v54
  v_exp_f32 v55, v55
  v_cvt_pk_bf16_f32 v62, v52, v53
  v_cvt_pk_bf16_f32 v63, v54, v55
  v_add_u32 v105, v106, v105
  s_waitcnt lgkmcnt(3)
  v_mov_b32 v112, 4
  s_mov_b64 exec, 1
  ds_write_b32 v109, v112 offset:0
  s_mov_b64 exec, -1
  v_exp_f32 v24, v24
  v_exp_f32 v25, v25
  v_mfma_f32_32x32x16_bf16 v[64:79], v[96:99], v[56:59], v[64:79]
  v_exp_f32 v26, v26
  v_exp_f32 v27, v27
  v_cvt_pk_bf16_f32 v56, v24, v25
  v_exp_f32 v28, v28
  v_exp_f32 v29, v29
  v_cvt_pk_bf16_f32 v57, v26, v27
  v_mfma_f32_32x32x16_bf16 v[64:79], v[100:103], v[60:63], v[64:79]
  ds_read_b128 v[96:99], v105 offset:1024
  ds_read_b128 v[100:103], v105 offset:1536
  v_exp_f32 v30, v30
  v_exp_f32 v31, v31
  v_cvt_pk_bf16_f32 v58, v28, v29
  v_exp_f32 v32, v32
  v_exp_f32 v33, v33
  v_cvt_pk_bf16_f32 v59, v30, v31
  v_mfma_f32_32x32x16_bf16 v[40:55], v[84:87], v[4:7], v[8:23]
  ds_read_b128 v[84:87], v3 offset:35840
  v_exp_f32 v34, v34
  v_exp_f32 v35, v35
  v_cvt_pk_bf16_f32 v60, v32, v33
  v_exp_f32 v36, v36
  v_exp_f32 v37, v37
  v_cvt_pk_bf16_f32 v61, v34, v35
  s_cmp_ge_u32 s22, 4
  s_cbranch_scc1 fused_kernel_g_48
  s_add_u32 s33, s48, 0
  buffer_load_dwordx4 v[128:131], v2, s[8:11], s33 offen offset:2048
fused_kernel_g_48:
  v_exp_f32 v38, v38
  v_exp_f32 v39, v39
  v_cvt_pk_bf16_f32 v62, v36, v37
  v_cvt_pk_bf16_f32 v63, v38, v39
  s_waitcnt lgkmcnt(4)
  v_exp_f32 v40, v40
  v_exp_f32 v41, v41
  v_mfma_f32_32x32x16_bf16 v[64:79], v[88:91], v[56:59], v[64:79]
  v_exp_f32 v42, v42
  v_exp_f32 v43, v43
  v_cvt_pk_bf16_f32 v56, v40, v41
  ds_read_b32 v113, v110 offset:0
  v_exp_f32 v44, v44
  v_exp_f32 v45, v45
  v_cvt_pk_bf16_f32 v57, v42, v43
  v_mfma_f32_32x32x16_bf16 v[64:79], v[92:95], v[60:63], v[64:79]
  ds_read_b128 v[88:91], v105 offset:2048
  ds_read_b128 v[92:95], v105 offset:2560
  v_exp_f32 v46, v46
  v_exp_f32 v47, v47
  v_cvt_pk_bf16_f32 v58, v44, v45
  v_exp_f32 v48, v48
  v_exp_f32 v49, v49
  v_cvt_pk_bf16_f32 v59, v46, v47
  v_mfma_f32_32x32x16_bf16 v[24:39], v[80:83], v[4:7], v[8:23]
  ds_read_b128 v[80:83], v3 offset:36864
  v_exp_f32 v50, v50
  v_exp_f32 v51, v51
  v_cvt_pk_bf16_f32 v60, v48, v49
  v_exp_f32 v52, v52
  v_exp_f32 v53, v53
  v_cvt_pk_bf16_f32 v61, v50, v51
  s_cmp_ge_u32 s22, 4
  s_cbranch_scc1 fused_kernel_g_49
  s_add_u32 s33, s48, 0
  buffer_load_dwordx4 v[132:135], v2, s[8:11], s33 offen offset:3072
fused_kernel_g_49:
  v_exp_f32 v54, v54
  v_exp_f32 v55, v55
  v_cvt_pk_bf16_f32 v62, v52, v53
  v_cvt_pk_bf16_f32 v63, v54, v55
  v_add_u32 v105, v106, v105
  s_waitcnt lgkmcnt(3)
  s_cmp_lt_u32 s22, 4
  s_cbranch_scc1 fused_kernel_g_50
  v_cmp_gt_u32 vcc, 4, v113
  s_cmp_eq_u64 vcc, 0
  s_cbranch_scc1 fused_kernel_ck_51_ok
  s_mov_b32 s60, 0
fused_kernel_ck_51:
  ds_read_b32 v113, v110 offset:0
  s_waitcnt lgkmcnt(0)
  v_cmp_gt_u32 vcc, 4, v113
  s_cmp_eq_u64 vcc, 0
  s_cbranch_scc1 fused_kernel_ck_51_ok
  s_add_u32 s60, s60, 1
  s_cmp_lt_u32 s60, 640000
  s_cbranch_scc1 fused_kernel_ck_51
fused_kernel_ck_51_ok:
fused_kernel_g_50:
  v_exp_f32 v24, v24
  v_exp_f32 v25, v25
  v_mfma_f32_32x32x16_bf16 v[64:79], v[96:99], v[56:59], v[64:79]
  v_exp_f32 v26, v26
  v_exp_f32 v27, v27
  v_cvt_pk_bf16_f32 v56, v24, v25
  v_exp_f32 v28, v28
  v_exp_f32 v29, v29
  v_cvt_pk_bf16_f32 v57, v26, v27
  v_mfma_f32_32x32x16_bf16 v[64:79], v[100:103], v[60:63], v[64:79]
  ds_read_b128 v[96:99], v105 offset:1024
  ds_read_b128 v[100:103], v105 offset:1536
  v_exp_f32 v30, v30
  v_exp_f32 v31, v31
  v_cvt_pk_bf16_f32 v58, v28, v29
  v_exp_f32 v32, v32
  v_exp_f32 v33, v33
  v_cvt_pk_bf16_f32 v59, v30, v31
  v_mfma_f32_32x32x16_bf16 v[40:55], v[84:87], v[4:7], v[8:23]
  ds_read_b128 v[84:87], v3 offset:37888
  v_exp_f32 v34, v34
  v_exp_f32 v35, v35
  v_cvt_pk_bf16_f32 v60, v32, v33
  v_exp_f32 v36, v36
  v_exp_f32 v37, v37
  v_cvt_pk_bf16_f32 v61, v34, v35
  s_cmp_lt_u32 s22, 4
  s_cbranch_scc1 fused_kernel_g_52_a
  s_add_u32 m0, s38, 24576
  s_add_u32 s33, s36, 24576
  buffer_load_dwordx4 v3, s[8:11], s33 offen offset:0 lds
  buffer_load_dwordx4 v3, s[8:11], s33 offen offset:1024 lds
  s_branch fused_kernel_g_52
fused_kernel_g_52_a:
  s_add_u32 s33, s48, 4096
  buffer_load_dwordx4 v[136:139], v2, s[8:11], s33 offen offset:0
fused_kernel_g_52:
  v_exp_f32 v38, v38
  v_exp_f32 v39, v39
  v_cvt_pk_bf16_f32 v62, v36, v37
  v_cvt_pk_bf16_f32 v63, v38, v39
  s_waitcnt lgkmcnt(3)
  s_cmp_ge_u32 s22, 4
  s_cbranch_scc1 fused_kernel_g_53
  s_waitcnt vmcnt(43)
  v_mov_b32 v112, 5
  s_mov_b64 exec, 1
  ds_write_b32 v109, v112 offset:64
  s_mov_b64 exec, -1
fused_kernel_g_53:
  v_exp_f32 v40, v40
  v_exp_f32 v41, v41
  v_mfma_f32_32x32x16_bf16 v[64:79], v[88:91], v[56:59], v[64:79]
  v_exp_f32 v42, v42
  v_exp_f32 v43, v43
  v_cvt_pk_bf16_f32 v56, v40, v41
  v_exp_f32 v44, v44
  v_exp_f32 v45, v45
  v_cvt_pk_bf16_f32 v57, v42, v43
  v_mfma_f32_32x32x16_bf16 v[64:79], v[92:95], v[60:63], v[64:79]
  ds_read_b128 v[88:91], v105 offset:2048
  ds_read_b128 v[92:95], v105 offset:2560
  v_exp_f32 v46, v46
  v_exp_f32 v47, v47
  v_cvt_pk_bf16_f32 v58, v44, v45
  v_exp_f32 v48, v48
  v_exp_f32 v49, v49
  v_cvt_pk_bf16_f32 v59, v46, v47
  v_mfma_f32_32x32x16_bf16 v[24:39], v[80:83], v[4:7], v[8:23]
  ds_read_b128 v[80:83], v3 offset:38912
  v_exp_f32 v50, v50
  v_exp_f32 v51, v51
  v_cvt_pk_bf16_f32 v60, v48, v49
  v_exp_f32 v52, v52
  v_exp_f32 v53, v53
  v_cvt_pk_bf16_f32 v61, v50, v51
  s_cmp_lt_u32 s22, 4
  s_cbranch_scc1 fused_kernel_g_54_a
  s_add_u32 m0, s38, 90112
  s_add_u32 s33, s36, 57344
  buffer_load_dwordx4 v3, s[8:11], s33 offen offset:0 lds
  buffer_load_dwordx4 v3, s[8:11], s33 offen offset:1024 lds
  s_branch fused_kernel_g_54
fused_kernel_g_54_a:
  s_add_u32 s33, s48, 4096
  buffer_load_dwordx4 v[140:143], v2, s[8:11], s33 offen offset:1024
fused_kernel_g_54:
  v_exp_f32 v54, v54
  v_exp_f32 v55, v55
  v_cvt_pk_bf16_f32 v62, v52, v53
  v_cvt_pk_bf16_f32 v63, v54, v55
  v_add_u32 v105, v106, v105
  s_waitcnt lgkmcnt(3)
  v_exp_f32 v24, v24
  v_exp_f32 v25, v25
  v_mfma_f32_32x32x16_bf16 v[64:79], v[96:99], v[56:59], v[64:79]
  v_exp_f32 v26, v26
  v_exp_f32 v27, v27
  v_cvt_pk_bf16_f32 v56, v24, v25
  ds_read_b32 v113, v111 offset:64
  v_exp_f32 v28, v28
  v_exp_f32 v29, v29
  v_cvt_pk_bf16_f32 v57, v26, v27
  v_mfma_f32_32x32x16_bf16 v[64:79], v[100:103], v[60:63], v[64:79]
  ds_read_b128 v[96:99], v105 offset:1024
  ds_read_b128 v[100:103], v105 offset:1536
  v_exp_f32 v30, v30
  v_exp_f32 v31, v31
  v_cvt_pk_bf16_f32 v58, v28, v29
  v_exp_f32 v32, v32
  v_exp_f32 v33, v33
  v_cvt_pk_bf16_f32 v59, v30, v31
  v_mfma_f32_32x32x16_bf16 v[40:55], v[84:87], v[4:7], v[8:23]
  ds_read_b128 v[84:87], v3 offset:39936
  v_exp_f32 v34, v34
  v_exp_f32 v35, v35
  v_cvt_pk_bf16_f32 v60, v32, v33
  v_exp_f32 v36, v36
  v_exp_f32 v37, v37
  v_cvt_pk_bf16_f32 v61, v34, v35
  s_cmp_lt_u32 s22, 4
  s_cbranch_scc1 fused_kernel_g_55_a
  s_mul_i32 s33, s40, 44032
  s_add_u32 s33, s33, s52
  s_add_u32 s33, s33, s38
  buffer_load_dwordx4 v[236:239], v3, s[8:11], s33 offen
  s_mul_i32 s33, s40, 44032
  s_add_u32 s33, s33, s52
  s_add_u32 s33, s33, s38
  s_add_u32 s33, s33, 1024
  buffer_load_dwordx4 v[236:239], v3, s[8:11], s33 offen
  s_branch fused_kernel_g_55
fused_kernel_g_55_a:
  s_add_u32 s33, s48, 4096
  buffer_load_dwordx4 v[144:147], v2, s[8:11], s33 offen offset:2048
fused_kernel_g_55:
  v_exp_f32 v38, v38
  v_exp_f32 v39, v39
  v_cvt_pk_bf16_f32 v62, v36, v37
  v_cvt_pk_bf16_f32 v63, v38, v39
  s_waitcnt lgkmcnt(3)
  v_cmp_gt_u32 vcc, 5, v113
  s_cmp_eq_u64 vcc, 0
  s_cbranch_scc1 fused_kernel_ck_56_ok
  s_mov_b32 s60, 0
fused_kernel_ck_56:
  ds_read_b32 v113, v111 offset:64
  s_waitcnt lgkmcnt(0)
  v_cmp_gt_u32 vcc, 5, v113
  s_cmp_eq_u64 vcc, 0
  s_cbranch_scc1 fused_kernel_ck_56_ok
  s_add_u32 s60, s60, 1
  s_cmp_lt_u32 s60, 640000
  s_cbranch_scc1 fused_kernel_ck_56
fused_kernel_ck_56_ok:
  v_exp_f32 v40, v40
  v_exp_f32 v41, v41
  v_mfma_f32_32x32x16_bf16 v[64:79], v[88:91], v[56:59], v[64:79]
  v_exp_f32 v42, v42
  v_exp_f32 v43, v43
  v_cvt_pk_bf16_f32 v56, v40, v41
  v_exp_f32 v44, v44
  v_exp_f32 v45, v45
  v_cvt_pk_bf16_f32 v57, v42, v43
  v_mfma_f32_32x32x16_bf16 v[64:79], v[92:95], v[60:63], v[64:79]
  ds_read_b128 v[88:91], v105 offset:2048
  ds_read_b128 v[92:95], v105 offset:2560
  v_exp_f32 v46, v46
  v_exp_f32 v47, v47
  v_cvt_pk_bf16_f32 v58, v44, v45
  v_exp_f32 v48, v48
  v_exp_f32 v49, v49
  v_cvt_pk_bf16_f32 v59, v46, v47
  v_mfma_f32_32x32x16_bf16 v[24:39], v[80:83], v[4:7], v[8:23]
  ds_read_b128 v[80:83], v3 offset:40960
  v_exp_f32 v50, v50
  v_exp_f32 v51, v51
  v_cvt_pk_bf16_f32 v60, v48, v49
  v_exp_f32 v52, v52
  v_exp_f32 v53, v53
  v_cvt_pk_bf16_f32 v61, v50, v51
  s_cmp_lt_u32 s22, 4
  s_cbranch_scc1 fused_kernel_g_57_a
  s_mul_i32 s33, s40, 44032
  s_add_u32 s33, s33, s52
  s_add_u32 s33, s33, s38
  s_add_u32 s33, s33, 8192
  buffer_load_dwordx4 v[236:239], v3, s[8:11], s33 offen
  s_mul_i32 s33, s40, 44032
  s_add_u32 s33, s33, s52
  s_add_u32 s33, s33, s38
  s_add_u32 s33, s33, 9216
  buffer_load_dwordx4 v[236:239], v3, s[8:11], s33 offen
  s_branch fused_kernel_g_57
fused_kernel_g_57_a:
  s_add_u32 s33, s48, 4096
  buffer_load_dwordx4 v[148:151], v2, s[8:11], s33 offen offset:3072
fused_kernel_g_57:
  v_exp_f32 v54, v54
  v_exp_f32 v55, v55
  v_cvt_pk_bf16_f32 v62, v52, v53
  v_cvt_pk_bf16_f32 v63, v54, v55
  v_add_u32 v105, v106, v105
  s_waitcnt lgkmcnt(3)
  v_exp_f32 v24, v24
  v_exp_f32 v25, v25
  v_mfma_f32_32x32x16_bf16 v[64:79], v[96:99], v[56:59], v[64:79]
  v_exp_f32 v26, v26
  v_exp_f32 v27, v27
  v_cvt_pk_bf16_f32 v56, v24, v25
  v_exp_f32 v28, v28
  v_exp_f32 v29, v29
  v_cvt_pk_bf16_f32 v57, v26, v27
  v_mfma_f32_32x32x16_bf16 v[64:79], v[100:103], v[60:63], v[64:79]
  ds_read_b128 v[96:99], v105 offset:1024
  ds_read_b128 v[100:103], v105 offset:1536
  v_exp_f32 v30, v30
  v_exp_f32 v31, v31
  v_cvt_pk_bf16_f32 v58, v28, v29
  v_exp_f32 v32, v32
  v_exp_f32 v33, v33
  v_cvt_pk_bf16_f32 v59, v30, v31
  v_mfma_f32_32x32x16_bf16 v[40:55], v[84:87], v[4:7], v[8:23]
  ds_read_b128 v[84:87], v3 offset:41984
  v_exp_f32 v34, v34
  v_exp_f32 v35, v35
  v_cvt_pk_bf16_f32 v60, v32, v33
  v_exp_f32 v36, v36
  v_exp_f32 v37, v37
  v_cvt_pk_bf16_f32 v61, v34, v35
  s_cmp_lt_u32 s22, 4
  s_cbranch_scc1 fused_kernel_g_58_a
  s_mul_i32 s33, s40, 44032
  s_add_u32 s33, s33, s52
  s_add_u32 s33, s33, s38
  s_add_u32 s33, s33, 16384
  buffer_load_dwordx4 v[236:239], v3, s[8:11], s33 offen
  s_mul_i32 s33, s40, 44032
  s_add_u32 s33, s33, s52
  s_add_u32 s33, s33, s38
  s_add_u32 s33, s33, 17408
  buffer_load_dwordx4 v[236:239], v3, s[8:11], s33 offen
  s_branch fused_kernel_g_58
fused_kernel_g_58_a:
  s_add_u32 s33, s53, 0
  buffer_load_dwordx4 v[152:155], v2, s[8:11], s33 offen offset:0
fused_kernel_g_58:
  v_exp_f32 v38, v38
  v_exp_f32 v39, v39
  v_cvt_pk_bf16_f32 v62, v36, v37
  v_cvt_pk_bf16_f32 v63, v38, v39
  s_waitcnt lgkmcnt(3)
  v_exp_f32 v40, v40
  v_exp_f32 v41, v41
  v_mfma_f32_32x32x16_bf16 v[64:79], v[88:91], v[56:59], v[64:79]
  v_exp_f32 v42, v42
  v_exp_f32 v43, v43
  v_cvt_pk_bf16_f32 v56, v40, v41
  v_exp_f32 v44, v44
  v_exp_f32 v45, v45
  v_cvt_pk_bf16_f32 v57, v42, v43
  v_mfma_f32_32x32x16_bf16 v[64:79], v[92:95], v[60:63], v[64:79]
  ds_read_b128 v[88:91], v105 offset:2048
  ds_read_b128 v[92:95], v105 offset:2560
  v_exp_f32 v46, v46
  v_exp_f32 v47, v47
  v_cvt_pk_bf16_f32 v58, v44, v45
  v_exp_f32 v48, v48
  v_exp_f32 v49, v49
  v_cvt_pk_bf16_f32 v59, v46, v47
  v_mfma_f32_32x32x16_bf16 v[24:39], v[80:83], v[4:7], v[8:23]
  ds_read_b128 v[80:83], v3 offset:43008
  v_exp_f32 v50, v50
  v_exp_f32 v51, v51
  v_cvt_pk_bf16_f32 v60, v48, v49
  v_exp_f32 v52, v52
  v_exp_f32 v53, v53
  v_cvt_pk_bf16_f32 v61, v50, v51
  s_cmp_lt_u32 s22, 4
  s_cbranch_scc1 fused_kernel_g_59_a
  s_mul_i32 s33, s40, 44032
  s_add_u32 s33, s33, s52
  s_add_u32 s33, s33, s38
  s_add_u32 s33, s33, 24576
  buffer_load_dwordx4 v[236:239], v3, s[8:11], s33 offen
  s_mul_i32 s33, s40, 44032
  s_add_u32 s33, s33, s52
  s_add_u32 s33, s33, s38
  s_add_u32 s33, s33, 25600
  buffer_load_dwordx4 v[236:239], v3, s[8:11], s33 offen
  s_branch fused_kernel_g_59
fused_kernel_g_59_a:
  s_add_u32 s33, s53, 0
  buffer_load_dwordx4 v[156:159], v2, s[8:11], s33 offen offset:1024
fused_kernel_g_59:
  v_exp_f32 v54, v54
  v_exp_f32 v55, v55
  v_cvt_pk_bf16_f32 v62, v52, v53
  v_cvt_pk_bf16_f32 v63, v54, v55
  v_add_u32 v105, v106, v105
  s_waitcnt lgkmcnt(3)
  v_mov_b32 v112, 5
  s_mov_b64 exec, 1
  ds_write_b32 v109, v112 offset:0
  s_mov_b64 exec, -1
  v_exp_f32 v24, v24
  v_exp_f32 v25, v25
  v_mfma_f32_32x32x16_bf16 v[64:79], v[96:99], v[56:59], v[64:79]
  v_exp_f32 v26, v26
  v_exp_f32 v27, v27
  v_cvt_pk_bf16_f32 v56, v24, v25
  v_exp_f32 v28, v28
  v_exp_f32 v29, v29
  v_cvt_pk_bf16_f32 v57, v26, v27
  v_mfma_f32_32x32x16_bf16 v[64:79], v[100:103], v[60:63], v[64:79]
  ds_read_b128 v[96:99], v105 offset:1024
  ds_read_b128 v[100:103], v105 offset:1536
  v_exp_f32 v30, v30
  v_exp_f32 v31, v31
  v_cvt_pk_bf16_f32 v58, v28, v29
  v_exp_f32 v32, v32
  v_exp_f32 v33, v33
  v_cvt_pk_bf16_f32 v59, v30, v31
  v_mfma_f32_32x32x16_bf16 v[40:55], v[84:87], v[4:7], v[8:23]
  ds_read_b128 v[84:87], v3 offset:44032
  v_exp_f32 v34, v34
  v_exp_f32 v35, v35
  v_cvt_pk_bf16_f32 v60, v32, v33
  v_exp_f32 v36, v36
  v_exp_f32 v37, v37
  v_cvt_pk_bf16_f32 v61, v34, v35
  s_cmp_lt_u32 s22, 4
  s_cbranch_scc1 fused_kernel_g_60_a
  s_mul_i32 s33, s40, 44032
  s_add_u32 s33, s33, s52
  s_add_u32 s33, s33, s38
  s_add_u32 s33, s33, 32768
  buffer_load_dwordx4 v[236:239], v3, s[8:11], s33 offen
  s_mul_i32 s33, s40, 44032
  s_add_u32 s33, s33, s52
  s_add_u32 s33, s33, s38
  s_add_u32 s33, s33, 33792
  buffer_load_dwordx4 v[236:239], v3, s[8:11], s33 offen
  s_branch fused_kernel_g_60
fused_kernel_g_60_a:
  s_add_u32 s33, s53, 0
  buffer_load_dwordx4 v[160:163], v2, s[8:11], s33 offen offset:2048
fused_kernel_g_60:
  v_exp_f32 v38, v38
  v_exp_f32 v39, v39
  v_cvt_pk_bf16_f32 v62, v36, v37
  v_cvt_pk_bf16_f32 v63, v38, v39
  s_waitcnt lgkmcnt(4)
  v_exp_f32 v40, v40
  v_exp_f32 v41, v41
  v_mfma_f32_32x32x16_bf16 v[64:79], v[88:91], v[56:59], v[64:79]
  v_exp_f32 v42, v42
  v_exp_f32 v43, v43
  v_cvt_pk_bf16_f32 v56, v40, v41
  ds_read_b32 v113, v110 offset:0
  v_exp_f32 v44, v44
  v_exp_f32 v45, v45
  v_cvt_pk_bf16_f32 v57, v42, v43
  v_mfma_f32_32x32x16_bf16 v[64:79], v[92:95], v[60:63], v[64:79]
  ds_read_b128 v[88:91], v105 offset:2048
  ds_read_b128 v[92:95], v105 offset:2560
  v_exp_f32 v46, v46
  v_exp_f32 v47, v47
  v_cvt_pk_bf16_f32 v58, v44, v45
  v_exp_f32 v48, v48
  v_exp_f32 v49, v49
  v_cvt_pk_bf16_f32 v59, v46, v47
  v_mfma_f32_32x32x16_bf16 v[24:39], v[80:83], v[4:7], v[8:23]
  ds_read_b128 v[80:83], v3 offset:45056
  v_exp_f32 v50, v50
  v_exp_f32 v51, v51
  v_cvt_pk_bf16_f32 v60, v48, v49
  v_exp_f32 v52, v52
  v_exp_f32 v53, v53
  v_cvt_pk_bf16_f32 v61, v50, v51
  s_cmp_lt_u32 s22, 4
  s_cbranch_scc1 fused_kernel_g_61_a
  s_mul_i32 s33, s40, 44032
  s_add_u32 s33, s33, s52
  s_add_u32 s33, s33, s38
  s_add_u32 s33, s33, 40960
  buffer_load_dwordx4 v[236:239], v3, s[8:11], s33 offen
  s_branch fused_kernel_g_61
fused_kernel_g_61_a:
  s_add_u32 s33, s53, 0
  buffer_load_dwordx4 v[164:167], v2, s[8:11], s33 offen offset:3072
fused_kernel_g_61:
  v_exp_f32 v54, v54
  v_exp_f32 v55, v55
  v_cvt_pk_bf16_f32 v62, v52, v53
  v_cvt_pk_bf16_f32 v63, v54, v55
  v_add_u32 v105, v106, v105
  s_waitcnt lgkmcnt(3)
  s_cmp_lt_u32 s22, 4
  s_cbranch_scc1 fused_kernel_g_62
  v_cmp_gt_u32 vcc, 5, v113
  s_cmp_eq_u64 vcc, 0
  s_cbranch_scc1 fused_kernel_ck_63_ok
  s_mov_b32 s60, 0
fused_kernel_ck_63:
  ds_read_b32 v113, v110 offset:0
  s_waitcnt lgkmcnt(0)
  v_cmp_gt_u32 vcc, 5, v113
  s_cmp_eq_u64 vcc, 0
  s_cbranch_scc1 fused_kernel_ck_63_ok
  s_add_u32 s60, s60, 1
  s_cmp_lt_u32 s60, 640000
  s_cbranch_scc1 fused_kernel_ck_63
fused_kernel_ck_63_ok:
fused_kernel_g_62:
  v_exp_f32 v24, v24
  v_exp_f32 v25, v25
  v_mfma_f32_32x32x16_bf16 v[64:79], v[96:99], v[56:59], v[64:79]
  v_exp_f32 v26, v26
  v_exp_f32 v27, v27
  v_cvt_pk_bf16_f32 v56, v24, v25
  v_exp_f32 v28, v28
  v_exp_f32 v29, v29
  v_cvt_pk_bf16_f32 v57, v26, v27
  v_mfma_f32_32x32x16_bf16 v[64:79], v[100:103], v[60:63], v[64:79]
  ds_read_b128 v[96:99], v105 offset:1024
  ds_read_b128 v[100:103], v105 offset:1536
  v_exp_f32 v30, v30
  v_exp_f32 v31, v31
  v_cvt_pk_bf16_f32 v58, v28, v29
  v_exp_f32 v32, v32
  v_exp_f32 v33, v33
  v_cvt_pk_bf16_f32 v59, v30, v31
  v_mfma_f32_32x32x16_bf16 v[40:55], v[84:87], v[4:7], v[8:23]
  ds_read_b128 v[84:87], v3 offset:46080
  v_exp_f32 v34, v34
  v_exp_f32 v35, v35
  v_cvt_pk_bf16_f32 v60, v32, v33
  v_exp_f32 v36, v36
  v_exp_f32 v37, v37
  v_cvt_pk_bf16_f32 v61, v34, v35
  s_cmp_lt_u32 s22, 4
  s_cbranch_scc1 fused_kernel_g_64_a
  s_add_u32 m0, s38, 32768
  s_add_u32 s33, s36, 65536
  buffer_load_dwordx4 v3, s[8:11], s33 offen offset:0 lds
  buffer_load_dwordx4 v3, s[8:11], s33 offen offset:1024 lds
  s_branch fused_kernel_g_64
fused_kernel_g_64_a:
  s_add_u32 s33, s53, 4096
  buffer_load_dwordx4 v[168:171], v2, s[8:11], s33 offen offset:0
fused_kernel_g_64:
  v_exp_f32 v38, v38
  v_exp_f32 v39, v39
  v_cvt_pk_bf16_f32 v62, v36, v37
  v_cvt_pk_bf16_f32 v63, v38, v39
  s_waitcnt lgkmcnt(3)
  s_cmp_ge_u32 s22, 4
  s_cbranch_scc1 fused_kernel_g_65
  s_waitcnt vmcnt(47)
  v_mov_b32 v112, 6
  s_mov_b64 exec, 1
  ds_write_b32 v109, v112 offset:64
  s_mov_b64 exec, -1
fused_kernel_g_65:
  v_exp_f32 v40, v40
  v_exp_f32 v41, v41
  v_mfma_f32_32x32x16_bf16 v[64:79], v[88:91], v[56:59], v[64:79]
  v_exp_f32 v42, v42
  v_exp_f32 v43, v43
  v_cvt_pk_bf16_f32 v56, v40, v41
  v_exp_f32 v44, v44
  v_exp_f32 v45, v45
  v_cvt_pk_bf16_f32 v57, v42, v43
  v_mfma_f32_32x32x16_bf16 v[64:79], v[92:95], v[60:63], v[64:79]
  ds_read_b128 v[88:91], v105 offset:2048
  ds_read_b128 v[92:95], v105 offset:2560
  v_exp_f32 v46, v46
  v_exp_f32 v47, v47
  v_cvt_pk_bf16_f32 v58, v44, v45
  v_exp_f32 v48, v48
  v_exp_f32 v49, v49
  v_cvt_pk_bf16_f32 v59, v46, v47
  v_mfma_f32_32x32x16_bf16 v[24:39], v[80:83], v[4:7], v[8:23]
  ds_read_b128 v[80:83], v3 offset:47104
  v_exp_f32 v50, v50
  v_exp_f32 v51, v51
  v_cvt_pk_bf16_f32 v60, v48, v49
  v_exp_f32 v52, v52
  v_exp_f32 v53, v53
  v_cvt_pk_bf16_f32 v61, v50, v51
  s_cmp_lt_u32 s22, 4
  s_cbranch_scc1 fused_kernel_g_66_a
  s_add_u32 m0, s38, 98304
  s_add_u32 s33, s36, 81920
  buffer_load_dwordx4 v3, s[8:11], s33 offen offset:0 lds
  buffer_load_dwordx4 v3, s[8:11], s33 offen offset:1024 lds
  s_branch fused_kernel_g_66
fused_kernel_g_66_a:
  s_add_u32 s33, s53, 4096
  buffer_load_dwordx4 v[172:175], v2, s[8:11], s33 offen offset:1024
fused_kernel_g_66:
  v_exp_f32 v54, v54
  v_exp_f32 v55, v55
  v_cvt_pk_bf16_f32 v62, v52, v53
  v_cvt_pk_bf16_f32 v63, v54, v55
  v_add_u32 v105, v106, v105
  s_waitcnt lgkmcnt(3)
  v_exp_f32 v24, v24
  v_exp_f32 v25, v25
  v_mfma_f32_32x32x16_bf16 v[64:79], v[96:99], v[56:59], v[64:79]
  v_exp_f32 v26, v26
  v_exp_f32 v27, v27
  v_cvt_pk_bf16_f32 v56, v24, v25
  ds_read_b32 v113, v111 offset:64
  v_exp_f32 v28, v28
  v_exp_f32 v29, v29
  v_cvt_pk_bf16_f32 v57, v26, v27
  v_mfma_f32_32x32x16_bf16 v[64:79], v[100:103], v[60:63], v[64:79]
  ds_read_b128 v[96:99], v105 offset:1024
  ds_read_b128 v[100:103], v105 offset:1536
  v_exp_f32 v30, v30
  v_exp_f32 v31, v31
  v_cvt_pk_bf16_f32 v58, v28, v29
  v_exp_f32 v32, v32
  v_exp_f32 v33, v33
  v_cvt_pk_bf16_f32 v59, v30, v31
  v_mfma_f32_32x32x16_bf16 v[40:55], v[84:87], v[4:7], v[8:23]
  ds_read_b128 v[84:87], v3 offset:48128
  v_exp_f32 v34, v34
  v_exp_f32 v35, v35
  v_cvt_pk_bf16_f32 v60, v32, v33
  v_exp_f32 v36, v36
  v_exp_f32 v37, v37
  v_cvt_pk_bf16_f32 v61, v34, v35
  s_cmp_ge_u32 s22, 4
  s_cbranch_scc1 fused_kernel_g_67
  s_add_u32 s33, s53, 4096
  buffer_load_dwordx4 v[176:179], v2, s[8:11], s33 offen offset:2048
fused_kernel_g_67:
  v_exp_f32 v38, v38
  v_exp_f32 v39, v39
  v_cvt_pk_bf16_f32 v62, v36, v37
  v_cvt_pk_bf16_f32 v63, v38, v39
  s_waitcnt lgkmcnt(3)
  v_cmp_gt_u32 vcc, 6, v113
  s_cmp_eq_u64 vcc, 0
  s_cbranch_scc1 fused_kernel_ck_68_ok
  s_mov_b32 s60, 0
fused_kernel_ck_68:
  ds_read_b32 v113, v111 offset:64
  s_waitcnt lgkmcnt(0)
  v_cmp_gt_u32 vcc, 6, v113
  s_cmp_eq_u64 vcc, 0
  s_cbranch_scc1 fused_kernel_ck_68_ok
  s_add_u32 s60, s60, 1
  s_cmp_lt_u32 s60, 640000
  s_cbranch_scc1 fused_kernel_ck_68
fused_kernel_ck_68_ok:
  v_exp_f32 v40, v40
  v_exp_f32 v41, v41
  v_mfma_f32_32x32x16_bf16 v[64:79], v[88:91], v[56:59], v[64:79]
  v_exp_f32 v42, v42
  v_exp_f32 v43, v43
  v_cvt_pk_bf16_f32 v56, v40, v41
  v_exp_f32 v44, v44
  v_exp_f32 v45, v45
  v_cvt_pk_bf16_f32 v57, v42, v43
  v_mfma_f32_32x32x16_bf16 v[64:79], v[92:95], v[60:63], v[64:79]
  ds_read_b128 v[88:91], v105 offset:2048
  ds_read_b128 v[92:95], v105 offset:2560
  v_exp_f32 v46, v46
  v_exp_f32 v47, v47
  v_cvt_pk_bf16_f32 v58, v44, v45
  v_exp_f32 v48, v48
  v_exp_f32 v49, v49
  v_cvt_pk_bf16_f32 v59, v46, v47
  v_mfma_f32_32x32x16_bf16 v[24:39], v[80:83], v[4:7], v[8:23]
  ds_read_b128 v[80:83], v3 offset:49152
  v_exp_f32 v50, v50
  v_exp_f32 v51, v51
  v_cvt_pk_bf16_f32 v60, v48, v49
  v_exp_f32 v52, v52
  v_exp_f32 v53, v53
  v_cvt_pk_bf16_f32 v61, v50, v51
  s_cmp_ge_u32 s22, 4
  s_cbranch_scc1 fused_kernel_g_69
  s_add_u32 s33, s53, 4096
  buffer_load_dwordx4 v[180:183], v2, s[8:11], s33 offen offset:3072
fused_kernel_g_69:
  v_exp_f32 v54, v54
  v_exp_f32 v55, v55
  v_cvt_pk_bf16_f32 v62, v52, v53
  v_cvt_pk_bf16_f32 v63, v54, v55
  v_add_u32 v105, v106, v105
  s_waitcnt lgkmcnt(3)
  v_exp_f32 v24, v24
  v_exp_f32 v25, v25
  v_mfma_f32_32x32x16_bf16 v[64:79], v[96:99], v[56:59], v[64:79]
  v_exp_f32 v26, v26
  v_exp_f32 v27, v27
  v_cvt_pk_bf16_f32 v56, v24, v25
  v_exp_f32 v28, v28
  v_exp_f32 v29, v29
  v_cvt_pk_bf16_f32 v57, v26, v27
  v_mfma_f32_32x32x16_bf16 v[64:79], v[100:103], v[60:63], v[64:79]
  ds_read_b128 v[96:99], v105 offset:1024
  ds_read_b128 v[100:103], v105 offset:1536
  v_exp_f32 v30, v30
  v_exp_f32 v31, v31
  v_cvt_pk_bf16_f32 v58, v28, v29
  v_exp_f32 v32, v32
  v_exp_f32 v33, v33
  v_cvt_pk_bf16_f32 v59, v30, v31
  v_mfma_f32_32x32x16_bf16 v[40:55], v[84:87], v[4:7], v[8:23]
  ds_read_b128 v[84:87], v3 offset:50176
  v_exp_f32 v34, v34
  v_exp_f32 v35, v35
  v_cvt_pk_bf16_f32 v60, v32, v33
  v_exp_f32 v36, v36
  v_exp_f32 v37, v37
  v_cvt_pk_bf16_f32 v61, v34, v35
  v_exp_f32 v38, v38
  v_exp_f32 v39, v39
  v_cvt_pk_bf16_f32 v62, v36, v37
  v_cvt_pk_bf16_f32 v63, v38, v39
  s_waitcnt lgkmcnt(3)
  v_exp_f32 v40, v40
  v_exp_f32 v41, v41
  v_mfma_f32_32x32x16_bf16 v[64:79], v[88:91], v[56:59], v[64:79]
  v_exp_f32 v42, v42
  v_exp_f32 v43, v43
  v_cvt_pk_bf16_f32 v56, v40, v41
  v_exp_f32 v44, v44
  v_exp_f32 v45, v45
  v_cvt_pk_bf16_f32 v57, v42, v43
  v_mfma_f32_32x32x16_bf16 v[64:79], v[92:95], v[60:63], v[64:79]
  ds_read_b128 v[88:91], v105 offset:2048
  ds_read_b128 v[92:95], v105 offset:2560
  v_exp_f32 v46, v46
  v_exp_f32 v47, v47
  v_cvt_pk_bf16_f32 v58, v44, v45
  v_exp_f32 v48, v48
  v_exp_f32 v49, v49
  v_cvt_pk_bf16_f32 v59, v46, v47
  v_mfma_f32_32x32x16_bf16 v[24:39], v[80:83], v[4:7], v[8:23]
  ds_read_b128 v[80:83], v3 offset:51200
  v_exp_f32 v50, v50
  v_exp_f32 v51, v51
  v_cvt_pk_bf16_f32 v60, v48, v49
  v_exp_f32 v52, v52
  v_exp_f32 v53, v53
  v_cvt_pk_bf16_f32 v61, v50, v51
  v_exp_f32 v54, v54
  v_exp_f32 v55, v55
  v_cvt_pk_bf16_f32 v62, v52, v53
  v_cvt_pk_bf16_f32 v63, v54, v55
  v_add_u32 v105, v106, v105
  s_waitcnt lgkmcnt(3)
  v_mov_b32 v112, 6
  s_mov_b64 exec, 1
  ds_write_b32 v109, v112 offset:0
  s_mov_b64 exec, -1
  v_exp_f32 v24, v24
  v_exp_f32 v25, v25
  v_mfma_f32_32x32x16_bf16 v[64:79], v[96:99], v[56:59], v[64:79]
  v_exp_f32 v26, v26
  v_exp_f32 v27, v27
  v_cvt_pk_bf16_f32 v56, v24, v25
  v_exp_f32 v28, v28
  v_exp_f32 v29, v29
  v_cvt_pk_bf16_f32 v57, v26, v27
  v_mfma_f32_32x32x16_bf16 v[64:79], v[100:103], v[60:63], v[64:79]
  ds_read_b128 v[96:99], v105 offset:1024
  ds_read_b128 v[100:103], v105 offset:1536
  v_exp_f32 v30, v30
  v_exp_f32 v31, v31
  v_cvt_pk_bf16_f32 v58, v28, v29
  v_exp_f32 v32, v32
  v_exp_f32 v33, v33
  v_cvt_pk_bf16_f32 v59, v30, v31
  v_mfma_f32_32x32x16_bf16 v[40:55], v[84:87], v[4:7], v[8:23]
  ds_read_b128 v[84:87], v3 offset:52224
  v_exp_f32 v34, v34
  v_exp_f32 v35, v35
  v_cvt_pk_bf16_f32 v60, v32, v33
  v_exp_f32 v36, v36
  v_exp_f32 v37, v37
  v_cvt_pk_bf16_f32 v61, v34, v35
  s_lshl_b32 s33, s27, 15
  s_lshl_b32 s34, s21, 10
  s_add_u32 s33, s33, s34
  s_add_u32 s33, s33, 9437184
  buffer_load_dwordx4 v[236:239], v3, s[8:11], s33 offen sc1
  s_and_b32 s33, s30, 3072
  s_add_u32 s33, s33, s23
  buffer_load_dwordx4 v[236:239], v3, s[8:11], s33 offen sc1
  v_exp_f32 v38, v38
  v_exp_f32 v39, v39
  v_cvt_pk_bf16_f32 v62, v36, v37
  v_cvt_pk_bf16_f32 v63, v38, v39
  s_waitcnt lgkmcnt(4)
  v_exp_f32 v40, v40
  v_exp_f32 v41, v41
  v_mfma_f32_32x32x16_bf16 v[64:79], v[88:91], v[56:59], v[64:79]
  v_exp_f32 v42, v42
  v_exp_f32 v43, v43
  v_cvt_pk_bf16_f32 v56, v40, v41
  ds_read_b32 v113, v110 offset:0
  v_exp_f32 v44, v44
  v_exp_f32 v45, v45
  v_cvt_pk_bf16_f32 v57, v42, v43
  v_mfma_f32_32x32x16_bf16 v[64:79], v[92:95], v[60:63], v[64:79]
  ds_read_b128 v[88:91], v105 offset:2048
  ds_read_b128 v[92:95], v105 offset:2560
  v_exp_f32 v46, v46
  v_exp_f32 v47, v47
  v_cvt_pk_bf16_f32 v58, v44, v45
  v_exp_f32 v48, v48
  v_exp_f32 v49, v49
  v_cvt_pk_bf16_f32 v59, v46, v47
  v_mfma_f32_32x32x16_bf16 v[24:39], v[80:83], v[4:7], v[8:23]
  ds_read_b128 v[80:83], v3 offset:53248
  v_exp_f32 v50, v50
  v_exp_f32 v51, v51
  v_cvt_pk_bf16_f32 v60, v48, v49
  v_exp_f32 v52, v52
  v_exp_f32 v53, v53
  v_cvt_pk_bf16_f32 v61, v50, v51
  s_lshl_b32 s33, s44, 15
  s_lshl_b32 s34, s46, 10
  s_add_u32 s33, s33, s34
  s_add_u32 s33, s33, 11534336
  buffer_load_dwordx4 v[236:239], v3, s[8:11], s33 offen sc1
  s_lshl_b32 s33, s44, 13
  s_lshl_b32 s34, s46, 8
  s_add_u32 s33, s33, s34
  s_add_u32 s33, s33, 29622272
  buffer_load_dword v236, v118, s[8:11], s33 offen sc1
  v_exp_f32 v54, v54
  v_exp_f32 v55, v55
  v_cvt_pk_bf16_f32 v62, v52, v53
  v_cvt_pk_bf16_f32 v63, v54, v55
  v_add_u32 v105, v106, v105
  s_waitcnt lgkmcnt(3)
  s_cmp_lt_u32 s22, 4
  s_cbranch_scc1 fused_kernel_g_70
  v_cmp_gt_u32 vcc, 6, v113
  s_cmp_eq_u64 vcc, 0
  s_cbranch_scc1 fused_kernel_ck_71_ok
  s_mov_b32 s60, 0
fused_kernel_ck_71:
  ds_read_b32 v113, v110 offset:0
  s_waitcnt lgkmcnt(0)
  v_cmp_gt_u32 vcc, 6, v113
  s_cmp_eq_u64 vcc, 0
  s_cbranch_scc1 fused_kernel_ck_71_ok
  s_add_u32 s60, s60, 1
  s_cmp_lt_u32 s60, 640000
  s_cbranch_scc1 fused_kernel_ck_71
fused_kernel_ck_71_ok:
fused_kernel_g_70:
  v_exp_f32 v24, v24
  v_exp_f32 v25, v25
  v_mfma_f32_32x32x16_bf16 v[64:79], v[96:99], v[56:59], v[64:79]
  v_exp_f32 v26, v26
  v_exp_f32 v27, v27
  v_cvt_pk_bf16_f32 v56, v24, v25
  v_exp_f32 v28, v28
  v_exp_f32 v29, v29
  v_cvt_pk_bf16_f32 v57, v26, v27
  v_mfma_f32_32x32x16_bf16 v[64:79], v[100:103], v[60:63], v[64:79]
  ds_read_b128 v[96:99], v105 offset:1024
  ds_read_b128 v[100:103], v105 offset:1536
  v_exp_f32 v30, v30
  v_exp_f32 v31, v31
  v_cvt_pk_bf16_f32 v58, v28, v29
  v_exp_f32 v32, v32
  v_exp_f32 v33, v33
  v_cvt_pk_bf16_f32 v59, v30, v31
  v_mfma_f32_32x32x16_bf16 v[40:55], v[84:87], v[4:7], v[8:23]
  ds_read_b128 v[84:87], v3 offset:54272
  v_exp_f32 v34, v34
  v_exp_f32 v35, v35
  v_cvt_pk_bf16_f32 v60, v32, v33
  v_exp_f32 v36, v36
  v_exp_f32 v37, v37
  v_cvt_pk_bf16_f32 v61, v34, v35
  s_cmp_lt_u32 s22, 4
  s_cbranch_scc1 fused_kernel_g_72
  s_add_u32 m0, s38, 40960
  s_add_u32 s33, s36, 73728
  buffer_load_dwordx4 v3, s[8:11], s33 offen offset:0 lds
  buffer_load_dwordx4 v3, s[8:11], s33 offen offset:1024 lds
fused_kernel_g_72:
  v_exp_f32 v38, v38
  v_exp_f32 v39, v39
  v_cvt_pk_bf16_f32 v62, v36, v37
  v_cvt_pk_bf16_f32 v63, v38, v39
  s_waitcnt lgkmcnt(3)
  s_cmp_ge_u32 s22, 4
  s_cbranch_scc1 fused_kernel_g_73
  s_waitcnt vmcnt(50)
  v_mov_b32 v112, 7
  s_mov_b64 exec, 1
  ds_write_b32 v109, v112 offset:64
  s_mov_b64 exec, -1
fused_kernel_g_73:
  v_exp_f32 v40, v40
  v_exp_f32 v41, v41
  v_mfma_f32_32x32x16_bf16 v[64:79], v[88:91], v[56:59], v[64:79]
  v_exp_f32 v42, v42
  v_exp_f32 v43, v43
  v_cvt_pk_bf16_f32 v56, v40, v41
  v_exp_f32 v44, v44
  v_exp_f32 v45, v45
  v_cvt_pk_bf16_f32 v57, v42, v43
  v_mfma_f32_32x32x16_bf16 v[64:79], v[92:95], v[60:63], v[64:79]
  ds_read_b128 v[88:91], v105 offset:2048
  ds_read_b128 v[92:95], v105 offset:2560
  v_exp_f32 v46, v46
  v_exp_f32 v47, v47
  v_cvt_pk_bf16_f32 v58, v44, v45
  v_exp_f32 v48, v48
  v_exp_f32 v49, v49
  v_cvt_pk_bf16_f32 v59, v46, v47
  v_mfma_f32_32x32x16_bf16 v[24:39], v[80:83], v[4:7], v[8:23]
  ds_read_b128 v[80:83], v3 offset:55296
  v_exp_f32 v50, v50
  v_exp_f32 v51, v51
  v_cvt_pk_bf16_f32 v60, v48, v49
  v_exp_f32 v52, v52
  v_exp_f32 v53, v53
  v_cvt_pk_bf16_f32 v61, v50, v51
  s_cmp_lt_u32 s22, 4
  s_cbranch_scc1 fused_kernel_g_74
  s_add_u32 m0, s38, 106496
  s_add_u32 s33, s36, 90112
  buffer_load_dwordx4 v3, s[8:11], s33 offen offset:0 lds
  buffer_load_dwordx4 v3, s[8:11], s33 offen offset:1024 lds
fused_kernel_g_74:
  v_exp_f32 v54, v54
  v_exp_f32 v55, v55
  v_cvt_pk_bf16_f32 v62, v52, v53
  v_cvt_pk_bf16_f32 v63, v54, v55
  v_add_u32 v105, v106, v105
  s_waitcnt lgkmcnt(3)
  v_exp_f32 v24, v24
  v_exp_f32 v25, v25
  v_mfma_f32_32x32x16_bf16 v[64:79], v[96:99], v[56:59], v[64:79]
  v_exp_f32 v26, v26
  v_exp_f32 v27, v27
  v_cvt_pk_bf16_f32 v56, v24, v25
  ds_read_b32 v113, v111 offset:64
  v_exp_f32 v28, v28
  v_exp_f32 v29, v29
  v_cvt_pk_bf16_f32 v57, v26, v27
  v_mfma_f32_32x32x16_bf16 v[64:79], v[100:103], v[60:63], v[64:79]
  ds_read_b128 v[96:99], v105 offset:1024
  ds_read_b128 v[100:103], v105 offset:1536
  v_exp_f32 v30, v30
  v_exp_f32 v31, v31
  v_cvt_pk_bf16_f32 v58, v28, v29
  v_exp_f32 v32, v32
  v_exp_f32 v33, v33
  v_cvt_pk_bf16_f32 v59, v30, v31
  v_mfma_f32_32x32x16_bf16 v[40:55], v[84:87], v[4:7], v[8:23]
  ds_read_b128 v[84:87], v3 offset:56320
  v_exp_f32 v34, v34
  v_exp_f32 v35, v35
  v_cvt_pk_bf16_f32 v60, v32, v33
  v_exp_f32 v36, v36
  v_exp_f32 v37, v37
  v_cvt_pk_bf16_f32 v61, v34, v35
  v_exp_f32 v38, v38
  v_exp_f32 v39, v39
  v_cvt_pk_bf16_f32 v62, v36, v37
  v_cvt_pk_bf16_f32 v63, v38, v39
  s_waitcnt lgkmcnt(3)
  v_cmp_gt_u32 vcc, 7, v113
  s_cmp_eq_u64 vcc, 0
  s_cbranch_scc1 fused_kernel_ck_75_ok
  s_mov_b32 s60, 0
fused_kernel_ck_75:
  ds_read_b32 v113, v111 offset:64
  s_waitcnt lgkmcnt(0)
  v_cmp_gt_u32 vcc, 7, v113
  s_cmp_eq_u64 vcc, 0
  s_cbranch_scc1 fused_kernel_ck_75_ok
  s_add_u32 s60, s60, 1
  s_cmp_lt_u32 s60, 640000
  s_cbranch_scc1 fused_kernel_ck_75
fused_kernel_ck_75_ok:
  v_exp_f32 v40, v40
  v_exp_f32 v41, v41
  v_mfma_f32_32x32x16_bf16 v[64:79], v[88:91], v[56:59], v[64:79]
  v_exp_f32 v42, v42
  v_exp_f32 v43, v43
  v_cvt_pk_bf16_f32 v56, v40, v41
  v_exp_f32 v44, v44
  v_exp_f32 v45, v45
  v_cvt_pk_bf16_f32 v57, v42, v43
  v_mfma_f32_32x32x16_bf16 v[64:79], v[92:95], v[60:63], v[64:79]
  ds_read_b128 v[88:91], v105 offset:2048
  ds_read_b128 v[92:95], v105 offset:2560
  v_exp_f32 v46, v46
  v_exp_f32 v47, v47
  v_cvt_pk_bf16_f32 v58, v44, v45
  v_exp_f32 v48, v48
  v_exp_f32 v49, v49
  v_cvt_pk_bf16_f32 v59, v46, v47
  v_mfma_f32_32x32x16_bf16 v[24:39], v[80:83], v[4:7], v[8:23]
  ds_read_b128 v[80:83], v3 offset:57344
  v_exp_f32 v50, v50
  v_exp_f32 v51, v51
  v_cvt_pk_bf16_f32 v60, v48, v49
  v_exp_f32 v52, v52
  v_exp_f32 v53, v53
  v_cvt_pk_bf16_f32 v61, v50, v51
  v_exp_f32 v54, v54
  v_exp_f32 v55, v55
  v_cvt_pk_bf16_f32 v62, v52, v53
  v_cvt_pk_bf16_f32 v63, v54, v55
  v_add_u32 v105, v106, v105
  s_waitcnt lgkmcnt(3)
  v_exp_f32 v24, v24
  v_exp_f32 v25, v25
  v_mfma_f32_32x32x16_bf16 v[64:79], v[96:99], v[56:59], v[64:79]
  v_exp_f32 v26, v26
  v_exp_f32 v27, v27
  v_cvt_pk_bf16_f32 v56, v24, v25
  v_exp_f32 v28, v28
  v_exp_f32 v29, v29
  v_cvt_pk_bf16_f32 v57, v26, v27
  v_mfma_f32_32x32x16_bf16 v[64:79], v[100:103], v[60:63], v[64:79]
  ds_read_b128 v[96:99], v105 offset:1024
  ds_read_b128 v[100:103], v105 offset:1536
  v_exp_f32 v30, v30
  v_exp_f32 v31, v31
  v_cvt_pk_bf16_f32 v58, v28, v29
  v_exp_f32 v32, v32
  v_exp_f32 v33, v33
  v_cvt_pk_bf16_f32 v59, v30, v31
  v_mfma_f32_32x32x16_bf16 v[40:55], v[84:87], v[4:7], v[8:23]
  ds_read_b128 v[84:87], v3 offset:58368
  v_exp_f32 v34, v34
  v_exp_f32 v35, v35
  v_cvt_pk_bf16_f32 v60, v32, v33
  v_exp_f32 v36, v36
  v_exp_f32 v37, v37
  v_cvt_pk_bf16_f32 v61, v34, v35
  s_mul_i32 s33, s27, 88064
  s_lshl_b32 s34, s47, 10
  s_add_u32 s33, s33, s34
  s_add_u32 s33, s33, 13631488
  buffer_load_dwordx4 v[236:239], v3, s[8:11], s33 offen offset:0 sc1
  v_exp_f32 v38, v38
  v_exp_f32 v39, v39
  v_cvt_pk_bf16_f32 v62, v36, v37
  v_cvt_pk_bf16_f32 v63, v38, v39
  s_waitcnt lgkmcnt(3)
  s_cmp_lt_u32 s22, 4
  s_cbranch_scc1 fused_kernel_g_76
  s_waitcnt vmcnt(1)
  v_mov_b32 v112, 9
  s_mov_b64 exec, 1
  ds_write_b32 v109, v112 offset:64
  s_mov_b64 exec, -1
fused_kernel_g_76:
  v_exp_f32 v40, v40
  v_exp_f32 v41, v41
  v_mfma_f32_32x32x16_bf16 v[64:79], v[88:91], v[56:59], v[64:79]
  v_exp_f32 v42, v42
  v_exp_f32 v43, v43
  v_cvt_pk_bf16_f32 v56, v40, v41
  v_exp_f32 v44, v44
  v_exp_f32 v45, v45
  v_cvt_pk_bf16_f32 v57, v42, v43
  v_mfma_f32_32x32x16_bf16 v[64:79], v[92:95], v[60:63], v[64:79]
  ds_read_b128 v[88:91], v105 offset:2048
  ds_read_b128 v[92:95], v105 offset:2560
  v_exp_f32 v46, v46
  v_exp_f32 v47, v47
  v_cvt_pk_bf16_f32 v58, v44, v45
  v_exp_f32 v48, v48
  v_exp_f32 v49, v49
  v_cvt_pk_bf16_f32 v59, v46, v47
  v_mfma_f32_32x32x16_bf16 v[24:39], v[80:83], v[4:7], v[8:23]
  ds_read_b128 v[80:83], v3 offset:59392
  v_exp_f32 v50, v50
  v_exp_f32 v51, v51
  v_cvt_pk_bf16_f32 v60, v48, v49
  v_exp_f32 v52, v52
  v_exp_f32 v53, v53
  v_cvt_pk_bf16_f32 v61, v50, v51
  s_mul_i32 s33, s27, 88064
  s_lshl_b32 s34, s47, 10
  s_add_u32 s33, s33, s34
  s_add_u32 s33, s33, 13631488
  buffer_load_dwordx4 v[236:239], v3, s[8:11], s33 offen offset:1024 sc1
  v_exp_f32 v54, v54
  v_exp_f32 v55, v55
  v_cvt_pk_bf16_f32 v62, v52, v53
  v_cvt_pk_bf16_f32 v63, v54, v55
  v_add_u32 v105, v106, v105
  s_waitcnt lgkmcnt(3)
  v_exp_f32 v24, v24
  v_exp_f32 v25, v25
  v_mfma_f32_32x32x16_bf16 v[64:79], v[96:99], v[56:59], v[64:79]
  v_exp_f32 v26, v26
  v_exp_f32 v27, v27
  v_cvt_pk_bf16_f32 v56, v24, v25
  v_exp_f32 v28, v28
  v_exp_f32 v29, v29
  v_cvt_pk_bf16_f32 v57, v26, v27
  v_mfma_f32_32x32x16_bf16 v[64:79], v[100:103], v[60:63], v[64:79]
  ds_read_b128 v[96:99], v105 offset:1024
  ds_read_b128 v[100:103], v105 offset:1536
  v_exp_f32 v30, v30
  v_exp_f32 v31, v31
  v_cvt_pk_bf16_f32 v58, v28, v29
  v_exp_f32 v32, v32
  v_exp_f32 v33, v33
  v_cvt_pk_bf16_f32 v59, v30, v31
  v_mfma_f32_32x32x16_bf16 v[40:55], v[84:87], v[4:7], v[8:23]
  ds_read_b128 v[84:87], v3 offset:60416
  v_exp_f32 v34, v34
  v_exp_f32 v35, v35
  v_cvt_pk_bf16_f32 v60, v32, v33
  v_exp_f32 v36, v36
  v_exp_f32 v37, v37
  v_cvt_pk_bf16_f32 v61, v34, v35
  s_mul_i32 s33, s27, 88064
  s_lshl_b32 s34, s47, 10
  s_add_u32 s33, s33, s34
  s_add_u32 s33, s33, 13631488
  buffer_load_dwordx4 v[236:239], v3, s[8:11], s33 offen offset:2048 sc1
  v_exp_f32 v38, v38
  v_exp_f32 v39, v39
  v_cvt_pk_bf16_f32 v62, v36, v37
  v_cvt_pk_bf16_f32 v63, v38, v39
  s_waitcnt lgkmcnt(3)
  v_exp_f32 v40, v40
  v_exp_f32 v41, v41
  v_mfma_f32_32x32x16_bf16 v[64:79], v[88:91], v[56:59], v[64:79]
  v_exp_f32 v42, v42
  v_exp_f32 v43, v43
  v_cvt_pk_bf16_f32 v56, v40, v41
  v_exp_f32 v44, v44
  v_exp_f32 v45, v45
  v_cvt_pk_bf16_f32 v57, v42, v43
  v_mfma_f32_32x32x16_bf16 v[64:79], v[92:95], v[60:63], v[64:79]
  ds_read_b128 v[88:91], v105 offset:2048
  ds_read_b128 v[92:95], v105 offset:2560
  v_exp_f32 v46, v46
  v_exp_f32 v47, v47
  v_cvt_pk_bf16_f32 v58, v44, v45
  v_exp_f32 v48, v48
  v_exp_f32 v49, v49
  v_cvt_pk_bf16_f32 v59, v46, v47
  v_mfma_f32_32x32x16_bf16 v[24:39], v[80:83], v[4:7], v[8:23]
  ds_read_b128 v[80:83], v3 offset:61440
  v_exp_f32 v50, v50
  v_exp_f32 v51, v51
  v_cvt_pk_bf16_f32 v60, v48, v49
  v_exp_f32 v52, v52
  v_exp_f32 v53, v53
  v_cvt_pk_bf16_f32 v61, v50, v51
  v_exp_f32 v54, v54
  v_exp_f32 v55, v55
  v_cvt_pk_bf16_f32 v62, v52, v53
  v_cvt_pk_bf16_f32 v63, v54, v55
  v_add_u32 v105, v106, v105
  s_waitcnt lgkmcnt(3)
  v_exp_f32 v24, v24
  v_exp_f32 v25, v25
  v_mfma_f32_32x32x16_bf16 v[64:79], v[96:99], v[56:59], v[64:79]
  v_exp_f32 v26, v26
  v_exp_f32 v27, v27
  v_cvt_pk_bf16_f32 v56, v24, v25
  v_exp_f32 v28, v28
  v_exp_f32 v29, v29
  v_cvt_pk_bf16_f32 v57, v26, v27
  v_mfma_f32_32x32x16_bf16 v[64:79], v[100:103], v[60:63], v[64:79]
  ds_read_b128 v[96:99], v105 offset:1024
  ds_read_b128 v[100:103], v105 offset:1536
  v_exp_f32 v30, v30
  v_exp_f32 v31, v31
  v_cvt_pk_bf16_f32 v58, v28, v29
  v_exp_f32 v32, v32
  v_exp_f32 v33, v33
  v_cvt_pk_bf16_f32 v59, v30, v31
  v_mfma_f32_32x32x16_bf16 v[40:55], v[84:87], v[4:7], v[8:23]
  ds_read_b128 v[84:87], v3 offset:62464
  v_exp_f32 v34, v34
  v_exp_f32 v35, v35
  v_cvt_pk_bf16_f32 v60, v32, v33
  v_exp_f32 v36, v36
  v_exp_f32 v37, v37
  v_cvt_pk_bf16_f32 v61, v34, v35
  v_exp_f32 v38, v38
  v_exp_f32 v39, v39
  v_cvt_pk_bf16_f32 v62, v36, v37
  v_cvt_pk_bf16_f32 v63, v38, v39
  s_waitcnt lgkmcnt(3)
  v_exp_f32 v40, v40
  v_exp_f32 v41, v41
  v_mfma_f32_32x32x16_bf16 v[64:79], v[88:91], v[56:59], v[64:79]
  v_exp_f32 v42, v42
  v_exp_f32 v43, v43
  v_cvt_pk_bf16_f32 v56, v40, v41
  v_exp_f32 v44, v44
  v_exp_f32 v45, v45
  v_cvt_pk_bf16_f32 v57, v42, v43
  v_mfma_f32_32x32x16_bf16 v[64:79], v[92:95], v[60:63], v[64:79]
  ds_read_b128 v[88:91], v105 offset:2048
  ds_read_b128 v[92:95], v105 offset:2560
  v_exp_f32 v46, v46
  v_exp_f32 v47, v47
  v_cvt_pk_bf16_f32 v58, v44, v45
  v_exp_f32 v48, v48
  v_exp_f32 v49, v49
  v_cvt_pk_bf16_f32 v59, v46, v47
  v_mfma_f32_32x32x16_bf16 v[24:39], v[80:83], v[4:7], v[8:23]
  ds_read_b128 v[80:83], v3 offset:63488
  v_exp_f32 v50, v50
  v_exp_f32 v51, v51
  v_cvt_pk_bf16_f32 v60, v48, v49
  v_exp_f32 v52, v52
  v_exp_f32 v53, v53
  v_cvt_pk_bf16_f32 v61, v50, v51
  v_exp_f32 v54, v54
  v_exp_f32 v55, v55
  v_cvt_pk_bf16_f32 v62, v52, v53
  v_cvt_pk_bf16_f32 v63, v54, v55
  v_add_u32 v105, v106, v105
  s_waitcnt lgkmcnt(3)
  v_exp_f32 v24, v24
  v_exp_f32 v25, v25
  v_mfma_f32_32x32x16_bf16 v[64:79], v[96:99], v[56:59], v[64:79]
  v_exp_f32 v26, v26
  v_exp_f32 v27, v27
  v_cvt_pk_bf16_f32 v56, v24, v25
  v_exp_f32 v28, v28
  v_exp_f32 v29, v29
  v_cvt_pk_bf16_f32 v57, v26, v27
  v_mfma_f32_32x32x16_bf16 v[64:79], v[100:103], v[60:63], v[64:79]
  ds_read_b128 v[96:99], v105 offset:1024
  ds_read_b128 v[100:103], v105 offset:1536
  v_exp_f32 v30, v30
  v_exp_f32 v31, v31
  v_cvt_pk_bf16_f32 v58, v28, v29
  v_exp_f32 v32, v32
  v_exp_f32 v33, v33
  v_cvt_pk_bf16_f32 v59, v30, v31
  v_mfma_f32_32x32x16_bf16 v[40:55], v[84:87], v[4:7], v[8:23]
  ds_read_b128 v[84:87], v3 offset:64512
  v_exp_f32 v34, v34
  v_exp_f32 v35, v35
  v_cvt_pk_bf16_f32 v60, v32, v33
  v_exp_f32 v36, v36
  v_exp_f32 v37, v37
  v_cvt_pk_bf16_f32 v61, v34, v35
  v_exp_f32 v38, v38
  v_exp_f32 v39, v39
  v_cvt_pk_bf16_f32 v62, v36, v37
  v_cvt_pk_bf16_f32 v63, v38, v39
  s_waitcnt lgkmcnt(3)
  v_exp_f32 v40, v40
  v_exp_f32 v41, v41
  v_mfma_f32_32x32x16_bf16 v[64:79], v[88:91], v[56:59], v[64:79]
  v_exp_f32 v42, v42
  v_exp_f32 v43, v43
  v_cvt_pk_bf16_f32 v56, v40, v41
  v_exp_f32 v44, v44
  v_exp_f32 v45, v45
  v_cvt_pk_bf16_f32 v57, v42, v43
  v_mfma_f32_32x32x16_bf16 v[64:79], v[92:95], v[60:63], v[64:79]
  ds_read_b128 v[88:91], v105 offset:2048
  ds_read_b128 v[92:95], v105 offset:2560
  v_exp_f32 v46, v46
  v_exp_f32 v47, v47
  v_cvt_pk_bf16_f32 v58, v44, v45
  v_exp_f32 v48, v48
  v_exp_f32 v49, v49
  v_cvt_pk_bf16_f32 v59, v46, v47
  v_mfma_f32_32x32x16_bf16 v[24:39], v[80:83], v[4:7], v[8:23]
  v_exp_f32 v50, v50
  v_exp_f32 v51, v51
  v_cvt_pk_bf16_f32 v60, v48, v49
  v_exp_f32 v52, v52
  v_exp_f32 v53, v53
  v_cvt_pk_bf16_f32 v61, v50, v51
  v_exp_f32 v54, v54
  v_exp_f32 v55, v55
  v_cvt_pk_bf16_f32 v62, v52, v53
  v_cvt_pk_bf16_f32 v63, v54, v55
  v_add_u32 v105, v106, v105
  s_waitcnt lgkmcnt(2)
  v_exp_f32 v24, v24
  v_exp_f32 v25, v25
  v_mfma_f32_32x32x16_bf16 v[64:79], v[96:99], v[56:59], v[64:79]
  v_exp_f32 v26, v26
  v_exp_f32 v27, v27
  v_cvt_pk_bf16_f32 v56, v24, v25
  v_exp_f32 v28, v28
  v_exp_f32 v29, v29
  v_cvt_pk_bf16_f32 v57, v26, v27
  v_mfma_f32_32x32x16_bf16 v[64:79], v[100:103], v[60:63], v[64:79]
  ds_read_b128 v[96:99], v105 offset:1024
  ds_read_b128 v[100:103], v105 offset:1536
  v_exp_f32 v30, v30
  v_exp_f32 v31, v31
  v_cvt_pk_bf16_f32 v58, v28, v29
  v_exp_f32 v32, v32
  v_exp_f32 v33, v33
  v_cvt_pk_bf16_f32 v59, v30, v31
  v_mfma_f32_32x32x16_bf16 v[40:55], v[84:87], v[4:7], v[8:23]
  v_exp_f32 v34, v34
  v_exp_f32 v35, v35
  v_cvt_pk_bf16_f32 v60, v32, v33
  v_exp_f32 v36, v36
  v_exp_f32 v37, v37
  v_cvt_pk_bf16_f32 v61, v34, v35
  v_exp_f32 v38, v38
  v_exp_f32 v39, v39
  v_cvt_pk_bf16_f32 v62, v36, v37
  v_cvt_pk_bf16_f32 v63, v38, v39
  s_waitcnt lgkmcnt(2)
  v_exp_f32 v40, v40
  v_exp_f32 v41, v41
  v_mfma_f32_32x32x16_bf16 v[64:79], v[88:91], v[56:59], v[64:79]
  v_exp_f32 v42, v42
  v_exp_f32 v43, v43
  v_cvt_pk_bf16_f32 v56, v40, v41
  v_exp_f32 v44, v44
  v_exp_f32 v45, v45
  v_cvt_pk_bf16_f32 v57, v42, v43
  v_mfma_f32_32x32x16_bf16 v[64:79], v[92:95], v[60:63], v[64:79]
  v_exp_f32 v46, v46
  v_exp_f32 v47, v47
  v_cvt_pk_bf16_f32 v58, v44, v45
  v_exp_f32 v48, v48
  v_exp_f32 v49, v49
  v_cvt_pk_bf16_f32 v59, v46, v47
  v_exp_f32 v50, v50
  v_exp_f32 v51, v51
  v_cvt_pk_bf16_f32 v60, v48, v49
  v_exp_f32 v52, v52
  v_exp_f32 v53, v53
  v_cvt_pk_bf16_f32 v61, v50, v51
  v_exp_f32 v54, v54
  v_exp_f32 v55, v55
  v_cvt_pk_bf16_f32 v62, v52, v53
  v_cvt_pk_bf16_f32 v63, v54, v55
  v_add_u32 v105, v106, v105
  s_waitcnt lgkmcnt(0)
  s_nop 1
  v_mfma_f32_32x32x16_bf16 v[64:79], v[96:99], v[56:59], v[64:79]
  v_mfma_f32_32x32x16_bf16 v[64:79], v[100:103], v[60:63], v[64:79]
attn_lend:
  s_waitcnt lgkmcnt(0)
  s_nop 11
  v_mov_b32 v108, 0x5d800000
  v_cmp_nle_f32 vcc, v72, v108
  s_cmp_eq_u64 vcc, 0
  s_cbranch_scc0 attn_slow
attn_fin:
  v_rcp_f32 v108, v72
  s_lshl_b32 s29, s27, 15
  s_lshl_b32 s33, s21, 10
  s_add_u32 s29, s29, s33
  s_add_u32 s29, s29, 9437184
  v_mul_f32 v64, v64, v108
  v_mul_f32 v65, v65, v108
  v_mul_f32 v66, v66, v108
  v_mul_f32 v67, v67, v108
  v_mul_f32 v68, v68, v108
  v_mul_f32 v69, v69, v108
  v_mul_f32 v70, v70, v108
  v_mul_f32 v71, v71, v108
  v_cvt_pk_bf16_f32 v56, v64, v65
  v_cvt_pk_bf16_f32 v57, v66, v67
  v_cvt_pk_bf16_f32 v58, v68, v69
  v_cvt_pk_bf16_f32 v59, v70, v71
  buffer_store_dwordx4 v[56:59], v3, s[8:11], s29 offen
  s_setprio 2
  s_cmp_ge_u32 s22, 4
  s_cbranch_scc1 fused_kernel_pr_77
  s_setprio 3
fused_kernel_pr_77:
  v_mov_b32 v112, 7
  s_lshl_b32 s61, s22, 2
  s_add_u32 s61, s61, 163584
  v_mov_b32 v16, s61
  s_lshl_b32 s61, s43, 4
  s_add_u32 s62, s61, 163584
  v_and_b32 v17, 3, v1
  v_lshl_add_u32 v17, v17, 2, s62
  s_add_u32 s61, s61, 12
  v_lshlrev_b32 v18, 2, v1
  v_and_b32 v18, s61, v18
  v_add_u32 v18, 163584, v18
  s_mov_b64 exec, 1
  ds_write_b32 v16, v112 offset:0
  s_mov_b64 exec, -1
  v_mov_b32 v112, 1
  v_and_b32 v113, 7, v1
  v_lshlrev_b32 v113, 2, v113
  s_lshl_b32 s54, s22, 7
  s_lshl_b32 s55, s21, 2
  s_add_u32 s54, s54, s55
  s_add_u32 s54, s54, s23
  s_add_u32 s55, s54, 1024
  s_lshl_b32 s56, s45, 7
  s_add_u32 s56, s56, s23
  s_lshl_b32 s57, s42, 5
  s_add_u32 s57, s57, s56
  s_add_u32 s57, s57, 1024
  s_mov_b32 s61, 133888
  s_mov_b32 s62, 150272
  s_cmp_eq_u32 s43, 1
  s_cselect_b32 s61, 49152, s61
  s_cselect_b32 s62, 114688, s62
  s_xor_b32 s63, s42, 1
  s_lshl_b32 s63, s63, 11
  s_add_u32 s63, s63, s61
  v_add_u32 v5, s63, v3
  s_xor_b32 s63, s42, 2
  s_lshl_b32 s63, s63, 11
  s_add_u32 s63, s63, s61
  v_add_u32 v6, s63, v3
  s_xor_b32 s63, s42, 3
  s_lshl_b32 s63, s63, 11
  s_add_u32 s63, s63, s62
  v_add_u32 v7, s63, v3
  s_lshl_b32 s63, s42, 11
  s_add_u32 s61, s61, s63
  s_add_u32 s62, s62, s63
  v_add_u32 v8, s61, v3
  v_add_u32 v9, s62, v3
  v_and_b32 v10, 31, v1
  v_lshlrev_b32 v11, 2, v10
  v_lshlrev_b32 v10, 3, v10
  s_waitcnt vmcnt(0)
  s_mov_b64 exec, 1
  buffer_store_dword v112, v115, s[8:11], s55 offen
  s_mov_b64 exec, -1
  buffer_load_dword v4, v113, s[8:11], s57 offen sc1
  s_lshl_b32 s61, s44, 15
  s_lshl_b32 s62, s42, 13
  s_add_u32 s61, s61, s62
  s_add_u32 s61, s61, 9437184
  s_add_u32 s62, s61, 4096
  v_lshlrev_b32 v80, 16, v184
  v_and_b32 v81, 0xffff0000, v184
  v_lshlrev_b32 v82, 16, v185
  v_and_b32 v83, 0xffff0000, v185
  v_lshlrev_b32 v84, 16, v186
  v_and_b32 v85, 0xffff0000, v186
  v_lshlrev_b32 v86, 16, v187
  v_and_b32 v87, 0xffff0000, v187
  v_lshrrev_b32 v19, 4, v1
  v_cmp_eq_u32 vcc, 2, v19
  v_mov_b32 v19, -1.4426950408889634
  v_add_u32 v20, 158464, v118
  v_add_f32 v204, v204, v208
  v_add_f32 v205, v205, v209
  v_add_f32 v206, v206, v210
  v_add_f32 v207, v207, v211
  v_add_f32 v212, v212, v216
  v_add_f32 v213, v213, v217
  v_add_f32 v214, v214, v218
  v_add_f32 v215, v215, v219
  v_add_f32 v220, v220, v224
  v_add_f32 v221, v221, v225
  v_add_f32 v222, v222, v226
  v_add_f32 v223, v223, v227
  v_add_f32 v204, v204, v206
  v_add_f32 v205, v205, v207
  v_add_f32 v212, v212, v214
  v_add_f32 v213, v213, v215
  v_add_f32 v220, v220, v222
  v_add_f32 v221, v221, v223
  v_add_f32 v204, v204, v205
  v_add_f32 v212, v212, v213
  v_add_f32 v220, v220, v221
  v_cndmask_b32 v19, 1.0, v19, vcc
  v_mul_f32 v204, v19, v204
  v_mul_f32 v212, v19, v212
  v_mul_f32 v220, v19, v220
  ds_write_b32 v20, v204 offset:0
  ds_write_b32 v20, v212 offset:256
  ds_write_b32 v20, v220 offset:512
  s_mov_b32 s60, 0
  s_branch f_p1_chk
f_p1:
  buffer_load_dword v4, v113, s[8:11], s57 offen sc1
f_p1_chk:
  s_waitcnt vmcnt(0)
  v_cmp_ne_u32 vcc, 1, v4
  s_cmp_eq_u64 vcc, 0
  s_cbranch_scc1 f_p1_ok
  s_add_u32 s60, s60, 1
  s_cmp_lt_u32 s60, 40000
  s_cbranch_scc1 f_p1
f_p1_ok:
  buffer_load_dwordx4 v[204:207], v3, s[8:11], s61 offen offset:0 sc1
  buffer_load_dwordx4 v[208:211], v3, s[8:11], s61 offen offset:1024 sc1
  buffer_load_dwordx4 v[212:215], v3, s[8:11], s61 offen offset:2048 sc1
  buffer_load_dwordx4 v[216:219], v3, s[8:11], s61 offen offset:3072 sc1
  buffer_load_dwordx4 v[220:223], v3, s[8:11], s62 offen offset:0 sc1
  buffer_load_dwordx4 v[224:227], v3, s[8:11], s62 offen offset:1024 sc1
  buffer_load_dwordx4 v[228:231], v3, s[8:11], s62 offen offset:2048 sc1
  buffer_load_dwordx4 v[232:235], v3, s[8:11], s62 offen offset:3072 sc1
  s_mov_b32 s60, 0
f_wa:
  ds_read_b32 v4, v18 offset:0
  s_waitcnt lgkmcnt(0)
  v_cmp_gt_u32 vcc, 7, v4
  s_cmp_eq_u64 vcc, 0
  s_cbranch_scc1 f_wa_ok
  s_add_u32 s60, s60, 1
  s_cmp_lt_u32 s60, 640000
  s_cbranch_scc1 f_wa
f_wa_ok:
  s_lshl_b32 s61, s44, 15
  s_lshl_b32 s62, s46, 10
  s_add_u32 s61, s61, s62
  s_add_u32 s61, s61, 11534336
  s_lshl_b32 s62, s44, 13
  s_lshl_b32 s63, s46, 8
  s_add_u32 s62, s62, s63
  s_add_u32 s62, s62, 29622272
  s_lshl_b32 s63, s46, 2
  s_add_u32 s63, s63, s56
  s_add_u32 s63, s63, 2048
  s_waitcnt vmcnt(7)
  v_mfma_f32_32x32x16_bf16 v[24:39], v[120:123], v[204:207], 0
  v_mfma_f32_32x32x16_bf16 v[40:55], v[152:155], v[204:207], 0
  s_waitcnt vmcnt(6)
  v_mfma_f32_32x32x16_bf16 v[24:39], v[124:127], v[208:211], v[24:39]
  v_mfma_f32_32x32x16_bf16 v[40:55], v[156:159], v[208:211], v[40:55]
  s_waitcnt vmcnt(5)
  v_mfma_f32_32x32x16_bf16 v[24:39], v[128:131], v[212:215], v[24:39]
  v_mfma_f32_32x32x16_bf16 v[40:55], v[160:163], v[212:215], v[40:55]
  s_waitcnt vmcnt(4)
  v_mfma_f32_32x32x16_bf16 v[24:39], v[132:135], v[216:219], v[24:39]
  v_mfma_f32_32x32x16_bf16 v[40:55], v[164:167], v[216:219], v[40:55]
  s_waitcnt vmcnt(3)
  v_mfma_f32_32x32x16_bf16 v[24:39], v[136:139], v[220:223], v[24:39]
  v_mfma_f32_32x32x16_bf16 v[40:55], v[168:171], v[220:223], v[40:55]
  s_waitcnt vmcnt(2)
  v_mfma_f32_32x32x16_bf16 v[24:39], v[140:143], v[224:227], v[24:39]
  v_mfma_f32_32x32x16_bf16 v[40:55], v[172:175], v[224:227], v[40:55]
  s_waitcnt vmcnt(1)
  v_mfma_f32_32x32x16_bf16 v[24:39], v[144:147], v[228:231], v[24:39]
  v_mfma_f32_32x32x16_bf16 v[40:55], v[176:179], v[228:231], v[40:55]
  s_waitcnt vmcnt(0)
  v_mfma_f32_32x32x16_bf16 v[24:39], v[148:151], v[232:235], v[24:39]
  v_mfma_f32_32x32x16_bf16 v[40:55], v[180:183], v[232:235], v[40:55]
  s_lshl_b32 s57, s22, 7
  s_add_u32 s57, s57, s23
  s_add_u32 s57, s57, 2048
  s_lshl_b32 s33, s27, 15
  s_add_u32 s33, s33, 11534336
  s_lshl_b32 s34, s27, 13
  s_add_u32 s34, s34, 29622272
  s_mul_i32 s35, s27, 88064
  s_lshl_b32 s36, s47, 10
  s_add_u32 s35, s35, s36
  s_add_u32 s35, s35, 13631488
  s_mul_i32 s36, s42, 22
  s_cmp_eq_u32 s42, 3
  s_cselect_b32 s36, 65, s36
  s_lshl_b32 s36, s36, 10
  ds_write_b128 v5, v[32:35] offset:0
  ds_write_b128 v5, v[36:39] offset:1024
  ds_write_b128 v6, v[40:43] offset:8192
  ds_write_b128 v6, v[44:47] offset:9216
  ds_write_b128 v7, v[48:51] offset:0
  ds_write_b128 v7, v[52:55] offset:1024
  s_mov_b64 exec, 1
  ds_write_b32 v16, v112 offset:32
  s_mov_b64 exec, -1
  s_lshr_b32 s37, s42, 1
  s_mul_i32 s38, s37, 88064
  s_add_u32 s38, s38, s52
  s_add_u32 s38, s38, s36
  s_xor_b32 s37, s37, 1
  s_mul_i32 s39, s37, 88064
  s_add_u32 s39, s39, s52
  s_add_u32 s39, s39, s36
  s_mul_i32 s28, s44, 88064
  s_add_u32 s28, s28, s36
  s_add_u32 s28, s28, 13631488
  s_mul_i32 s31, s42, 28
  s_add_u32 s31, s31, s56
  s_add_u32 s31, s31, 3072
  s_add_u32 s55, s54, 3072
  s_mov_b32 s60, 0
f_wb:
  ds_read_b32 v4, v17 offset:32
  s_waitcnt lgkmcnt(0)
  v_cmp_gt_u32 vcc, 1, v4
  s_cmp_eq_u64 vcc, 0
  s_cbranch_scc1 f_wb_ok
  s_add_u32 s60, s60, 1
  s_cmp_lt_u32 s60, 640000
  s_cbranch_scc1 f_wb
f_wb_ok:
  ds_read_b128 v[56:59], v8 offset:0
  ds_read_b128 v[60:63], v8 offset:1024
  ds_read_b128 v[64:67], v8 offset:8192
  ds_read_b128 v[68:71], v8 offset:9216
  ds_read_b128 v[72:75], v9 offset:0
  ds_read_b128 v[76:79], v9 offset:1024
  s_waitcnt lgkmcnt(4)
  v_add_f32 v24, v24, v56
  v_add_f32 v25, v25, v57
  v_add_f32 v26, v26, v58
  v_add_f32 v27, v27, v59
  v_add_f32 v28, v28, v60
  v_add_f32 v29, v29, v61
  v_add_f32 v30, v30, v62
  v_add_f32 v31, v31, v63
  s_waitcnt lgkmcnt(2)
  v_add_f32 v24, v24, v64
  v_add_f32 v25, v25, v65
  v_add_f32 v26, v26, v66
  v_add_f32 v27, v27, v67
  v_add_f32 v28, v28, v68
  v_add_f32 v29, v29, v69
  v_add_f32 v30, v30, v70
  v_add_f32 v31, v31, v71
  s_waitcnt lgkmcnt(0)
  v_add_f32 v24, v24, v72
  v_add_f32 v25, v25, v73
  v_add_f32 v26, v26, v74
  v_add_f32 v27, v27, v75
  v_add_f32 v28, v28, v76
  v_add_f32 v29, v29, v77
  v_add_f32 v30, v30, v78
  v_add_f32 v31, v31, v79
  v_mov_b32 v4, 2
  s_mov_b64 exec, 1
  ds_write_b32 v16, v4 offset:32
  s_mov_b64 exec, -1
  v_fma_f32 v24, v24, v188, v80
  v_fma_f32 v25, v25, v189, v81
  v_fma_f32 v26, v26, v190, v82
  v_fma_f32 v27, v27, v191, v83
  v_fma_f32 v28, v28, v192, v84
  v_fma_f32 v29, v29, v193, v85
  v_fma_f32 v30, v30, v194, v86
  v_fma_f32 v31, v31, v195, v87
  v_mul_f32 v80, v24, v196
  v_mul_f32 v81, v25, v197
  v_mul_f32 v82, v26, v198
  v_mul_f32 v83, v27, v199
  v_mul_f32 v84, v28, v200
  v_mul_f32 v85, v29, v201
  v_mul_f32 v86, v30, v202
  v_mul_f32 v87, v31, v203
  v_cvt_pk_bf16_f32 v88, v80, v81
  v_cvt_pk_bf16_f32 v89, v82, v83
  v_cvt_pk_bf16_f32 v90, v84, v85
  v_cvt_pk_bf16_f32 v91, v86, v87
  buffer_store_dwordx4 v[88:91], v3, s[8:11], s61 offen
  v_add_f32 v4, v24, v25
  v_mul_f32 v5, v24, v24
  v_add_f32 v6, v26, v27
  v_mul_f32 v7, v25, v25
  v_add_f32 v4, v4, v28
  v_add_f32 v6, v6, v29
  v_add_f32 v4, v4, v30
  v_add_f32 v6, v6, v31
  v_fmac_f32 v5, v26, v26
  v_fmac_f32 v7, v27, v27
  v_fmac_f32 v5, v28, v28
  v_fmac_f32 v7, v29, v29
  v_fmac_f32 v5, v30, v30
  v_fmac_f32 v7, v31, v31
  v_add_f32 v4, v4, v6
  v_add_f32 v5, v5, v7
  v_mov_b32 v6, v4
  v_mov_b32 v7, v5
  v_cvt_pk_bf16_f32 v12, v24, v25
  v_cvt_pk_bf16_f32 v13, v26, v27
  v_permlane32_swap_b32 v4, v6
  v_permlane32_swap_b32 v5, v7
  v_cvt_pk_bf16_f32 v14, v28, v29
  v_add_f32 v4, v4, v6
  v_add_f32 v5, v5, v7
  v_cvt_pk_bf16_f32 v15, v30, v31
  buffer_store_dwordx2 v[4:5], v10, s[8:11], s62 offen
  v_or_b32 v233, 16, v17
  v_add_u32 v7, 158464, v117
  v_lshlrev_b32 v9, 8, v117
  v_add_u32 v237, v9, v10
  s_waitcnt vmcnt(0)
  s_mov_b64 exec, 1
  buffer_store_dword v112, v115, s[8:11], s63 offen
  s_mov_b64 exec, -1
  s_cmp_ge_u32 s21, 29
  s_cbranch_scc1 f_skip
  buffer_load_dword v9, v11, s[8:11], s57 offen sc1
  s_mov_b32 s60, 0
f_w01:
  ds_read_b32 v8, v233 offset:64
  s_waitcnt lgkmcnt(0)
  v_cmp_gt_u32 vcc, 8, v8
  s_cmp_eq_u64 vcc, 0
  s_cbranch_scc1 f_w01_ok
  s_sleep 1
  s_add_u32 s60, s60, 1
  s_cmp_lt_u32 s60, 640000
  s_cbranch_scc1 f_w01
f_w01_ok:
  v_add_u32 v8, 65536, v3
  ds_read_b128 v[192:195], v3 offset:0
  ds_read_b128 v[196:199], v8 offset:0
  ds_read_b128 v[200:203], v3 offset:1024
  ds_read_b128 v[204:207], v8 offset:1024
  ds_read_b128 v[208:211], v3 offset:2048
  s_mov_b32 s60, 0
  s_branch f_p2_chk
f_p2:
  buffer_load_dword v9, v11, s[8:11], s57 offen sc1
f_p2_chk:
  s_waitcnt vmcnt(0)
  v_cmp_ne_u32 vcc, 1, v9
  s_cmp_eq_u64 vcc, 0
  s_cbranch_scc1 f_p2_ok
  s_add_u32 s60, s60, 1
  s_cmp_lt_u32 s60, 40000
  s_cbranch_scc1 f_p2
f_p2_ok:
  s_cmp_ge_u32 s22, 4
  s_cbranch_scc1 fused_kernel_pr_78
  s_setprio 0
fused_kernel_pr_78:
  buffer_load_dwordx4 v[16:19], v3, s[8:11], s33 offen offset:0 sc1
  buffer_load_dwordx4 v[20:23], v3, s[8:11], s33 offen offset:1024 sc1
  buffer_load_dwordx4 v[24:27], v3, s[8:11], s33 offen offset:2048 sc1
  buffer_load_dwordx4 v[28:31], v3, s[8:11], s33 offen offset:3072 sc1
  s_add_u32 s33, s33, 4096
  buffer_load_dwordx4 v[32:35], v3, s[8:11], s33 offen offset:0 sc1
  buffer_load_dwordx4 v[36:39], v3, s[8:11], s33 offen offset:1024 sc1
  buffer_load_dwordx4 v[40:43], v3, s[8:11], s33 offen offset:2048 sc1
  buffer_load_dwordx4 v[44:47], v3, s[8:11], s33 offen offset:3072 sc1
  ds_read_b128 v[212:215], v8 offset:2048
  s_waitcnt vmcnt(7)
  s_waitcnt lgkmcnt(5)
  v_mfma_f32_32x32x16_bf16 v[144:159], v[192:195], v[16:19], 0
  s_add_u32 s33, s33, 4096
  buffer_load_dwordx4 v[48:51], v3, s[8:11], s33 offen offset:0 sc1
  ds_read_b128 v[192:195], v3 offset:3072
  s_waitcnt lgkmcnt(5)
  v_mfma_f32_32x32x16_bf16 v[160:175], v[196:199], v[16:19], 0
  ds_read_b128 v[196:199], v8 offset:3072
  s_waitcnt vmcnt(7)
  s_waitcnt lgkmcnt(5)
  v_mfma_f32_32x32x16_bf16 v[144:159], v[200:203], v[20:23], v[144:159]
  buffer_load_dwordx4 v[52:55], v3, s[8:11], s33 offen offset:1024 sc1
  ds_read_b128 v[200:203], v3 offset:4096
  s_waitcnt lgkmcnt(5)
  v_mfma_f32_32x32x16_bf16 v[160:175], v[204:207], v[20:23], v[160:175]
  ds_read_b128 v[204:207], v8 offset:4096
  s_waitcnt vmcnt(7)
  s_waitcnt lgkmcnt(5)
  v_mfma_f32_32x32x16_bf16 v[144:159], v[208:211], v[24:27], v[144:159]
  buffer_load_dwordx4 v[56:59], v3, s[8:11], s33 offen offset:2048 sc1
  ds_read_b128 v[208:211], v3 offset:5120
  s_waitcnt lgkmcnt(5)
  v_mfma_f32_32x32x16_bf16 v[160:175], v[212:215], v[24:27], v[160:175]
  ds_read_b128 v[212:215], v8 offset:5120
  s_waitcnt vmcnt(7)
  s_waitcnt lgkmcnt(5)
  v_mfma_f32_32x32x16_bf16 v[144:159], v[192:195], v[28:31], v[144:159]
  buffer_load_dwordx4 v[60:63], v3, s[8:11], s33 offen offset:3072 sc1
  ds_read_b128 v[192:195], v3 offset:6144
  s_waitcnt lgkmcnt(5)
  v_mfma_f32_32x32x16_bf16 v[160:175], v[196:199], v[28:31], v[160:175]
  ds_read_b128 v[196:199], v8 offset:6144
  s_waitcnt vmcnt(7)
  s_waitcnt lgkmcnt(5)
  v_mfma_f32_32x32x16_bf16 v[144:159], v[200:203], v[32:35], v[144:159]
  s_add_u32 s33, s33, 4096
  buffer_load_dwordx4 v[64:67], v3, s[8:11], s33 offen offset:0 sc1
  ds_read_b128 v[200:203], v3 offset:7168
  s_waitcnt lgkmcnt(5)
  v_mfma_f32_32x32x16_bf16 v[160:175], v[204:207], v[32:35], v[160:175]
  ds_read_b128 v[204:207], v8 offset:7168
  s_waitcnt vmcnt(7)
  s_waitcnt lgkmcnt(5)
  v_mfma_f32_32x32x16_bf16 v[144:159], v[208:211], v[36:39], v[144:159]
  buffer_load_dwordx4 v[68:71], v3, s[8:11], s33 offen offset:1024 sc1
  ds_read_b128 v[208:211], v3 offset:8192
  s_waitcnt lgkmcnt(5)
  v_mfma_f32_32x32x16_bf16 v[160:175], v[212:215], v[36:39], v[160:175]
  ds_read_b128 v[212:215], v8 offset:8192
  s_waitcnt vmcnt(7)
  s_waitcnt lgkmcnt(5)
  v_mfma_f32_32x32x16_bf16 v[144:159], v[192:195], v[40:43], v[144:159]
  buffer_load_dwordx4 v[72:75], v3, s[8:11], s33 offen offset:2048 sc1
  ds_read_b128 v[192:195], v3 offset:9216
  s_waitcnt lgkmcnt(5)
  v_mfma_f32_32x32x16_bf16 v[160:175], v[196:199], v[40:43], v[160:175]
  ds_read_b128 v[196:199], v8 offset:9216
  s_waitcnt vmcnt(7)
  s_waitcnt lgkmcnt(5)
  v_mfma_f32_32x32x16_bf16 v[144:159], v[200:203], v[44:47], v[144:159]
  buffer_load_dwordx4 v[76:79], v3, s[8:11], s33 offen offset:3072 sc1
  ds_read_b128 v[200:203], v3 offset:10240
  s_waitcnt lgkmcnt(5)
  v_mfma_f32_32x32x16_bf16 v[160:175], v[204:207], v[44:47], v[160:175]
  ds_read_b128 v[204:207], v8 offset:10240
  s_waitcnt vmcnt(7)
  s_waitcnt lgkmcnt(5)
  v_mfma_f32_32x32x16_bf16 v[144:159], v[208:211], v[48:51], v[144:159]
  s_add_u32 s33, s33, 4096
  buffer_load_dwordx4 v[80:83], v3, s[8:11], s33 offen offset:0 sc1
  ds_read_b128 v[208:211], v3 offset:11264
  s_waitcnt lgkmcnt(5)
  v_mfma_f32_32x32x16_bf16 v[160:175], v[212:215], v[48:51], v[160:175]
  ds_read_b128 v[212:215], v8 offset:11264
  s_waitcnt vmcnt(7)
  s_waitcnt lgkmcnt(5)
  v_mfma_f32_32x32x16_bf16 v[144:159], v[192:195], v[52:55], v[144:159]
  buffer_load_dwordx4 v[84:87], v3, s[8:11], s33 offen offset:1024 sc1
  ds_read_b128 v[192:195], v3 offset:12288
  s_waitcnt lgkmcnt(5)
  v_mfma_f32_32x32x16_bf16 v[160:175], v[196:199], v[52:55], v[160:175]
  ds_read_b128 v[196:199], v8 offset:12288
  s_waitcnt vmcnt(7)
  s_waitcnt lgkmcnt(5)
  v_mfma_f32_32x32x16_bf16 v[144:159], v[200:203], v[56:59], v[144:159]
  buffer_load_dwordx4 v[88:91], v3, s[8:11], s33 offen offset:2048 sc1
  ds_read_b128 v[200:203], v3 offset:13312
  s_waitcnt lgkmcnt(5)
  v_mfma_f32_32x32x16_bf16 v[160:175], v[204:207], v[56:59], v[160:175]
  ds_read_b128 v[204:207], v8 offset:13312
  s_waitcnt vmcnt(7)
  s_waitcnt lgkmcnt(5)
  v_mfma_f32_32x32x16_bf16 v[144:159], v[208:211], v[60:63], v[144:159]
  buffer_load_dwordx4 v[92:95], v3, s[8:11], s33 offen offset:3072 sc1
  ds_read_b128 v[208:211], v3 offset:14336
  s_waitcnt lgkmcnt(5)
  v_mfma_f32_32x32x16_bf16 v[160:175], v[212:215], v[60:63], v[160:175]
  ds_read_b128 v[212:215], v8 offset:14336
  s_waitcnt vmcnt(7)
  s_waitcnt lgkmcnt(5)
  v_mfma_f32_32x32x16_bf16 v[144:159], v[192:195], v[64:67], v[144:159]
  s_add_u32 s33, s33, 4096
  buffer_load_dwordx4 v[96:99], v3, s[8:11], s33 offen offset:0 sc1
  ds_read_b128 v[192:195], v3 offset:15360
  s_waitcnt lgkmcnt(5)
  v_mfma_f32_32x32x16_bf16 v[160:175], v[196:199], v[64:67], v[160:175]
  ds_read_b128 v[196:199], v8 offset:15360
  s_waitcnt vmcnt(7)
  s_waitcnt lgkmcnt(5)
  v_mfma_f32_32x32x16_bf16 v[144:159], v[200:203], v[68:71], v[144:159]
  buffer_load_dwordx4 v[100:103], v3, s[8:11], s33 offen offset:1024 sc1
  ds_read_b128 v[200:203], v3 offset:16384
  s_waitcnt lgkmcnt(5)
  v_mfma_f32_32x32x16_bf16 v[160:175], v[204:207], v[68:71], v[160:175]
  ds_read_b128 v[204:207], v8 offset:16384
  s_waitcnt vmcnt(7)
  s_waitcnt lgkmcnt(5)
  v_mfma_f32_32x32x16_bf16 v[144:159], v[208:211], v[72:75], v[144:159]
  buffer_load_dwordx4 v[104:107], v3, s[8:11], s33 offen offset:2048 sc1
  ds_read_b128 v[208:211], v3 offset:17408
  s_waitcnt lgkmcnt(5)
  v_mfma_f32_32x32x16_bf16 v[160:175], v[212:215], v[72:75], v[160:175]
  ds_read_b128 v[212:215], v8 offset:17408
  s_waitcnt vmcnt(7)
  s_waitcnt lgkmcnt(5)
  v_mfma_f32_32x32x16_bf16 v[144:159], v[192:195], v[76:79], v[144:159]
  buffer_load_dwordx4 v[108:111], v3, s[8:11], s33 offen offset:3072 sc1
  ds_read_b128 v[192:195], v3 offset:18432
  s_waitcnt lgkmcnt(5)
  v_mfma_f32_32x32x16_bf16 v[160:175], v[196:199], v[76:79], v[160:175]
  ds_read_b128 v[196:199], v8 offset:18432
  s_waitcnt vmcnt(7)
  s_waitcnt lgkmcnt(5)
  v_mfma_f32_32x32x16_bf16 v[144:159], v[200:203], v[80:83], v[144:159]
  s_add_u32 s33, s33, 4096
  buffer_load_dwordx4 v[112:115], v3, s[8:11], s33 offen offset:0 sc1
  ds_read_b128 v[200:203], v3 offset:19456
  s_waitcnt lgkmcnt(5)
  v_mfma_f32_32x32x16_bf16 v[160:175], v[204:207], v[80:83], v[160:175]
  ds_read_b128 v[204:207], v8 offset:19456
  s_waitcnt vmcnt(7)
  s_waitcnt lgkmcnt(5)
  v_mfma_f32_32x32x16_bf16 v[144:159], v[208:211], v[84:87], v[144:159]
  buffer_load_dwordx4 v[116:119], v3, s[8:11], s33 offen offset:1024 sc1
  ds_read_b128 v[208:211], v3 offset:20480
  s_waitcnt lgkmcnt(5)
  v_mfma_f32_32x32x16_bf16 v[160:175], v[212:215], v[84:87], v[160:175]
  ds_read_b128 v[212:215], v8 offset:20480
  s_waitcnt vmcnt(7)
  s_waitcnt lgkmcnt(5)
  v_mfma_f32_32x32x16_bf16 v[144:159], v[192:195], v[88:91], v[144:159]
  buffer_load_dwordx4 v[120:123], v3, s[8:11], s33 offen offset:2048 sc1
  ds_read_b128 v[192:195], v3 offset:21504
  s_waitcnt lgkmcnt(5)
  v_mfma_f32_32x32x16_bf16 v[160:175], v[196:199], v[88:91], v[160:175]
  ds_read_b128 v[196:199], v8 offset:21504
  s_waitcnt vmcnt(7)
  s_waitcnt lgkmcnt(5)
  v_mfma_f32_32x32x16_bf16 v[144:159], v[200:203], v[92:95], v[144:159]
  buffer_load_dwordx4 v[124:127], v3, s[8:11], s33 offen offset:3072 sc1
  ds_read_b128 v[200:203], v3 offset:22528
  s_waitcnt lgkmcnt(5)
  v_mfma_f32_32x32x16_bf16 v[160:175], v[204:207], v[92:95], v[160:175]
  ds_read_b128 v[204:207], v8 offset:22528
  s_waitcnt vmcnt(7)
  s_waitcnt lgkmcnt(5)
  v_mfma_f32_32x32x16_bf16 v[144:159], v[208:211], v[96:99], v[144:159]
  s_add_u32 s33, s33, 4096
  buffer_load_dwordx4 v[128:131], v3, s[8:11], s33 offen offset:0 sc1
  ds_read_b128 v[208:211], v3 offset:23552
  s_waitcnt lgkmcnt(5)
  v_mfma_f32_32x32x16_bf16 v[160:175], v[212:215], v[96:99], v[160:175]
  ds_read_b128 v[212:215], v8 offset:23552
  s_waitcnt vmcnt(7)
  s_waitcnt lgkmcnt(5)
  v_mfma_f32_32x32x16_bf16 v[144:159], v[192:195], v[100:103], v[144:159]
  buffer_load_dwordx4 v[132:135], v3, s[8:11], s33 offen offset:1024 sc1
  ds_read_b128 v[192:195], v3 offset:24576
  s_waitcnt lgkmcnt(5)
  v_mfma_f32_32x32x16_bf16 v[160:175], v[196:199], v[100:103], v[160:175]
  ds_read_b128 v[196:199], v8 offset:24576
  s_waitcnt vmcnt(7)
  s_waitcnt lgkmcnt(5)
  v_mfma_f32_32x32x16_bf16 v[144:159], v[200:203], v[104:107], v[144:159]
  buffer_load_dwordx4 v[136:139], v3, s[8:11], s33 offen offset:2048 sc1
  ds_read_b128 v[200:203], v3 offset:25600
  s_waitcnt lgkmcnt(5)
  v_mfma_f32_32x32x16_bf16 v[160:175], v[204:207], v[104:107], v[160:175]
  ds_read_b128 v[204:207], v8 offset:25600
  s_waitcnt vmcnt(7)
  s_waitcnt lgkmcnt(5)
  v_mfma_f32_32x32x16_bf16 v[144:159], v[208:211], v[108:111], v[144:159]
  buffer_load_dwordx4 v[140:143], v3, s[8:11], s33 offen offset:3072 sc1
  ds_read_b128 v[208:211], v3 offset:26624
  s_waitcnt lgkmcnt(5)
  v_mfma_f32_32x32x16_bf16 v[160:175], v[212:215], v[108:111], v[160:175]
  buffer_load_dwordx2 v[216:217], v237, s[8:11], s34 offen offset:0 sc1
  ds_read_b128 v[212:215], v8 offset:26624
  s_waitcnt vmcnt(8)
  s_waitcnt lgkmcnt(5)
  v_mfma_f32_32x32x16_bf16 v[144:159], v[192:195], v[112:115], v[144:159]
  buffer_load_dwordx2 v[218:219], v237, s[8:11], s34 offen offset:256 sc1
  ds_read_b128 v[192:195], v3 offset:27648
  s_waitcnt lgkmcnt(5)
  v_mfma_f32_32x32x16_bf16 v[160:175], v[196:199], v[112:115], v[160:175]
  buffer_load_dwordx2 v[220:221], v237, s[8:11], s34 offen offset:512 sc1
  ds_read_b128 v[196:199], v8 offset:27648
  s_waitcnt vmcnt(9)
  s_waitcnt lgkmcnt(5)
  v_mfma_f32_32x32x16_bf16 v[144:159], v[200:203], v[116:119], v[144:159]
  buffer_load_dwordx2 v[222:223], v237, s[8:11], s34 offen offset:768 sc1
  ds_read_b128 v[200:203], v3 offset:28672
  s_waitcnt lgkmcnt(5)
  v_mfma_f32_32x32x16_bf16 v[160:175], v[204:207], v[116:119], v[160:175]
  buffer_load_dwordx2 v[224:225], v237, s[8:11], s34 offen offset:1024 sc1
  ds_read_b128 v[204:207], v8 offset:28672
  s_waitcnt vmcnt(10)
  s_waitcnt lgkmcnt(5)
  v_mfma_f32_32x32x16_bf16 v[144:159], v[208:211], v[120:123], v[144:159]
  buffer_load_dwordx2 v[226:227], v237, s[8:11], s34 offen offset:1280 sc1
  ds_read_b128 v[208:211], v3 offset:29696
  s_waitcnt lgkmcnt(5)
  v_mfma_f32_32x32x16_bf16 v[160:175], v[212:215], v[120:123], v[160:175]
  buffer_load_dwordx2 v[228:229], v237, s[8:11], s34 offen offset:1536 sc1
  ds_read_b128 v[212:215], v8 offset:29696
  s_waitcnt vmcnt(11)
  s_waitcnt lgkmcnt(5)
  v_mfma_f32_32x32x16_bf16 v[144:159], v[192:195], v[124:127], v[144:159]
  buffer_load_dwordx2 v[230:231], v237, s[8:11], s34 offen offset:1792 sc1
  ds_read_b128 v[192:195], v3 offset:30720
  s_waitcnt lgkmcnt(5)
  v_mfma_f32_32x32x16_bf16 v[160:175], v[196:199], v[124:127], v[160:175]
  buffer_load_dwordx2 v[240:241], v237, s[8:11], s34 offen offset:2048 sc1
  ds_read_b32 v191, v233 offset:64
  ds_read_b128 v[196:199], v8 offset:30720
  s_waitcnt vmcnt(12)
  s_waitcnt lgkmcnt(6)
  v_mfma_f32_32x32x16_bf16 v[144:159], v[200:203], v[128:131], v[144:159]
  buffer_load_dwordx2 v[242:243], v237, s[8:11], s34 offen offset:2304 sc1
  ds_read_b128 v[200:203], v3 offset:31744
  s_waitcnt lgkmcnt(6)
  v_mfma_f32_32x32x16_bf16 v[160:175], v[204:207], v[128:131], v[160:175]
  buffer_load_dwordx2 v[244:245], v237, s[8:11], s34 offen offset:2560 sc1
  ds_read_b128 v[204:207], v8 offset:31744
  s_waitcnt vmcnt(13)
  s_waitcnt lgkmcnt(6)
  v_mfma_f32_32x32x16_bf16 v[144:159], v[208:211], v[132:135], v[144:159]
  buffer_load_dwordx2 v[246:247], v237, s[8:11], s34 offen offset:2816 sc1
  s_waitcnt lgkmcnt(3)
  v_cmp_gt_u32 vcc, 9, v191
  s_cmp_eq_u64 vcc, 0
  s_cbranch_scc1 f_wt_ok
  s_mov_b32 s60, 0
f_wt:
  ds_read_b32 v191, v233 offset:64
  s_waitcnt lgkmcnt(0)
  v_cmp_gt_u32 vcc, 9, v191
  s_cmp_eq_u64 vcc, 0
  s_cbranch_scc1 f_wt_ok
  s_sleep 1
  s_add_u32 s60, s60, 1
  s_cmp_lt_u32 s60, 640000
  s_cbranch_scc1 f_wt
f_wt_ok:
  ds_read_b128 v[208:211], v3 offset:32768
  v_mfma_f32_32x32x16_bf16 v[160:175], v[212:215], v[132:135], v[160:175]
  buffer_load_dwordx2 v[248:249], v237, s[8:11], s34 offen offset:3072 sc1
  ds_read_b128 v[212:215], v3 offset:33792
  s_waitcnt vmcnt(14)
  v_mfma_f32_32x32x16_bf16 v[144:159], v[192:195], v[136:139], v[144:159]
  buffer_load_dwordx2 v[250:251], v237, s[8:11], s34 offen offset:3328 sc1
  ds_read_b128 v[192:195], v3 offset:34816
  s_waitcnt lgkmcnt(5)
  v_mfma_f32_32x32x16_bf16 v[160:175], v[196:199], v[136:139], v[160:175]
  buffer_load_dwordx2 v[252:253], v237, s[8:11], s34 offen offset:3584 sc1
  ds_read_b128 v[196:199], v3 offset:35840
  s_waitcnt vmcnt(15)
  s_waitcnt lgkmcnt(5)
  v_mfma_f32_32x32x16_bf16 v[144:159], v[200:203], v[140:143], v[144:159]
  buffer_load_dwordx2 v[254:255], v237, s[8:11], s34 offen offset:3840 sc1
  ds_read_b128 v[200:203], v3 offset:36864
  s_waitcnt lgkmcnt(5)
  v_mfma_f32_32x32x16_bf16 v[160:175], v[204:207], v[140:143], v[160:175]
  ds_read_b128 v[204:207], v3 offset:37888
  s_waitcnt lgkmcnt(5)
  v_mfma_f32_32x32x16_bf16 v[176:191], v[208:211], v[16:19], 0
  s_waitcnt vmcnt(0)
  v_add_f32 v216, v216, v240
  v_add_f32 v217, v217, v241
  v_add_f32 v218, v218, v242
  v_add_f32 v219, v219, v243
  v_add_f32 v220, v220, v244
  v_add_f32 v221, v221, v245
  v_add_f32 v222, v222, v246
  ds_read_b128 v[208:211], v3 offset:38912
  s_waitcnt lgkmcnt(5)
  v_mfma_f32_32x32x16_bf16 v[176:191], v[212:215], v[20:23], v[176:191]
  buffer_load_dwordx4 v[16:19], v2, s[8:11], s38 offen offset:0
  v_add_f32 v223, v223, v247
  v_add_f32 v224, v224, v248
  v_add_f32 v225, v225, v249
  v_add_f32 v226, v226, v250
  v_add_f32 v227, v227, v251
  v_add_f32 v228, v228, v252
  v_add_f32 v229, v229, v253
  v_add_f32 v230, v230, v254
  ds_read_b128 v[212:215], v3 offset:39936
  s_waitcnt lgkmcnt(5)
  v_mfma_f32_32x32x16_bf16 v[176:191], v[192:195], v[24:27], v[176:191]
  buffer_load_dwordx4 v[20:23], v2, s[8:11], s39 offen offset:0
  v_add_f32 v231, v231, v255
  v_add_f32 v216, v216, v224
  v_add_f32 v217, v217, v225
  v_add_f32 v218, v218, v226
  v_add_f32 v219, v219, v227
  v_add_f32 v220, v220, v228
  v_add_f32 v221, v221, v229
  v_add_f32 v222, v222, v230
  ds_read_b128 v[192:195], v3 offset:40960
  s_waitcnt lgkmcnt(5)
  v_mfma_f32_32x32x16_bf16 v[176:191], v[196:199], v[28:31], v[176:191]
  buffer_load_dwordx4 v[24:27], v2, s[8:11], s38 offen offset:1024
  v_add_f32 v223, v223, v231
  v_add_f32 v216, v216, v220
  v_add_f32 v217, v217, v221
  v_add_f32 v218, v218, v222
  v_add_f32 v219, v219, v223
  v_add_f32 v216, v216, v218
  v_add_f32 v217, v217, v219
  v_mov_b32 v218, v216
  ds_read_b128 v[196:199], v3 offset:41984
  s_waitcnt lgkmcnt(5)
  v_mfma_f32_32x32x16_bf16 v[176:191], v[200:203], v[32:35], v[176:191]
  buffer_load_dwordx4 v[28:31], v2, s[8:11], s39 offen offset:1024
  v_mov_b32 v219, v217
  s_nop 1
  v_permlane32_swap_b32 v216, v218
  v_permlane32_swap_b32 v217, v219
  v_add_f32 v216, v216, v218
  v_add_f32 v217, v217, v219
  v_mul_f32 v4, -0.001953125, v216
  v_mul_f32 v217, 0.001953125, v217
  ds_read_b128 v[200:203], v3 offset:43008
  s_waitcnt lgkmcnt(5)
  v_mfma_f32_32x32x16_bf16 v[176:191], v[204:207], v[36:39], v[176:191]
  buffer_load_dwordx4 v[32:35], v2, s[8:11], s38 offen offset:2048
  v_fma_f32 v217, -v4, v4, v217
  v_max_f32 v217, 0, v217
  v_add_f32 v217, 0x3727c5ac, v217
  v_rsq_f32 v6, v217
  s_nop 0
  v_mul_f32 v5, -1.4426950408889634, v6
  ds_read_b128 v[216:219], v7 offset:0
  ds_read_b128 v[220:223], v7 offset:64
  ds_read_b128 v[204:207], v3 offset:44032
  s_waitcnt lgkmcnt(7)
  v_mfma_f32_32x32x16_bf16 v[176:191], v[208:211], v[40:43], v[176:191]
  buffer_load_dwordx4 v[36:39], v2, s[8:11], s39 offen offset:2048
  ds_read_b128 v[224:227], v7 offset:128
  ds_read_b128 v[228:231], v7 offset:192
  s_waitcnt lgkmcnt(0)
  v_fma_f32 v144, v4, v216, v144
  v_fma_f32 v145, v4, v217, v145
  v_fma_f32 v146, v4, v218, v146
  v_fma_f32 v147, v4, v219, v147
  v_fma_f32 v144, v5, v144, v224
  v_fma_f32 v145, v5, v145, v225
  ds_read_b128 v[208:211], v3 offset:45056
  v_mfma_f32_32x32x16_bf16 v[176:191], v[212:215], v[44:47], v[176:191]
  buffer_load_dwordx4 v[40:43], v2, s[8:11], s38 offen offset:3072
  v_fma_f32 v146, v5, v146, v226
  v_fma_f32 v147, v5, v147, v227
  v_exp_f32 v144, v144
  v_exp_f32 v145, v145
  v_exp_f32 v146, v146
  ds_read_b128 v[212:215], v3 offset:46080
  v_mfma_f32_32x32x16_bf16 v[176:191], v[192:195], v[48:51], v[176:191]
  buffer_load_dwordx4 v[44:47], v2, s[8:11], s39 offen offset:3072
  v_exp_f32 v147, v147
  v_fma_f32 v152, v4, v220, v152
  v_fma_f32 v153, v4, v221, v153
  v_fma_f32 v154, v4, v222, v154
  v_fma_f32 v155, v4, v223, v155
  v_add_f32 v144, 1.0, v144
  v_add_f32 v145, 1.0, v145
  ds_read_b128 v[192:195], v3 offset:47104
  v_mfma_f32_32x32x16_bf16 v[176:191], v[196:199], v[52:55], v[176:191]
  s_add_u32 s61, s38, 4096
  buffer_load_dwordx4 v[48:51], v2, s[8:11], s61 offen offset:0
  v_add_f32 v146, 1.0, v146
  v_add_f32 v147, 1.0, v147
  v_rcp_f32 v144, v144
  v_rcp_f32 v145, v145
  v_rcp_f32 v146, v146
  ds_read_b128 v[196:199], v3 offset:48128
  v_mfma_f32_32x32x16_bf16 v[176:191], v[200:203], v[56:59], v[176:191]
  s_add_u32 s61, s39, 4096
  buffer_load_dwordx4 v[52:55], v2, s[8:11], s61 offen offset:0
  v_rcp_f32 v147, v147
  v_fma_f32 v152, v6, v152, v228
  v_fma_f32 v153, v6, v153, v229
  v_fma_f32 v154, v6, v154, v230
  v_fma_f32 v155, v6, v155, v231
  v_mul_f32 v152, v152, v144
  v_mul_f32 v153, v153, v145
  ds_read_b128 v[200:203], v8 offset:32768
  v_mfma_f32_32x32x16_bf16 v[176:191], v[204:207], v[60:63], v[176:191]
  s_add_u32 s61, s38, 4096
  buffer_load_dwordx4 v[56:59], v2, s[8:11], s61 offen offset:1024
  v_mul_f32 v154, v154, v146
  v_mul_f32 v155, v155, v147
  v_cvt_pk_bf16_f32 v232, v152, v153
  v_cvt_pk_bf16_f32 v233, v154, v155
  ds_read_b128 v[216:219], v7 offset:32
  ds_read_b128 v[220:223], v7 offset:96
  ds_read_b128 v[224:227], v7 offset:160
  ds_read_b128 v[228:231], v7 offset:224
  s_waitcnt lgkmcnt(0)
  v_fma_f32 v148, v4, v216, v148
  ds_read_b128 v[204:207], v8 offset:33792
  v_mfma_f32_32x32x16_bf16 v[176:191], v[208:211], v[64:67], v[176:191]
  s_add_u32 s61, s39, 4096
  buffer_load_dwordx4 v[60:63], v2, s[8:11], s61 offen offset:1024
  v_fma_f32 v149, v4, v217, v149
  v_fma_f32 v150, v4, v218, v150
  v_fma_f32 v151, v4, v219, v151
  v_fma_f32 v148, v5, v148, v224
  v_fma_f32 v149, v5, v149, v225
  v_fma_f32 v150, v5, v150, v226
  v_fma_f32 v151, v5, v151, v227
  ds_read_b128 v[208:211], v8 offset:34816
  v_mfma_f32_32x32x16_bf16 v[176:191], v[212:215], v[68:71], v[176:191]
  s_add_u32 s61, s38, 4096
  buffer_load_dwordx4 v[64:67], v2, s[8:11], s61 offen offset:2048
  v_exp_f32 v148, v148
  v_exp_f32 v149, v149
  v_exp_f32 v150, v150
  v_exp_f32 v151, v151
  ds_read_b128 v[212:215], v8 offset:35840
  v_mfma_f32_32x32x16_bf16 v[176:191], v[192:195], v[72:75], v[176:191]
  s_add_u32 s61, s39, 4096
  buffer_load_dwordx4 v[68:71], v2, s[8:11], s61 offen offset:2048
  v_fma_f32 v156, v4, v220, v156
  v_fma_f32 v157, v4, v221, v157
  v_fma_f32 v158, v4, v222, v158
  v_fma_f32 v159, v4, v223, v159
  v_add_f32 v148, 1.0, v148
  v_add_f32 v149, 1.0, v149
  v_add_f32 v150, 1.0, v150
  v_add_f32 v151, 1.0, v151
  ds_read_b128 v[192:195], v8 offset:36864
  v_mfma_f32_32x32x16_bf16 v[176:191], v[196:199], v[76:79], v[176:191]
  s_add_u32 s61, s38, 4096
  buffer_load_dwordx4 v[72:75], v2, s[8:11], s61 offen offset:3072
  v_rcp_f32 v148, v148
  v_rcp_f32 v149, v149
  v_rcp_f32 v150, v150
  v_rcp_f32 v151, v151
  ds_read_b128 v[196:199], v8 offset:37888
  v_mfma_f32_32x32x16_bf16 v[176:191], v[200:203], v[80:83], v[176:191]
  s_add_u32 s61, s39, 4096
  buffer_load_dwordx4 v[76:79], v2, s[8:11], s61 offen offset:3072
  v_fma_f32 v156, v6, v156, v228
  v_fma_f32 v157, v6, v157, v229
  v_fma_f32 v158, v6, v158, v230
  v_fma_f32 v159, v6, v159, v231
  v_mul_f32 v156, v156, v148
  v_mul_f32 v157, v157, v149
  v_mul_f32 v158, v158, v150
  v_mul_f32 v159, v159, v151
  ds_read_b128 v[200:203], v8 offset:38912
  s_waitcnt lgkmcnt(5)
  v_mfma_f32_32x32x16_bf16 v[176:191], v[204:207], v[84:87], v[176:191]
  s_add_u32 s61, s38, 8192
  buffer_load_dwordx4 v[80:83], v2, s[8:11], s61 offen offset:0
  v_cvt_pk_bf16_f32 v234, v156, v157
  v_cvt_pk_bf16_f32 v235, v158, v159
  buffer_store_dwordx4 v[232:235], v3, s[8:11], s35 offen offset:0
  ds_read_b128 v[216:219], v7 offset:256
  ds_read_b128 v[220:223], v7 offset:320
  ds_read_b128 v[224:227], v7 offset:384
  ds_read_b128 v[228:231], v7 offset:448
  s_waitcnt lgkmcnt(0)
  v_fma_f32 v160, v4, v216, v160
  v_fma_f32 v161, v4, v217, v161
  ds_read_b128 v[204:207], v8 offset:39936
  v_mfma_f32_32x32x16_bf16 v[176:191], v[208:211], v[88:91], v[176:191]
  s_add_u32 s61, s39, 8192
  buffer_load_dwordx4 v[84:87], v2, s[8:11], s61 offen offset:0
  s_add_u32 s61, s38, 8192
  buffer_load_dwordx4 v[144:147], v2, s[8:11], s61 offen offset:1024
  v_fma_f32 v162, v4, v218, v162
  v_fma_f32 v163, v4, v219, v163
  v_fma_f32 v160, v5, v160, v224
  v_fma_f32 v161, v5, v161, v225
  v_fma_f32 v162, v5, v162, v226
  v_fma_f32 v163, v5, v163, v227
  v_exp_f32 v160, v160
  ds_read_b128 v[208:211], v8 offset:40960
  v_mfma_f32_32x32x16_bf16 v[176:191], v[212:215], v[92:95], v[176:191]
  s_add_u32 s61, s39, 8192
  buffer_load_dwordx4 v[148:151], v2, s[8:11], s61 offen offset:1024
  s_add_u32 s61, s38, 8192
  buffer_load_dwordx4 v[152:155], v2, s[8:11], s61 offen offset:2048
  v_exp_f32 v161, v161
  v_exp_f32 v162, v162
  v_exp_f32 v163, v163
  v_fma_f32 v168, v4, v220, v168
  v_fma_f32 v169, v4, v221, v169
  ds_read_b128 v[212:215], v8 offset:41984
  v_mfma_f32_32x32x16_bf16 v[176:191], v[192:195], v[96:99], v[176:191]
  s_add_u32 s61, s39, 8192
  buffer_load_dwordx4 v[156:159], v2, s[8:11], s61 offen offset:2048
  s_add_u32 s61, s38, 8192
  buffer_load_dwordx4 v[88:91], v2, s[8:11], s61 offen offset:3072
  v_fma_f32 v170, v4, v222, v170
  v_fma_f32 v171, v4, v223, v171
  v_add_f32 v160, 1.0, v160
  v_add_f32 v161, 1.0, v161
  v_add_f32 v162, 1.0, v162
  v_add_f32 v163, 1.0, v163
  v_rcp_f32 v160, v160
  ds_read_b128 v[192:195], v8 offset:43008
  v_mfma_f32_32x32x16_bf16 v[176:191], v[196:199], v[100:103], v[176:191]
  s_add_u32 s61, s39, 8192
  buffer_load_dwordx4 v[92:95], v2, s[8:11], s61 offen offset:3072
  s_add_u32 s61, s38, 12288
  buffer_load_dwordx4 v[96:99], v2, s[8:11], s61 offen offset:0
  v_rcp_f32 v161, v161
  v_rcp_f32 v162, v162
  v_rcp_f32 v163, v163
  v_fma_f32 v168, v6, v168, v228
  v_fma_f32 v169, v6, v169, v229
  ds_read_b128 v[196:199], v8 offset:44032
  v_mfma_f32_32x32x16_bf16 v[176:191], v[200:203], v[104:107], v[176:191]
  s_add_u32 s61, s39, 12288
  buffer_load_dwordx4 v[100:103], v2, s[8:11], s61 offen offset:0
  v_fma_f32 v170, v6, v170, v230
  v_fma_f32 v171, v6, v171, v231
  v_mul_f32 v168, v168, v160
  v_mul_f32 v169, v169, v161
  v_mul_f32 v170, v170, v162
  v_mul_f32 v171, v171, v163
  v_cvt_pk_bf16_f32 v236, v168, v169
  v_cvt_pk_bf16_f32 v237, v170, v171
  ds_read_b128 v[200:203], v8 offset:45056
  s_waitcnt lgkmcnt(5)
  v_mfma_f32_32x32x16_bf16 v[176:191], v[204:207], v[108:111], v[176:191]
  s_add_u32 s61, s38, 12288
  buffer_load_dwordx4 v[104:107], v2, s[8:11], s61 offen offset:1024
  ds_read_b128 v[216:219], v7 offset:288
  ds_read_b128 v[220:223], v7 offset:352
  ds_read_b128 v[224:227], v7 offset:416
  ds_read_b128 v[228:231], v7 offset:480
  s_waitcnt lgkmcnt(0)
  v_fma_f32 v164, v4, v216, v164
  v_fma_f32 v165, v4, v217, v165
  v_fma_f32 v166, v4, v218, v166
  v_fma_f32 v167, v4, v219, v167
  v_fma_f32 v164, v5, v164, v224
  ds_read_b128 v[204:207], v8 offset:46080
  v_mfma_f32_32x32x16_bf16 v[176:191], v[208:211], v[112:115], v[176:191]
  s_add_u32 s61, s39, 12288
  buffer_load_dwordx4 v[108:111], v2, s[8:11], s61 offen offset:1024
  v_fma_f32 v165, v5, v165, v225
  v_fma_f32 v166, v5, v166, v226
  v_fma_f32 v167, v5, v167, v227
  v_exp_f32 v164, v164
  v_exp_f32 v165, v165
  ds_read_b128 v[208:211], v8 offset:47104
  v_mfma_f32_32x32x16_bf16 v[176:191], v[212:215], v[116:119], v[176:191]
  s_add_u32 s61, s38, 12288
  buffer_load_dwordx4 v[112:115], v2, s[8:11], s61 offen offset:2048
  v_exp_f32 v166, v166
  v_exp_f32 v167, v167
  v_fma_f32 v172, v4, v220, v172
  v_fma_f32 v173, v4, v221, v173
  v_fma_f32 v174, v4, v222, v174
  v_fma_f32 v175, v4, v223, v175
  ds_read_b128 v[212:215], v8 offset:48128
  v_mfma_f32_32x32x16_bf16 v[176:191], v[192:195], v[120:123], v[176:191]
  s_add_u32 s61, s39, 12288
  buffer_load_dwordx4 v[116:119], v2, s[8:11], s61 offen offset:2048
  v_add_f32 v164, 1.0, v164
  v_add_f32 v165, 1.0, v165
  v_add_f32 v166, 1.0, v166
  v_add_f32 v167, 1.0, v167
  v_rcp_f32 v164, v164
  v_rcp_f32 v165, v165
  v_mfma_f32_32x32x16_bf16 v[176:191], v[196:199], v[124:127], v[176:191]
  s_add_u32 s61, s38, 12288
  buffer_load_dwordx4 v[120:123], v2, s[8:11], s61 offen offset:3072
  v_rcp_f32 v166, v166
  v_rcp_f32 v167, v167
  v_fma_f32 v172, v6, v172, v228
  v_fma_f32 v173, v6, v173, v229
  v_fma_f32 v174, v6, v174, v230
  v_fma_f32 v175, v6, v175, v231
  v_mfma_f32_32x32x16_bf16 v[176:191], v[200:203], v[128:131], v[176:191]
  s_add_u32 s61, s39, 12288
  buffer_load_dwordx4 v[124:127], v2, s[8:11], s61 offen offset:3072
  v_mul_f32 v172, v172, v164
  v_mul_f32 v173, v173, v165
  v_mul_f32 v174, v174, v166
  v_mul_f32 v175, v175, v167
  v_cvt_pk_bf16_f32 v238, v172, v173
  v_cvt_pk_bf16_f32 v239, v174, v175
  buffer_store_dwordx4 v[236:239], v3, s[8:11], s35 offen offset:1024
  s_waitcnt lgkmcnt(2)
  v_mfma_f32_32x32x16_bf16 v[176:191], v[204:207], v[132:135], v[176:191]
  s_add_u32 s61, s38, 16384
  buffer_load_dwordx4 v[128:131], v2, s[8:11], s61 offen offset:0
  s_add_u32 s61, s39, 16384
  buffer_load_dwordx4 v[160:163], v2, s[8:11], s61 offen offset:0
  s_waitcnt lgkmcnt(1)
  v_mfma_f32_32x32x16_bf16 v[176:191], v[208:211], v[136:139], v[176:191]
  s_add_u32 s61, s38, 16384
  buffer_load_dwordx4 v[164:167], v2, s[8:11], s61 offen offset:1024
  s_add_u32 s61, s39, 16384
  buffer_load_dwordx4 v[168:171], v2, s[8:11], s61 offen offset:1024
  s_waitcnt lgkmcnt(0)
  v_mfma_f32_32x32x16_bf16 v[176:191], v[212:215], v[140:143], v[176:191]
  s_add_u32 s61, s38, 16384
  buffer_load_dwordx4 v[172:175], v2, s[8:11], s61 offen offset:2048
  s_add_u32 s61, s39, 16384
  buffer_load_dwordx4 v[132:135], v2, s[8:11], s61 offen offset:2048
  ds_read_b128 v[216:219], v7 offset:512
  ds_read_b128 v[220:223], v7 offset:576
  ds_read_b128 v[224:227], v7 offset:640
  ds_read_b128 v[228:231], v7 offset:704
  s_nop 7
  s_waitcnt lgkmcnt(0)
  v_fma_f32 v176, v4, v216, v176
  v_fma_f32 v177, v4, v217, v177
  v_fma_f32 v178, v4, v218, v178
  v_fma_f32 v179, v4, v219, v179
  v_fma_f32 v176, v5, v176, v224
  v_fma_f32 v177, v5, v177, v225
  v_fma_f32 v178, v5, v178, v226
  v_fma_f32 v179, v5, v179, v227
  v_exp_f32 v176, v176
  v_exp_f32 v177, v177
  v_exp_f32 v178, v178
  v_exp_f32 v179, v179
  v_fma_f32 v184, v4, v220, v184
  v_fma_f32 v185, v4, v221, v185
  v_fma_f32 v186, v4, v222, v186
  v_fma_f32 v187, v4, v223, v187
  v_add_f32 v176, 1.0, v176
  v_add_f32 v177, 1.0, v177
  v_add_f32 v178, 1.0, v178
  v_add_f32 v179, 1.0, v179
  v_rcp_f32 v176, v176
  v_rcp_f32 v177, v177
  v_rcp_f32 v178, v178
  v_rcp_f32 v179, v179
  v_fma_f32 v184, v6, v184, v228
  v_fma_f32 v185, v6, v185, v229
  v_fma_f32 v186, v6, v186, v230
  v_fma_f32 v187, v6, v187, v231
  v_mul_f32 v184, v184, v176
  v_mul_f32 v185, v185, v177
  v_mul_f32 v186, v186, v178
  v_mul_f32 v187, v187, v179
  v_cvt_pk_bf16_f32 v232, v184, v185
  v_cvt_pk_bf16_f32 v233, v186, v187
  ds_read_b128 v[216:219], v7 offset:544
  ds_read_b128 v[220:223], v7 offset:608
  ds_read_b128 v[224:227], v7 offset:672
  ds_read_b128 v[228:231], v7 offset:736
  s_waitcnt lgkmcnt(0)
  v_fma_f32 v180, v4, v216, v180
  v_fma_f32 v181, v4, v217, v181
  v_fma_f32 v182, v4, v218, v182
  v_fma_f32 v183, v4, v219, v183
  v_fma_f32 v180, v5, v180, v224
  v_fma_f32 v181, v5, v181, v225
  v_fma_f32 v182, v5, v182, v226
  v_fma_f32 v183, v5, v183, v227
  v_exp_f32 v180, v180
  v_exp_f32 v181, v181
  v_exp_f32 v182, v182
  v_exp_f32 v183, v183
  v_fma_f32 v188, v4, v220, v188
  v_fma_f32 v189, v4, v221, v189
  v_fma_f32 v190, v4, v222, v190
  v_fma_f32 v191, v4, v223, v191
  v_add_f32 v180, 1.0, v180
  v_add_f32 v181, 1.0, v181
  v_add_f32 v182, 1.0, v182
  v_add_f32 v183, 1.0, v183
  v_rcp_f32 v180, v180
  v_rcp_f32 v181, v181
  v_rcp_f32 v182, v182
  v_rcp_f32 v183, v183
  v_fma_f32 v188, v6, v188, v228
  v_fma_f32 v189, v6, v189, v229
  v_fma_f32 v190, v6, v190, v230
  v_fma_f32 v191, v6, v191, v231
  v_mul_f32 v188, v188, v180
  v_mul_f32 v189, v189, v181
  v_mul_f32 v190, v190, v182
  v_mul_f32 v191, v191, v183
  v_cvt_pk_bf16_f32 v234, v188, v189
  v_cvt_pk_bf16_f32 v235, v190, v191
  buffer_store_dwordx4 v[232:235], v3, s[8:11], s35 offen offset:2048
  v_mov_b32 v9, 1
  v_mov_b32 v10, 0
  s_add_u32 s61, s38, 16384
  buffer_load_dwordx4 v[136:139], v2, s[8:11], s61 offen offset:3072
  s_add_u32 s61, s39, 16384
  buffer_load_dwordx4 v[140:143], v2, s[8:11], s61 offen offset:3072
  s_add_u32 s61, s38, 20480
  buffer_load_dwordx4 v[192:195], v2, s[8:11], s61 offen offset:0
  s_add_u32 s61, s39, 20480
  buffer_load_dwordx4 v[196:199], v2, s[8:11], s61 offen offset:0
  s_add_u32 s61, s38, 20480
  buffer_load_dwordx4 v[200:203], v2, s[8:11], s61 offen offset:1024
  s_add_u32 s61, s39, 20480
  buffer_load_dwordx4 v[204:207], v2, s[8:11], s61 offen offset:1024
  s_waitcnt vmcnt(6)
  s_mov_b64 exec, 1
  buffer_store_dword v9, v10, s[8:11], s55 offen
  s_mov_b64 exec, -1
f_d:
  s_cmp_ge_u32 s22, 4
  s_cbranch_scc1 fused_kernel_pr_79
  s_setprio 3
fused_kernel_pr_79:
  v_and_b32 v10, 7, v1
  v_lshlrev_b32 v10, 2, v10
  buffer_load_dword v8, v10, s[8:11], s31 offen sc1
  v_and_b32 v11, 31, v1
  v_lshrrev_b32 v9, 5, v1
  v_lshlrev_b32 v11, 10, v11
  v_lshl_add_u32 v11, v9, 3, v11
  v_lshlrev_b32 v9, 4, v9
  s_mov_b32 s60, 0
  s_branch f_p3_chk
f_p3:
  buffer_load_dword v8, v10, s[8:11], s31 offen sc1
f_p3_chk:
  s_waitcnt vmcnt(0)
  v_cmp_ne_u32 vcc, 1, v8
  s_cmp_eq_u64 vcc, 0
  s_cbranch_scc1 f_p3_ok
  s_add_u32 s60, s60, 1
  s_cmp_lt_u32 s60, 40000
  s_cbranch_scc1 f_p3
f_p3_ok:
  buffer_load_dwordx4 v[232:235], v3, s[8:11], s28 offen offset:0 sc1
  buffer_load_dwordx4 v[236:239], v3, s[8:11], s28 offen offset:1024 sc1
  buffer_load_dwordx4 v[240:243], v3, s[8:11], s28 offen offset:2048 sc1
  buffer_load_dwordx4 v[244:247], v3, s[8:11], s28 offen offset:3072 sc1
  s_add_u32 s28, s28, 4096
  buffer_load_dwordx4 v[248:251], v3, s[8:11], s28 offen offset:0 sc1
  buffer_load_dwordx4 v[252:255], v3, s[8:11], s28 offen offset:1024 sc1
  buffer_load_dwordx4 v[208:211], v3, s[8:11], s28 offen offset:2048 sc1
  buffer_load_dwordx4 v[212:215], v3, s[8:11], s28 offen offset:3072 sc1
  s_waitcnt vmcnt(7)
  v_mfma_f32_32x32x16_bf16 v[176:191], v[16:19], v[232:235], 0
  v_mfma_f32_32x32x16_bf16 v[216:231], v[20:23], v[232:235], 0
  s_waitcnt vmcnt(6)
  v_mfma_f32_32x32x16_bf16 v[176:191], v[24:27], v[236:239], v[176:191]
  v_mfma_f32_32x32x16_bf16 v[216:231], v[28:31], v[236:239], v[216:231]
  s_add_u32 s28, s28, 4096
  buffer_load_dwordx4 v[16:19], v3, s[8:11], s28 offen offset:0 sc1
  buffer_load_dwordx4 v[20:23], v3, s[8:11], s28 offen offset:1024 sc1
  buffer_load_dwordx4 v[232:235], v3, s[8:11], s28 offen offset:2048 sc1
  s_waitcnt vmcnt(8)
  v_mfma_f32_32x32x16_bf16 v[176:191], v[32:35], v[240:243], v[176:191]
  v_mfma_f32_32x32x16_bf16 v[216:231], v[36:39], v[240:243], v[216:231]
  buffer_load_dwordx4 v[24:27], v3, s[8:11], s28 offen offset:3072 sc1
  s_add_u32 s28, s28, 4096
  buffer_load_dwordx4 v[28:31], v3, s[8:11], s28 offen offset:0 sc1
  buffer_load_dwordx4 v[236:239], v3, s[8:11], s28 offen offset:1024 sc1
  s_waitcnt vmcnt(10)
  v_mfma_f32_32x32x16_bf16 v[176:191], v[40:43], v[244:247], v[176:191]
  v_mfma_f32_32x32x16_bf16 v[216:231], v[44:47], v[244:247], v[216:231]
  buffer_load_dwordx4 v[32:35], v3, s[8:11], s28 offen offset:2048 sc1
  buffer_load_dwordx4 v[36:39], v3, s[8:11], s28 offen offset:3072 sc1
  s_add_u32 s28, s28, 4096
  buffer_load_dwordx4 v[240:243], v3, s[8:11], s28 offen offset:0 sc1
  s_waitcnt vmcnt(12)
  v_mfma_f32_32x32x16_bf16 v[176:191], v[48:51], v[248:251], v[176:191]
  v_mfma_f32_32x32x16_bf16 v[216:231], v[52:55], v[248:251], v[216:231]
  buffer_load_dwordx4 v[40:43], v3, s[8:11], s28 offen offset:1024 sc1
  buffer_load_dwordx4 v[44:47], v3, s[8:11], s28 offen offset:2048 sc1
  buffer_load_dwordx4 v[244:247], v3, s[8:11], s28 offen offset:3072 sc1
  s_waitcnt vmcnt(14)
  v_mfma_f32_32x32x16_bf16 v[176:191], v[56:59], v[252:255], v[176:191]
  v_mfma_f32_32x32x16_bf16 v[216:231], v[60:63], v[252:255], v[216:231]
  s_add_u32 s28, s28, 4096
  buffer_load_dwordx4 v[48:51], v3, s[8:11], s28 offen offset:0 sc1
  buffer_load_dwordx4 v[52:55], v3, s[8:11], s28 offen offset:1024 sc1
  s_waitcnt vmcnt(15)
  v_mfma_f32_32x32x16_bf16 v[176:191], v[64:67], v[208:211], v[176:191]
  v_mfma_f32_32x32x16_bf16 v[216:231], v[68:71], v[208:211], v[216:231]
  s_add_u32 s61, s50, 10240
  buffer_load_dwordx4 v[248:251], v9, s[8:11], s61 offen
  buffer_load_dwordx4 v[56:59], v9, s[8:11], s61 offen offset:32
  s_waitcnt vmcnt(16)
  v_mfma_f32_32x32x16_bf16 v[176:191], v[72:75], v[212:215], v[176:191]
  v_mfma_f32_32x32x16_bf16 v[216:231], v[76:79], v[212:215], v[216:231]
  s_waitcnt vmcnt(15)
  v_mfma_f32_32x32x16_bf16 v[176:191], v[80:83], v[16:19], v[176:191]
  v_mfma_f32_32x32x16_bf16 v[216:231], v[84:87], v[16:19], v[216:231]
  s_waitcnt vmcnt(14)
  v_mfma_f32_32x32x16_bf16 v[176:191], v[144:147], v[20:23], v[176:191]
  v_mfma_f32_32x32x16_bf16 v[216:231], v[148:151], v[20:23], v[216:231]
  s_waitcnt vmcnt(13)
  v_mfma_f32_32x32x16_bf16 v[176:191], v[152:155], v[232:235], v[176:191]
  v_mfma_f32_32x32x16_bf16 v[216:231], v[156:159], v[232:235], v[216:231]
  s_waitcnt vmcnt(12)
  v_mfma_f32_32x32x16_bf16 v[176:191], v[88:91], v[24:27], v[176:191]
  v_mfma_f32_32x32x16_bf16 v[216:231], v[92:95], v[24:27], v[216:231]
  s_waitcnt vmcnt(11)
  v_mfma_f32_32x32x16_bf16 v[176:191], v[96:99], v[28:31], v[176:191]
  v_mfma_f32_32x32x16_bf16 v[216:231], v[100:103], v[28:31], v[216:231]
  s_lshl_b32 s61, s22, 2
  s_add_u32 s61, s61, 163584
  v_mov_b32 v63, s61
  s_lshl_b32 s61, s43, 4
  s_add_u32 s62, s61, 163584
  v_and_b32 v254, 3, v1
  v_lshl_add_u32 v254, v254, 2, s62
  s_mov_b32 s61, 133888
  s_mov_b32 s62, 150272
  s_cmp_eq_u32 s43, 1
  s_cselect_b32 s61, 49152, s61
  s_cselect_b32 s62, 114688, s62
  s_xor_b32 s63, s42, 1
  s_lshl_b32 s63, s63, 11
  s_add_u32 s63, s63, s61
  v_add_u32 v60, s63, v3
  s_xor_b32 s63, s42, 2
  s_lshl_b32 s63, s63, 11
  s_add_u32 s63, s63, s61
  v_add_u32 v61, s63, v3
  s_xor_b32 s63, s42, 3
  s_lshl_b32 s63, s63, 11
  s_add_u32 s63, s63, s62
  v_add_u32 v62, s63, v3
  s_lshl_b32 s63, s42, 11
  s_add_u32 s61, s61, s63
  s_add_u32 s62, s62, s63
  v_add_u32 v252, s61, v3
  v_add_u32 v253, s62, v3
  v_mov_b32 v255, 1
  ds_read_b32 v4, v254 offset:32
  v_lshlrev_b32 v64, 16, v12
  v_and_b32 v65, 0xffff0000, v12
  v_lshlrev_b32 v66, 16, v13
  v_and_b32 v67, 0xffff0000, v13
  v_lshlrev_b32 v68, 16, v14
  v_and_b32 v69, 0xffff0000, v14
  v_lshlrev_b32 v70, 16, v15
  v_and_b32 v71, 0xffff0000, v15
  s_waitcnt vmcnt(10)
  v_mfma_f32_32x32x16_bf16 v[176:191], v[104:107], v[236:239], v[176:191]
  v_mfma_f32_32x32x16_bf16 v[216:231], v[108:111], v[236:239], v[216:231]
  s_waitcnt vmcnt(9)
  v_mfma_f32_32x32x16_bf16 v[176:191], v[112:115], v[32:35], v[176:191]
  v_mfma_f32_32x32x16_bf16 v[216:231], v[116:119], v[32:35], v[216:231]
  s_waitcnt vmcnt(8)
  v_mfma_f32_32x32x16_bf16 v[176:191], v[120:123], v[36:39], v[176:191]
  v_mfma_f32_32x32x16_bf16 v[216:231], v[124:127], v[36:39], v[216:231]
  s_waitcnt vmcnt(7)
  v_mfma_f32_32x32x16_bf16 v[176:191], v[128:131], v[240:243], v[176:191]
  v_mfma_f32_32x32x16_bf16 v[216:231], v[160:163], v[240:243], v[216:231]
  s_waitcnt vmcnt(6)
  v_mfma_f32_32x32x16_bf16 v[176:191], v[164:167], v[40:43], v[176:191]
  v_mfma_f32_32x32x16_bf16 v[216:231], v[168:171], v[40:43], v[216:231]
  s_waitcnt vmcnt(5)
  v_mfma_f32_32x32x16_bf16 v[176:191], v[172:175], v[44:47], v[176:191]
  v_mfma_f32_32x32x16_bf16 v[216:231], v[132:135], v[44:47], v[216:231]
  s_waitcnt vmcnt(4)
  v_mfma_f32_32x32x16_bf16 v[176:191], v[136:139], v[244:247], v[176:191]
  v_mfma_f32_32x32x16_bf16 v[216:231], v[140:143], v[244:247], v[216:231]
  s_waitcnt vmcnt(3)
  v_mfma_f32_32x32x16_bf16 v[176:191], v[192:195], v[48:51], v[176:191]
  v_mfma_f32_32x32x16_bf16 v[216:231], v[196:199], v[48:51], v[216:231]
  s_waitcnt vmcnt(2)
  s_cmp_ge_u32 s42, 2
  s_cbranch_scc1 f_dskip
  v_mfma_f32_32x32x16_bf16 v[176:191], v[200:203], v[52:55], v[176:191]
  v_mfma_f32_32x32x16_bf16 v[216:231], v[204:207], v[52:55], v[216:231]
f_dskip:
  s_waitcnt lgkmcnt(0)
  v_cmp_gt_u32 vcc, 2, v4
  s_cmp_eq_u64 vcc, 0
  s_cbranch_scc1 f_wx_ok
  s_mov_b32 s60, 0
f_wx:
  ds_read_b32 v4, v254 offset:32
  s_waitcnt lgkmcnt(0)
  v_cmp_gt_u32 vcc, 2, v4
  s_cmp_eq_u64 vcc, 0
  s_cbranch_scc1 f_wx_ok
  s_add_u32 s60, s60, 1
  s_cmp_lt_u32 s60, 640000
  s_cbranch_scc1 f_wx
f_wx_ok:
  s_nop 9
  ds_write_b128 v60, v[184:187] offset:0
  ds_write_b128 v60, v[188:191] offset:1024
  ds_write_b128 v61, v[216:219] offset:8192
  ds_write_b128 v61, v[220:223] offset:9216
  ds_write_b128 v62, v[224:227] offset:0
  ds_write_b128 v62, v[228:231] offset:1024
  s_mov_b64 exec, 1
  ds_write_b32 v63, v255 offset:96
  s_mov_b64 exec, -1
  s_mov_b32 s60, 0
f_wd:
  ds_read_b32 v4, v254 offset:96
  s_waitcnt lgkmcnt(0)
  v_cmp_gt_u32 vcc, 1, v4
  s_cmp_eq_u64 vcc, 0
  s_cbranch_scc1 f_wd_ok
  s_add_u32 s60, s60, 1
  s_cmp_lt_u32 s60, 640000
  s_cbranch_scc1 f_wd
f_wd_ok:
  ds_read_b128 v[16:19], v252 offset:0
  ds_read_b128 v[20:23], v252 offset:1024
  ds_read_b128 v[24:27], v252 offset:8192
  ds_read_b128 v[28:31], v252 offset:9216
  ds_read_b128 v[32:35], v253 offset:0
  ds_read_b128 v[36:39], v253 offset:1024
  s_waitcnt lgkmcnt(4)
  v_add_f32 v176, v176, v16
  v_add_f32 v177, v177, v17
  v_add_f32 v178, v178, v18
  v_add_f32 v179, v179, v19
  v_add_f32 v180, v180, v20
  v_add_f32 v181, v181, v21
  v_add_f32 v182, v182, v22
  v_add_f32 v183, v183, v23
  s_waitcnt lgkmcnt(2)
  v_add_f32 v176, v176, v24
  v_add_f32 v177, v177, v25
  v_add_f32 v178, v178, v26
  v_add_f32 v179, v179, v27
  v_add_f32 v180, v180, v28
  v_add_f32 v181, v181, v29
  v_add_f32 v182, v182, v30
  v_add_f32 v183, v183, v31
  s_waitcnt lgkmcnt(0)
  v_add_f32 v176, v176, v32
  v_add_f32 v177, v177, v33
  v_add_f32 v178, v178, v34
  v_add_f32 v179, v179, v35
  v_add_f32 v180, v180, v36
  v_add_f32 v181, v181, v37
  v_add_f32 v182, v182, v38
  v_add_f32 v183, v183, v39
  s_waitcnt vmcnt(0)
  v_fma_f32 v176, v176, v248, v64
  v_fma_f32 v177, v177, v249, v65
  v_fma_f32 v178, v178, v250, v66
  v_fma_f32 v179, v179, v251, v67
  v_fma_f32 v180, v180, v56, v68
  v_fma_f32 v181, v181, v57, v69
  v_fma_f32 v182, v182, v58, v70
  v_fma_f32 v183, v183, v59, v71
  v_cvt_pk_bf16_f32 v4, v176, v177
  v_cvt_pk_bf16_f32 v5, v178, v179
  v_cvt_pk_bf16_f32 v6, v180, v181
  v_cvt_pk_bf16_f32 v7, v182, v183
  buffer_store_dwordx2 v[4:5], v11, s[16:19], s49 offen
  buffer_store_dwordx2 v[6:7], v11, s[16:19], s49 offen offset:16
f_pend:
f_end:
  s_endpgm
f_skip:
  buffer_load_dwordx4 v[16:19], v2, s[8:11], s38 offen offset:0
  buffer_load_dwordx4 v[20:23], v2, s[8:11], s39 offen offset:0
  buffer_load_dwordx4 v[24:27], v2, s[8:11], s38 offen offset:1024
  buffer_load_dwordx4 v[28:31], v2, s[8:11], s39 offen offset:1024
  buffer_load_dwordx4 v[32:35], v2, s[8:11], s38 offen offset:2048
  buffer_load_dwordx4 v[36:39], v2, s[8:11], s39 offen offset:2048
  buffer_load_dwordx4 v[40:43], v2, s[8:11], s38 offen offset:3072
  buffer_load_dwordx4 v[44:47], v2, s[8:11], s39 offen offset:3072
  s_add_u32 s61, s38, 4096
  buffer_load_dwordx4 v[48:51], v2, s[8:11], s61 offen offset:0
  s_add_u32 s61, s39, 4096
  buffer_load_dwordx4 v[52:55], v2, s[8:11], s61 offen offset:0
  s_add_u32 s61, s38, 4096
  buffer_load_dwordx4 v[56:59], v2, s[8:11], s61 offen offset:1024
  s_add_u32 s61, s39, 4096
  buffer_load_dwordx4 v[60:63], v2, s[8:11], s61 offen offset:1024
  s_add_u32 s61, s38, 4096
  buffer_load_dwordx4 v[64:67], v2, s[8:11], s61 offen offset:2048
  s_add_u32 s61, s39, 4096
  buffer_load_dwordx4 v[68:71], v2, s[8:11], s61 offen offset:2048
  s_add_u32 s61, s38, 4096
  buffer_load_dwordx4 v[72:75], v2, s[8:11], s61 offen offset:3072
  s_add_u32 s61, s39, 4096
  buffer_load_dwordx4 v[76:79], v2, s[8:11], s61 offen offset:3072
  s_add_u32 s61, s38, 8192
  buffer_load_dwordx4 v[80:83], v2, s[8:11], s61 offen offset:0
  s_add_u32 s61, s39, 8192
  buffer_load_dwordx4 v[84:87], v2, s[8:11], s61 offen offset:0
  s_add_u32 s61, s38, 8192
  buffer_load_dwordx4 v[144:147], v2, s[8:11], s61 offen offset:1024
  s_add_u32 s61, s39, 8192
  buffer_load_dwordx4 v[148:151], v2, s[8:11], s61 offen offset:1024
  s_add_u32 s61, s38, 8192
  buffer_load_dwordx4 v[152:155], v2, s[8:11], s61 offen offset:2048
  s_add_u32 s61, s39, 8192
  buffer_load_dwordx4 v[156:159], v2, s[8:11], s61 offen offset:2048
  s_add_u32 s61, s38, 8192
  buffer_load_dwordx4 v[88:91], v2, s[8:11], s61 offen offset:3072
  s_add_u32 s61, s39, 8192
  buffer_load_dwordx4 v[92:95], v2, s[8:11], s61 offen offset:3072
  s_add_u32 s61, s38, 12288
  buffer_load_dwordx4 v[96:99], v2, s[8:11], s61 offen offset:0
  s_add_u32 s61, s39, 12288
  buffer_load_dwordx4 v[100:103], v2, s[8:11], s61 offen offset:0
  s_add_u32 s61, s38, 12288
  buffer_load_dwordx4 v[104:107], v2, s[8:11], s61 offen offset:1024
  s_add_u32 s61, s39, 12288
  buffer_load_dwordx4 v[108:111], v2, s[8:11], s61 offen offset:1024
  s_add_u32 s61, s38, 12288
  buffer_load_dwordx4 v[112:115], v2, s[8:11], s61 offen offset:2048
  s_add_u32 s61, s39, 12288
  buffer_load_dwordx4 v[116:119], v2, s[8:11], s61 offen offset:2048
  s_add_u32 s61, s38, 12288
  buffer_load_dwordx4 v[120:123], v2, s[8:11], s61 offen offset:3072
  s_add_u32 s61, s39, 12288
  buffer_load_dwordx4 v[124:127], v2, s[8:11], s61 offen offset:3072
  s_add_u32 s61, s38, 16384
  buffer_load_dwordx4 v[128:131], v2, s[8:11], s61 offen offset:0
  s_add_u32 s61, s39, 16384
  buffer_load_dwordx4 v[160:163], v2, s[8:11], s61 offen offset:0
  s_add_u32 s61, s38, 16384
  buffer_load_dwordx4 v[164:167], v2, s[8:11], s61 offen offset:1024
  s_add_u32 s61, s39, 16384
  buffer_load_dwordx4 v[168:171], v2, s[8:11], s61 offen offset:1024
  s_add_u32 s61, s38, 16384
  buffer_load_dwordx4 v[172:175], v2, s[8:11], s61 offen offset:2048
  s_add_u32 s61, s39, 16384
  buffer_load_dwordx4 v[132:135], v2, s[8:11], s61 offen offset:2048
  s_add_u32 s61, s38, 16384
  buffer_load_dwordx4 v[136:139], v2, s[8:11], s61 offen offset:3072
  s_add_u32 s61, s39, 16384
  buffer_load_dwordx4 v[140:143], v2, s[8:11], s61 offen offset:3072
  s_add_u32 s61, s38, 20480
  buffer_load_dwordx4 v[192:195], v2, s[8:11], s61 offen offset:0
  s_add_u32 s61, s39, 20480
  buffer_load_dwordx4 v[196:199], v2, s[8:11], s61 offen offset:0
  s_add_u32 s61, s38, 20480
  buffer_load_dwordx4 v[200:203], v2, s[8:11], s61 offen offset:1024
  s_add_u32 s61, s39, 20480
  buffer_load_dwordx4 v[204:207], v2, s[8:11], s61 offen offset:1024
  s_branch f_d
.section .rodata,"a"
.p2align 6
.amdhsa_kernel front_kernel
  .amdhsa_next_free_vgpr 256
  .amdhsa_next_free_sgpr 102
  .amdhsa_accum_offset 256
  .amdhsa_group_segment_fixed_size 0
  .amdhsa_kernarg_size 96
  .amdhsa_user_sgpr_count 2
  .amdhsa_user_sgpr_kernarg_segment_ptr 1
  .amdhsa_system_sgpr_workgroup_id_x 1
.end_amdhsa_kernel
.p2align 6
.amdhsa_kernel fused_kernel
  .amdhsa_next_free_vgpr 256
  .amdhsa_next_free_sgpr 102
  .amdhsa_accum_offset 256
  .amdhsa_group_segment_fixed_size 0
  .amdhsa_kernarg_size 96
  .amdhsa_user_sgpr_count 2
  .amdhsa_user_sgpr_kernarg_segment_ptr 1
  .amdhsa_system_sgpr_workgroup_id_x 1
.end_amdhsa_kernel
```
